```python
import torch

def _softmax(x, axis=-1):
    return torch.softmax(x, dim=axis)
def _gelu(x):
    return torch.nn.functional.gelu(x, approximate="tanh")
def _silu(x):
    return torch.nn.functional.silu(x)
def _sigmoid(x):
    return torch.sigmoid(x)
def _layernorm(x, axis=-1, eps=1e-5):
    m = x.mean(dim=axis, keepdim=True)
    v = x.var(dim=axis, keepdim=True, unbiased=False)
    return (x - m) / torch.sqrt(v + eps)
def _scatter_add(tgt, idx, src, axis=0):
    return tgt.clone().index_add_(axis, idx, src)
def _segment_sum(src, seg, n):
    out = torch.zeros((n,) + src.shape[1:], dtype=src.dtype)
    return out.index_add_(0, seg, src)
def _pad(x, pw):
    flat = tuple(v for pair in reversed(pw) for v in pair)
    return torch.nn.functional.pad(x, flat)

kernel_name = 'interleave_layers__ssm_conv_s4d__mixer_channel_mlp__prompt'

def setup_inputs():

    _w = (lambda a: (lambda t: t.to(torch.bfloat16) if t.is_floating_point() else t)(torch.as_tensor(a)))
    def _A_setup():
        Bsz, L, D, N = 1, 2048, 512, 128
        return {
            "u": _w((lambda *s: torch.randn(*s, dtype=torch.bfloat16) * 0.05)(Bsz, L, D)),
            "log_A_real": _w((lambda *s: torch.randn(*s, dtype=torch.bfloat16) * 3.2)(D, N) * 0.5),
            "A_imag": _w((lambda *s: torch.randn(*s, dtype=torch.bfloat16) * 0.05)(D, N) * 3.14),
            "C_real": _w((lambda *s: torch.randn(*s, dtype=torch.bfloat16) * 0.05)(D, N) / N ** 0.5),
            "C_imag": _w((lambda *s: torch.randn(*s, dtype=torch.bfloat16) * 0.05)(D, N) / N ** 0.5),
            "log_dt": _w((lambda *s: torch.randn(*s, dtype=torch.bfloat16) * 0.05)(D) * 0.5 - 4.0),
            "D_skip": _w((lambda *s: torch.randn(*s, dtype=torch.bfloat16) * 0.05)(D)),
        }
    _A_in = _A_setup()

    def _B_setup():
        B, S, D, F = 1, 2048, 512, 1792
        return {
            "x": _w((lambda *s: torch.randn(*s, dtype=torch.bfloat16) * 0.05)(B, S, D)),
            "w1": _w((lambda *s: torch.randn(*s, dtype=torch.bfloat16) * 1.6)(D, F) * (D ** -0.5)),
            "b1": _w((lambda *s: torch.randn(*s, dtype=torch.bfloat16) * 0.4)(F)),
            "w2": _w((lambda *s: torch.randn(*s, dtype=torch.bfloat16) * 0.1)(F, D) * (F ** -0.5)),
            "b2": _w((lambda *s: torch.randn(*s, dtype=torch.bfloat16) * 0.1)(D)),
        }
    _B_in = _B_setup()

    return {
        "A_u": _A_in["u"],
        "A_log_A_real": _A_in["log_A_real"],
        "A_A_imag": _A_in["A_imag"],
        "A_C_real": _A_in["C_real"],
        "A_C_imag": _A_in["C_imag"],
        "A_log_dt": _A_in["log_dt"],
        "A_D_skip": _A_in["D_skip"],
        "B_x": _B_in["x"],
        "B_w1": _B_in["w1"],
        "B_b1": _B_in["b1"],
        "B_w2": _B_in["w2"],
        "B_b2": _B_in["b2"],
    }

def reference(A_u, A_log_A_real, A_A_imag, A_C_real, A_C_imag, A_log_dt, A_D_skip, B_x, B_w1, B_b1, B_w2, B_b2):
    def _A_ref(u, log_A_real, A_imag, C_real, C_imag, log_dt, D_skip):
        L = u.shape[1]
        dt = torch.exp(log_dt)
        A = -torch.exp(log_A_real) + 1j * A_imag
        C = (C_real + 1j * C_imag) * dt[:, None]
        pos = (lambda x, dt: x.to(dt))(torch.arange(L), log_dt.dtype)
        P = torch.exp((A * dt[:, None])[:, :, None] * pos[None, None, :])
        K = 2.0 * torch.einsum("dn,dnl->dl", C, P).real
        L2 = 2 * L
        u_t = (lambda x, *d: x.permute(*d))(u, 0, 2, 1)
        Kf = (lambda x, *a, **k: torch.fft.rfft(x.float(), *a, **k))(K, L2)
        Uf = (lambda x, *a, **k: torch.fft.rfft(x.float(), *a, **k))(u_t, L2)
        y = (lambda x, *a, **k: torch.fft.irfft(x, *a, **k).to(torch.bfloat16))(Uf * Kf[None, :, :], L2)[:, :, :L]
        y = (lambda x, *d: x.permute(*d))(y, 0, 2, 1)
        return y + u * D_skip[None, None, :]

    def _B_ref(x, w1, b1, w2, b2):
        y = _layernorm(x, axis=-1)
        h = _gelu(torch.einsum("bsd,df->bsf", y, w1) + b1)
        return torch.einsum("bsf,fd->bsd", h, w2) + b2

    x = A_u
    x = x + _A_ref(_layernorm(x, axis=-1), A_log_A_real, A_A_imag, A_C_real, A_C_imag, A_log_dt, A_D_skip)
    x = x + _B_ref(_layernorm(x, axis=-1), B_w1, B_b1, B_w2, B_b2)
    x = x + _A_ref(_layernorm(x, axis=-1), A_log_A_real, A_A_imag, A_C_real, A_C_imag, A_log_dt, A_D_skip)
    x = x + _B_ref(_layernorm(x, axis=-1), B_w1, B_b1, B_w2, B_b2)
    return x
```

```asm
; @launch kernel=mega_kernel grid=(256,1,1) block=(256,1,1) lds=163840
.amdgcn_target "amdgcn-amd-amdhsa--gfx950"
.text
.globl mega_kernel
.p2align 8
.type mega_kernel,@function
mega_kernel:
  s_cmp_ge_u32 s2, 256
  s_cbranch_scc1 mega_kernel_end
  s_load_dwordx16 s[4:19], s[0:1], 0
  s_load_dwordx8 s[20:27], s[0:1], 64
  s_load_dwordx4 s[28:31], s[0:1], 96
  s_load_dwordx2 s[32:33], s[0:1], 112

  s_getpc_b64 s[94:95]
cpf_here:
  s_lshr_b32 s40, s2, 3
  s_and_b32 s40, s40, 7
  s_lshl_b32 s40, s40, 13
  v_lshrrev_b32 v241, 6, v0
  v_lshlrev_b32 v241, 11, v241
  v_and_b32 v240, 63, v0
  v_lshl_add_u32 v240, v240, 4, v241
  v_add_u32 v240, s40, v240
  v_add_u32 v241, 1024, v240
  v_min_u32 v240, mega_kernel_end-cpf_here-16, v240
  v_min_u32 v241, mega_kernel_end-cpf_here-16, v241
  global_load_dwordx4 v[244:247], v240, s[94:95]
  global_load_dwordx4 v[248:251], v241, s[94:95]

  v_lshrrev_b32 v2, 6, v0
  v_and_b32 v1, 63, v0
  s_and_b32 s35, s2, 7
  s_lshr_b32 s36, s2, 3
  v_readfirstlane_b32 s34, v2
  s_lshl_b32 s37, s35, 6
  s_lshl_b32 s38, s36, 1
  s_add_u32 s37, s37, s38
  s_lshr_b32 s38, s36, 4
  s_lshl_b32 s39, s35, 1
  s_add_u32 s38, s38, s39
  s_and_b32 s39, s36, 15
  s_waitcnt lgkmcnt(0)

  s_add_u32 s90, s32, 31457280
  s_addc_u32 s91, s33, 0
  s_cmp_lg_u32 s2, 0
  s_cbranch_scc1 zc_1
  s_cmp_lg_u32 s34, 3
  s_cbranch_scc1 zc_1
  v_lshlrev_b32 v2, 8, v1
  v_add_u32 v3, 16384, v2
  v_mov_b32 v4, 0
  global_store_dword v2, v4, s[90:91] sc1
  global_store_dword v3, v4, s[90:91] sc1
  v_add_u32 v3, 16384, v3
  global_store_dword v3, v4, s[90:91] sc1

zc_1:
  s_lshl_b32 s40, s2, 3
  s_lshl_b32 s41, s34, 1
  s_add_u32 s40, s40, s41
  s_lshl_b32 s41, s40, 10
  v_lshlrev_b32 v2, 4, v1
  v_add_u32 v3, s41, v2
  global_load_dwordx4 a[0:3], v3, s[4:5]
  global_load_dwordx4 a[4:7], v3, s[4:5] offset:1024
  s_lshl_b32 s42, s36, 16
  s_lshl_b32 s43, s35, 7
  s_add_u32 s42, s42, s43
  v_lshrrev_b32 v20, 3, v0
  v_and_b32 v21, 7, v0
  v_lshlrev_b32 v22, 10, v20
  v_lshl_add_u32 v22, v21, 4, v22
  v_add_u32 v22, s42, v22
  v_add_u32 v23, 0x8000, v22
  global_load_dwordx4 a[8:11], v22, s[4:5]
  global_load_dwordx4 a[12:15], v23, s[4:5]
  s_lshl_b32 s44, s34, 7
  s_lshl_b32 s45, s37, 8
  s_add_u32 s44, s44, s45
  v_lshlrev_b32 v35, 1, v1
  v_add_u32 v35, s44, v35
  v_xor_b32 v36, 128, v35
  s_lshr_b32 s45, s34, 1
  s_add_u32 s45, s45, s37
  s_lshl_b32 s45, s45, 1
  v_mov_b32 v37, s45
  global_load_ushort v216, v37, s[14:15]
  global_load_ushort v217, v35, s[6:7]
  global_load_ushort v218, v35, s[8:9]
  global_load_ushort v219, v35, s[10:11]
  global_load_ushort v220, v35, s[12:13]
  global_load_ushort v221, v36, s[10:11]
  global_load_ushort v222, v36, s[12:13]
  v_mul_u32_u24 v32, 4682, v0
  v_lshrrev_b32 v32, 16, v32
  v_mul_u32_u24 v33, 14, v32
  v_sub_u32 v33, v0, v33
  s_mul_i32 s44, s38, 114688
  s_mul_i32 s45, s39, 224
  s_add_u32 s44, s44, s45
  v_mul_u32_u24 v34, 7168, v32
  v_lshl_add_u32 v34, v33, 4, v34
  v_add_u32 v34, s44, v34
  v_min_u32 v34, 1831408, v34
  global_load_dwordx4 a[16:19], v34, s[20:21]
  global_load_dwordx4 a[20:23], v34, s[20:21] offset:3584

  s_lshl_b32 s72, s2, 2
  s_add_u32 s72, s72, s34
  s_min_u32 s73, s72, 895
  s_cmp_ge_u32 s73, 448
  s_cbranch_scc1 wt_w1_2
  s_lshr_b32 s74, s73, 3
  s_and_b32 s75, s73, 7
  s_lshl_b32 s76, s74, 15
  s_lshl_b32 s77, s75, 7
  s_add_u32 s76, s76, s77
  s_add_u32 s82, s24, s76
  s_addc_u32 s83, s25, 0
  s_movk_i32 s81, 1024
  s_mul_i32 s76, s75, 56
  s_add_u32 s76, s76, s74
  s_lshl_b32 s76, s76, 12
  s_add_u32 s76, s76, 35651584
  s_add_u32 s77, s76, 1024
  s_add_u32 s78, s76, 2048
  s_add_u32 s79, s76, 3072
  s_branch wt_sel_3

wt_w1_2:
  s_sub_u32 s73, s73, 448
  s_mul_i32 s74, s73, 2341
  s_lshr_b32 s74, s74, 16
  s_mul_i32 s75, s74, 28
  s_sub_u32 s75, s73, s75
  s_mul_i32 s76, s74, 114688
  s_lshl_b32 s77, s75, 7
  s_add_u32 s76, s76, s77
  s_add_u32 s82, s20, s76
  s_addc_u32 s83, s21, 0
  s_movk_i32 s81, 3584

  s_lshl_b32 s84, s75, 2
  s_add_u32 s84, s84, 0
  s_mul_i32 s85, s84, 9363
  s_lshr_b32 s85, s85, 16
  s_mul_i32 s86, s85, 7
  s_sub_u32 s84, s84, s86
  s_lshl_b32 s85, s85, 4
  s_add_u32 s85, s85, s74
  s_mul_i32 s85, s85, 7
  s_add_u32 s85, s85, s84
  s_lshl_b32 s85, s85, 10
  s_add_u32 s76, s85, 33554432

  s_lshl_b32 s84, s75, 2
  s_add_u32 s84, s84, 1
  s_mul_i32 s85, s84, 9363
  s_lshr_b32 s85, s85, 16
  s_mul_i32 s86, s85, 7
  s_sub_u32 s84, s84, s86
  s_lshl_b32 s85, s85, 4
  s_add_u32 s85, s85, s74
  s_mul_i32 s85, s85, 7
  s_add_u32 s85, s85, s84
  s_lshl_b32 s85, s85, 10
  s_add_u32 s77, s85, 33554432

  s_lshl_b32 s84, s75, 2
  s_add_u32 s84, s84, 2
  s_mul_i32 s85, s84, 9363
  s_lshr_b32 s85, s85, 16
  s_mul_i32 s86, s85, 7
  s_sub_u32 s84, s84, s86
  s_lshl_b32 s85, s85, 4
  s_add_u32 s85, s85, s74
  s_mul_i32 s85, s85, 7
  s_add_u32 s85, s85, s84
  s_lshl_b32 s85, s85, 10
  s_add_u32 s78, s85, 33554432

  s_lshl_b32 s84, s75, 2
  s_add_u32 s84, s84, 3
  s_mul_i32 s85, s84, 9363
  s_lshr_b32 s85, s85, 16
  s_mul_i32 s86, s85, 7
  s_sub_u32 s84, s84, s86
  s_lshl_b32 s85, s85, 4
  s_add_u32 s85, s85, s74
  s_mul_i32 s85, s85, 7
  s_add_u32 s85, s85, s84
  s_lshl_b32 s85, s85, 10
  s_add_u32 s79, s85, 33554432

wt_sel_3:
  v_lshrrev_b32 v176, 3, v1
  v_and_b32 v177, 7, v1
  v_mul_lo_u32 v178, v176, s81
  v_lshl_add_u32 v178, v177, 4, v178
  s_lshl_b32 s84, s81, 3

  global_load_dwordx4 a[24:27], v178, s[82:83]
  v_add_u32 v178, s84, v178
  global_load_dwordx4 a[28:31], v178, s[82:83]
  v_add_u32 v178, s84, v178
  global_load_dwordx4 a[32:35], v178, s[82:83]
  v_add_u32 v178, s84, v178
  global_load_dwordx4 a[36:39], v178, s[82:83]
  s_mov_b32 s48, 0x3f803f80
  v_lshrrev_b32 v20, 3, v0
  v_and_b32 v21, 7, v0
  v_bfe_u32 v22, v20, 1, 1
  v_bfe_u32 v23, v20, 3, 1
  v_lshl_or_b32 v22, v23, 1, v22
  v_lshlrev_b32 v22, 1, v22
  v_xor_b32 v22, v22, v21
  v_lshlrev_b32 v22, 4, v22
  v_lshl_add_u32 v22, v20, 7, v22
  v_add_u32 v22, 114688, v22

  v_and_b32 v61, 15, v1
  v_lshrrev_b32 v62, 4, v1
  v_lshrrev_b32 v60, 2, v61
  v_lshl_add_u32 v60, v62, 3, v60
  v_lshlrev_b32 v60, 7, v60
  v_and_b32 v62, 1, v62
  v_lshlrev_b32 v62, 1, v62
  v_bfe_u32 v61, v1, 3, 1
  v_or_b32 v62, v62, v61
  v_xor_b32 v62, s34, v62
  v_lshl_add_u32 v60, v62, 5, v60
  v_and_b32 v61, 3, v1
  v_lshl_add_u32 v60, v61, 3, v60
  v_add_u32 v60, 114688, v60

  s_waitcnt vmcnt(13)
  ds_write_b128 v22, a[8:11]
  ds_write_b128 v22, a[12:15] offset:4096

  v_accvgpr_read_b32 v4, a0
  v_accvgpr_read_b32 v5, a1
  v_accvgpr_read_b32 v6, a2
  v_accvgpr_read_b32 v7, a3
  v_accvgpr_read_b32 v8, a4
  v_accvgpr_read_b32 v9, a5
  v_accvgpr_read_b32 v10, a6
  v_accvgpr_read_b32 v11, a7
  v_dot2_f32_bf16 v40, v4, s48, 0
  v_dot2_f32_bf16 v42, v4, v4, 0
  v_dot2_f32_bf16 v40, v5, s48, v40
  v_dot2_f32_bf16 v42, v5, v5, v42
  v_dot2_f32_bf16 v40, v6, s48, v40
  v_dot2_f32_bf16 v42, v6, v6, v42
  v_dot2_f32_bf16 v40, v7, s48, v40
  v_dot2_f32_bf16 v42, v7, v7, v42
  v_dot2_f32_bf16 v41, v8, s48, 0
  v_dot2_f32_bf16 v43, v8, v8, 0
  v_dot2_f32_bf16 v41, v9, s48, v41
  v_dot2_f32_bf16 v43, v9, v9, v43
  v_dot2_f32_bf16 v41, v10, s48, v41
  v_dot2_f32_bf16 v43, v10, v10, v43
  v_dot2_f32_bf16 v41, v11, s48, v41
  v_dot2_f32_bf16 v43, v11, v11, v43
  s_waitcnt vmcnt(4)
  s_mov_b32 s49, 0x00003f80
  s_mov_b32 s50, 0x3f800000
  v_mul_u32_u24 v32, 4682, v0
  v_lshrrev_b32 v32, 16, v32
  v_mul_u32_u24 v33, 14, v32
  v_sub_u32 v33, v0, v33

  v_accvgpr_read_b32 v24, a16
  v_accvgpr_read_b32 v25, a17
  v_accvgpr_read_b32 v26, a18
  v_accvgpr_read_b32 v27, a19
  v_accvgpr_read_b32 v28, a20
  v_accvgpr_read_b32 v29, a21
  v_accvgpr_read_b32 v30, a22
  v_accvgpr_read_b32 v31, a23
  v_dot2_f32_bf16 v52, v24, s49, 0
  v_dot2_f32_bf16 v53, v24, s50, 0
  v_dot2_f32_bf16 v54, v25, s49, 0
  v_dot2_f32_bf16 v55, v25, s50, 0
  v_dot2_f32_bf16 v56, v26, s49, 0
  v_dot2_f32_bf16 v57, v26, s50, 0
  v_dot2_f32_bf16 v58, v27, s49, 0
  v_dot2_f32_bf16 v59, v27, s50, 0
  v_dot2_f32_bf16 v52, v28, s49, v52
  v_dot2_f32_bf16 v53, v28, s50, v53
  v_dot2_f32_bf16 v54, v29, s49, v54
  v_dot2_f32_bf16 v55, v29, s50, v55
  v_dot2_f32_bf16 v56, v30, s49, v56
  v_dot2_f32_bf16 v57, v30, s50, v57
  v_dot2_f32_bf16 v58, v31, s49, v58
  v_dot2_f32_bf16 v59, v31, s50, v59
  v_mul_u32_u24 v34, 448, v32
  v_lshl_add_u32 v34, v33, 5, v34
  v_add_u32 v34, 122880, v34
  v_cmp_gt_u32 vcc, 224, v0
  s_and_saveexec_b64 s[46:47], vcc
  ds_write_b128 v34, v[52:55]
  ds_write_b128 v34, v[56:59] offset:16
  s_mov_b64 exec, s[46:47]

  s_add_u32 s52, s32, 0
  s_addc_u32 s53, s33, 0
  s_lshl_b32 s42, s35, 6
  s_lshl_b32 s43, s36, 6
  s_waitcnt lgkmcnt(0)
  s_barrier

  ds_read_b64_tr_b16 v[64:65], v60 offset:0
  ds_read_b64_tr_b16 v[66:67], v60 offset:512
  ds_read_b64_tr_b16 v[68:69], v60 offset:4096
  ds_read_b64_tr_b16 v[70:71], v60 offset:4608
  v_and_b32 v61, 15, v1
  s_lshl_b32 s94, s34, 4
  s_add_u32 s94, s94, s42
  v_add_u32 v61, s94, v61
  v_lshlrev_b32 v63, 12, v61
  v_lshrrev_b32 v62, 4, v1
  v_lshl_add_u32 v63, v62, 4, v63
  s_lshl_b32 s94, s43, 1
  v_add_u32 v63, s94, v63
  s_waitcnt lgkmcnt(0)
  global_store_dwordx4 v63, v[64:67], s[52:53] sc1
  global_store_dwordx4 v63, v[68:71], s[52:53] offset:64 sc1

  s_nop 1
  v_add_f32_dpp v40, v40, v40 quad_perm:[1,0,3,2] row_mask:0xf bank_mask:0xf
  v_add_f32_dpp v41, v41, v41 quad_perm:[1,0,3,2] row_mask:0xf bank_mask:0xf
  v_add_f32_dpp v42, v42, v42 quad_perm:[1,0,3,2] row_mask:0xf bank_mask:0xf
  v_add_f32_dpp v43, v43, v43 quad_perm:[1,0,3,2] row_mask:0xf bank_mask:0xf
  s_nop 1
  v_add_f32_dpp v40, v40, v40 quad_perm:[2,3,0,1] row_mask:0xf bank_mask:0xf
  v_add_f32_dpp v41, v41, v41 quad_perm:[2,3,0,1] row_mask:0xf bank_mask:0xf
  v_add_f32_dpp v42, v42, v42 quad_perm:[2,3,0,1] row_mask:0xf bank_mask:0xf
  v_add_f32_dpp v43, v43, v43 quad_perm:[2,3,0,1] row_mask:0xf bank_mask:0xf
  s_nop 1
  v_add_f32_dpp v40, v40, v40 row_half_mirror row_mask:0xf bank_mask:0xf
  v_add_f32_dpp v41, v41, v41 row_half_mirror row_mask:0xf bank_mask:0xf
  v_add_f32_dpp v42, v42, v42 row_half_mirror row_mask:0xf bank_mask:0xf
  v_add_f32_dpp v43, v43, v43 row_half_mirror row_mask:0xf bank_mask:0xf
  s_nop 1
  v_add_f32_dpp v40, v40, v40 row_mirror row_mask:0xf bank_mask:0xf
  v_add_f32_dpp v41, v41, v41 row_mirror row_mask:0xf bank_mask:0xf
  v_add_f32_dpp v42, v42, v42 row_mirror row_mask:0xf bank_mask:0xf
  v_add_f32_dpp v43, v43, v43 row_mirror row_mask:0xf bank_mask:0xf
  v_mov_b32 v44, v40
  v_mov_b32 v45, v41
  v_mov_b32 v46, v42
  v_mov_b32 v47, v43
  s_nop 1
  v_permlane16_swap_b32 v40, v44
  v_permlane16_swap_b32 v41, v45
  v_permlane16_swap_b32 v42, v46
  v_permlane16_swap_b32 v43, v47
  s_nop 1
  v_add_f32 v40, v40, v44
  v_add_f32 v41, v41, v45
  v_add_f32 v42, v42, v46
  v_add_f32 v43, v43, v47
  v_mov_b32 v44, v40
  v_mov_b32 v45, v41
  v_mov_b32 v46, v42
  v_mov_b32 v47, v43
  s_nop 1
  v_permlane32_swap_b32 v40, v44
  v_permlane32_swap_b32 v41, v45
  v_permlane32_swap_b32 v42, v46
  v_permlane32_swap_b32 v43, v47
  s_nop 1
  v_add_f32 v40, v40, v44
  v_add_f32 v41, v41, v45
  v_add_f32 v42, v42, v46
  v_add_f32 v43, v43, v47
  s_add_u32 s52, s32, 29360128
  s_addc_u32 s53, s33, 0
  s_add_u32 s54, s32, 29425664
  s_addc_u32 s55, s33, 0
  s_lshl_b32 s41, s40, 2
  v_mov_b32 v44, s41
  v_mov_b32 v46, 0
  v_mov_b32 v47, 0
  v_add_u32 v45, 8192, v44
  s_mov_b64 exec, 1
  global_store_dwordx2 v44, v[40:41], s[52:53] sc1
  global_store_dwordx2 v45, v[42:43], s[52:53] sc1
  global_store_dwordx2 v44, v[46:47], s[54:55] sc1
  global_store_dwordx2 v45, v[46:47], s[54:55] sc1
  s_mov_b64 exec, -1

  v_lshlrev_b32 v34, 2, v0
  v_add_u32 v34, 122880, v34
  v_cmp_gt_u32 vcc, 112, v0
  s_and_saveexec_b64 s[46:47], vcc
  s_cbranch_execz x0_skip_4

  ds_read_b32 v72, v34 offset:0
  ds_read_b32 v73, v34 offset:448
  ds_read_b32 v74, v34 offset:896
  ds_read_b32 v75, v34 offset:1344
  ds_read_b32 v76, v34 offset:1792
  ds_read_b32 v77, v34 offset:2240
  ds_read_b32 v78, v34 offset:2688
  ds_read_b32 v79, v34 offset:3136
  ds_read_b32 v80, v34 offset:3584
  ds_read_b32 v81, v34 offset:4032
  ds_read_b32 v82, v34 offset:4480
  ds_read_b32 v83, v34 offset:4928
  ds_read_b32 v84, v34 offset:5376
  ds_read_b32 v85, v34 offset:5824
  ds_read_b32 v86, v34 offset:6272
  ds_read_b32 v87, v34 offset:6720
  s_waitcnt lgkmcnt(0)
  v_add_f32 v72, v72, v80
  v_add_f32 v73, v73, v81
  v_add_f32 v74, v74, v82
  v_add_f32 v75, v75, v83
  v_add_f32 v76, v76, v84
  v_add_f32 v77, v77, v85
  v_add_f32 v78, v78, v86
  v_add_f32 v79, v79, v87
  v_add_f32 v72, v72, v76
  v_add_f32 v73, v73, v77
  v_add_f32 v74, v74, v78
  v_add_f32 v75, v75, v79
  v_add_f32 v72, v72, v74
  v_add_f32 v73, v73, v75
  v_add_f32 v72, v72, v73
  s_add_u32 s56, s32, 30408704
  s_addc_u32 s57, s33, 0
  s_lshl_b32 s58, s39, 4
  s_add_u32 s58, s58, s38
  s_mul_i32 s58, s58, 448
  v_lshlrev_b32 v34, 2, v0
  v_add_u32 v34, s58, v34
  global_store_dword v34, v72, s[56:57] sc1

x0_skip_4:
  s_mov_b64 exec, s[46:47]
  s_lshl_b32 s84, s34, 12
  s_add_u32 s84, s84, 0
  v_lshrrev_b32 v176, 3, v1
  v_and_b32 v177, 7, v1
  v_lshrrev_b32 v179, 4, v1
  v_and_b32 v179, 1, v179
  v_lshlrev_b32 v179, 1, v179
  v_xor_b32 v179, v177, v179
  v_lshlrev_b32 v180, 7, v176
  v_add_u32 v180, s84, v180
  v_lshl_add_u32 v181, v179, 4, v180
  v_xor_b32 v179, 4, v179
  v_lshl_add_u32 v182, v179, 4, v180
  v_and_b32 v183, 15, v1
  v_lshrrev_b32 v184, 4, v1
  v_lshrrev_b32 v185, 2, v183
  v_lshl_add_u32 v185, v184, 3, v185
  v_lshlrev_b32 v185, 7, v185
  v_and_b32 v186, 3, v183
  v_lshl_add_u32 v185, v186, 3, v185
  v_add_u32 v185, s84, v185
  v_lshrrev_b32 v186, 3, v183
  v_and_b32 v187, 1, v184
  v_lshl_or_b32 v186, v187, 1, v186
  s_waitcnt vmcnt(6)
  ds_write_b128 v181, a[24:27]
  ds_write_b128 v182, a[28:31] offset:1024
  ds_write_b128 v181, a[32:35] offset:2048
  ds_write_b128 v182, a[36:39] offset:3072

  v_xor_b32 v187, 0, v186
  v_lshl_add_u32 v188, v187, 5, v185
  v_xor_b32 v187, 1, v186
  v_lshl_add_u32 v189, v187, 5, v185
  v_xor_b32 v187, 2, v186
  v_lshl_add_u32 v190, v187, 5, v185
  v_xor_b32 v187, 3, v186
  v_lshl_add_u32 v191, v187, 5, v185
  ds_read_b64_tr_b16 v[160:161], v188
  ds_read_b64_tr_b16 v[162:163], v188 offset:512
  ds_read_b64_tr_b16 v[164:165], v189
  ds_read_b64_tr_b16 v[166:167], v189 offset:512
  ds_read_b64_tr_b16 v[168:169], v190
  ds_read_b64_tr_b16 v[170:171], v190 offset:512
  ds_read_b64_tr_b16 v[172:173], v191
  ds_read_b64_tr_b16 v[174:175], v191 offset:512
  v_lshlrev_b32 v178, 4, v1

  v_add_u32 v188, s76, v178
  v_add_u32 v189, s77, v178
  v_add_u32 v190, s78, v178
  v_add_u32 v191, s79, v178
  s_waitcnt lgkmcnt(0)
  global_store_dwordx4 v188, v[160:163], s[32:33] sc1
  global_store_dwordx4 v189, v[164:167], s[32:33] sc1
  global_store_dwordx4 v190, v[168:171], s[32:33] sc1
  global_store_dwordx4 v191, v[172:175], s[32:33] sc1
wtr_skip_5:
  s_mov_b32 s60, 0x3fb8aa3b
  s_mov_b32 s61, 0x32a57060
  s_mov_b32 s62, 0x3f317218
  s_mov_b32 s63, 0x3e22f983
  s_lshr_b32 s64, s34, 1
  s_and_b32 s65, s34, 1
  s_mul_i32 s66, s64, 44064
  s_add_u32 s66, s66, 16384
  s_lshl_b32 s46, s65, 8
  s_add_u32 s46, s46, s66
  v_lshlrev_b32 v232, 2, v1
  v_add_u32 v232, s46, v232

  s_cmp_lg_u32 s2, 0
  s_cbranch_scc1 zf_6
  s_cmp_lg_u32 s34, 3
  s_cbranch_scc1 zf_6
  v_mov_b32 v4, 0
  v_mov_b32 v5, 1
  s_mov_b64 exec, 1
  global_store_dword v4, v5, s[30:31] sc1
  s_mov_b64 exec, -1

zf_6:
  v_lshlrev_b32 v216, 16, v216
  v_lshlrev_b32 v217, 16, v217
  v_lshlrev_b32 v218, 16, v218
  v_lshlrev_b32 v219, 16, v219
  v_lshlrev_b32 v220, 16, v220
  v_lshlrev_b32 v221, 16, v221
  v_lshlrev_b32 v222, 16, v222
  v_mul_f32 v22, s60, v216
  v_fma_f32 v23, v216, s60, -v22
  v_fma_f32 v23, v216, s61, v23
  v_exp_f32 v20, v22
  v_mul_f32 v23, s62, v23
  s_nop 0
  v_fma_f32 v20, v20, v23, v20

  v_mul_f32 v24, s60, v217
  v_fma_f32 v25, v217, s60, -v24
  v_fma_f32 v25, v217, s61, v25
  v_exp_f32 v21, v24
  v_mul_f32 v25, s62, v25
  s_nop 0
  v_fma_f32 v21, v21, v25, v21

  v_cvt_pk_bf16_f32 v20, v20, v20
  v_lshlrev_b32 v20, 16, v20
  v_cvt_pk_bf16_f32 v21, v21, v21
  v_lshlrev_b32 v21, 16, v21
  v_add_f32 v22, |v219|, |v220|
  v_add_f32 v23, |v221|, |v222|
  v_add_f32 v22, v22, v23

  s_nop 1
  v_add_f32_dpp v22, v22, v22 quad_perm:[1,0,3,2] row_mask:0xf bank_mask:0xf
  s_nop 1
  v_add_f32_dpp v22, v22, v22 quad_perm:[2,3,0,1] row_mask:0xf bank_mask:0xf
  s_nop 1
  v_add_f32_dpp v22, v22, v22 row_half_mirror row_mask:0xf bank_mask:0xf
  s_nop 1
  v_add_f32_dpp v22, v22, v22 row_mirror row_mask:0xf bank_mask:0xf
  v_mov_b32 v23, v22
  s_nop 1
  v_permlane16_swap_b32 v22, v23
  s_nop 1
  v_add_f32 v22, v22, v23
  v_mov_b32 v23, v22
  s_nop 1
  v_permlane32_swap_b32 v22, v23
  s_nop 1
  v_add_f32 v22, v22, v23
  v_mul_f32 v22, v22, v20
  v_add_f32 v22, v22, v22
  v_frexp_exp_i32_f32 v23, v22
  v_sub_u32 v23, 15, v23
  v_max_i32 v23, 0xffffff9c, v23
  v_min_i32 v23, 100, v23
  v_mov_b32 v25, 1.0
  v_ldexp_f32 v24, v25, v23
  v_sub_u32 v23, 0, v23
  v_ldexp_f32 v25, v25, v23
  v_add_f32 v24, v24, v24
  v_mul_f32 v24, v24, v20
  v_mul_f32 v26, v21, v20
  v_mul_f32 v27, v218, v20
  v_mul_f32 v26, s60, v26
  v_mul_f32 v27, s63, v27
  v_mul_f32 v28, 0x41800000, v26
  v_mul_f32 v29, 0x41800000, v27
  v_exp_f32 v26, -v26
  v_exp_f32 v28, -v28
  v_fract_f32 v27, v27
  v_fract_f32 v29, v29
  v_cos_f32 v30, v27
  v_sin_f32 v31, v27
  v_cos_f32 v32, v29
  v_sin_f32 v33, v29
  v_mul_f32 v40, v219, v24
  v_mul_f32 v41, v220, v24
  v_mov_b32 v122, 1.0
  v_mov_b32 v123, 0
  v_mul_f32 v124, v26, v30
  v_mul_f32 v125, v26, -v31
  v_mul_f32 v2, v28, v32
  v_mul_f32 v3, v28, v33

  s_add_u32 s52, s32, 29491200
  s_addc_u32 s53, s33, 0
  s_add_u32 s45, s37, s64
  s_lshl_b32 s45, s45, 2
  v_mov_b32 v34, s45
  s_mov_b64 exec, 1
  global_store_dword v34, v25, s[52:53]
  s_mov_b64 exec, -1

  v_mov_b32 v247, 0
  global_load_dword v247, v247, s[30:31] sc1
  v_cvt_pk_f16_f32 v16, v40, v41
  ds_write_b32 v232, v16 offset:0
  v_cvt_pk_f16_f32 v17, v122, v123
  ds_write_b32 v232, v17 offset:22304
  v_cvt_pk_f16_f32 v18, v124, v125
  ds_write_b32 v232, v18 offset:22848
  v_pk_mul_f32 v[202:203], v[2:3], v[2:3] op_sel:[0,0] op_sel_hi:[0,1]
  v_pk_mul_f32 v[204:205], v[124:125], v[124:125] op_sel:[0,0] op_sel_hi:[0,1]
  v_pk_mul_f32 v[206:207], v[40:41], v[2:3] op_sel:[0,0] op_sel_hi:[0,1]
  v_pk_fma_f32 v[4:5], v[2:3], v[2:3], v[202:203] op_sel:[1,1,0] op_sel_hi:[1,0,1] neg_lo:[0,1,0]
  v_pk_fma_f32 v[126:127], v[124:125], v[124:125], v[204:205] op_sel:[1,1,0] op_sel_hi:[1,0,1] neg_lo:[0,1,0]
  v_pk_fma_f32 v[42:43], v[40:41], v[2:3], v[206:207] op_sel:[1,1,0] op_sel_hi:[1,0,1] neg_lo:[0,1,0]
  v_pk_mul_f32 v[202:203], v[4:5], v[4:5] op_sel:[0,0] op_sel_hi:[0,1]
  v_pk_mul_f32 v[204:205], v[126:127], v[126:127] op_sel:[0,0] op_sel_hi:[0,1]
  v_pk_mul_f32 v[206:207], v[40:41], v[4:5] op_sel:[0,0] op_sel_hi:[0,1]
  v_pk_mul_f32 v[208:209], v[42:43], v[4:5] op_sel:[0,0] op_sel_hi:[0,1]
  v_pk_mul_f32 v[210:211], v[124:125], v[126:127] op_sel:[0,0] op_sel_hi:[0,1]
  v_cvt_pk_f16_f32 v19, v126, v127
  ds_write_b32 v232, v19 offset:23392
  v_cvt_pk_f16_f32 v16, v42, v43
  ds_write_b32 v232, v16 offset:544
  v_pk_fma_f32 v[6:7], v[4:5], v[4:5], v[202:203] op_sel:[1,1,0] op_sel_hi:[1,0,1] neg_lo:[0,1,0]
  v_pk_fma_f32 v[130:131], v[126:127], v[126:127], v[204:205] op_sel:[1,1,0] op_sel_hi:[1,0,1] neg_lo:[0,1,0]
  v_pk_fma_f32 v[44:45], v[40:41], v[4:5], v[206:207] op_sel:[1,1,0] op_sel_hi:[1,0,1] neg_lo:[0,1,0]
  v_pk_fma_f32 v[46:47], v[42:43], v[4:5], v[208:209] op_sel:[1,1,0] op_sel_hi:[1,0,1] neg_lo:[0,1,0]
  v_pk_fma_f32 v[128:129], v[124:125], v[126:127], v[210:211] op_sel:[1,1,0] op_sel_hi:[1,0,1] neg_lo:[0,1,0]
  v_pk_mul_f32 v[202:203], v[6:7], v[6:7] op_sel:[0,0] op_sel_hi:[0,1]
  v_pk_mul_f32 v[204:205], v[130:131], v[130:131] op_sel:[0,0] op_sel_hi:[0,1]
  v_pk_mul_f32 v[206:207], v[40:41], v[6:7] op_sel:[0,0] op_sel_hi:[0,1]
  v_pk_mul_f32 v[208:209], v[42:43], v[6:7] op_sel:[0,0] op_sel_hi:[0,1]
  v_pk_mul_f32 v[210:211], v[124:125], v[130:131] op_sel:[0,0] op_sel_hi:[0,1]
  v_pk_mul_f32 v[212:213], v[44:45], v[6:7] op_sel:[0,0] op_sel_hi:[0,1]
  v_pk_mul_f32 v[214:215], v[126:127], v[130:131] op_sel:[0,0] op_sel_hi:[0,1]
  v_cvt_pk_f16_f32 v17, v130, v131
  ds_write_b32 v232, v17 offset:24480
  v_cvt_pk_f16_f32 v18, v44, v45
  ds_write_b32 v232, v18 offset:1088
  v_cvt_pk_f16_f32 v19, v46, v47
  ds_write_b32 v232, v19 offset:1632
  v_cvt_pk_f16_f32 v16, v128, v129
  ds_write_b32 v232, v16 offset:23936
  v_pk_fma_f32 v[8:9], v[6:7], v[6:7], v[202:203] op_sel:[1,1,0] op_sel_hi:[1,0,1] neg_lo:[0,1,0]
  v_pk_fma_f32 v[138:139], v[130:131], v[130:131], v[204:205] op_sel:[1,1,0] op_sel_hi:[1,0,1] neg_lo:[0,1,0]
  v_pk_fma_f32 v[48:49], v[40:41], v[6:7], v[206:207] op_sel:[1,1,0] op_sel_hi:[1,0,1] neg_lo:[0,1,0]
  v_pk_fma_f32 v[50:51], v[42:43], v[6:7], v[208:209] op_sel:[1,1,0] op_sel_hi:[1,0,1] neg_lo:[0,1,0]
  v_pk_fma_f32 v[132:133], v[124:125], v[130:131], v[210:211] op_sel:[1,1,0] op_sel_hi:[1,0,1] neg_lo:[0,1,0]
  v_pk_fma_f32 v[52:53], v[44:45], v[6:7], v[212:213] op_sel:[1,1,0] op_sel_hi:[1,0,1] neg_lo:[0,1,0]
  v_pk_fma_f32 v[134:135], v[126:127], v[130:131], v[214:215] op_sel:[1,1,0] op_sel_hi:[1,0,1] neg_lo:[0,1,0]
  v_pk_mul_f32 v[202:203], v[46:47], v[6:7] op_sel:[0,0] op_sel_hi:[0,1]
  v_pk_mul_f32 v[204:205], v[128:129], v[130:131] op_sel:[0,0] op_sel_hi:[0,1]
  v_cvt_pk_f16_f32 v17, v138, v139
  ds_write_b32 v232, v17 offset:26656
  v_cvt_pk_f16_f32 v18, v48, v49
  ds_write_b32 v232, v18 offset:2176
  v_cvt_pk_f16_f32 v19, v50, v51
  ds_write_b32 v232, v19 offset:2720
  v_cvt_pk_f16_f32 v16, v132, v133
  ds_write_b32 v232, v16 offset:25024
  v_cvt_pk_f16_f32 v17, v52, v53
  ds_write_b32 v232, v17 offset:3264
  v_cvt_pk_f16_f32 v18, v134, v135
  ds_write_b32 v232, v18 offset:25568
  v_pk_fma_f32 v[54:55], v[46:47], v[6:7], v[202:203] op_sel:[1,1,0] op_sel_hi:[1,0,1] neg_lo:[0,1,0]
  v_pk_fma_f32 v[136:137], v[128:129], v[130:131], v[204:205] op_sel:[1,1,0] op_sel_hi:[1,0,1] neg_lo:[0,1,0]
  v_pk_mul_f32 v[202:203], v[8:9], v[8:9] op_sel:[0,0] op_sel_hi:[0,1]
  v_pk_mul_f32 v[204:205], v[138:139], v[138:139] op_sel:[0,0] op_sel_hi:[0,1]
  v_pk_mul_f32 v[206:207], v[40:41], v[8:9] op_sel:[0,0] op_sel_hi:[0,1]
  v_pk_mul_f32 v[208:209], v[42:43], v[8:9] op_sel:[0,0] op_sel_hi:[0,1]
  v_pk_mul_f32 v[210:211], v[124:125], v[138:139] op_sel:[0,0] op_sel_hi:[0,1]
  v_pk_mul_f32 v[212:213], v[44:45], v[8:9] op_sel:[0,0] op_sel_hi:[0,1]
  v_pk_mul_f32 v[214:215], v[126:127], v[138:139] op_sel:[0,0] op_sel_hi:[0,1]
  v_cvt_pk_f16_f32 v19, v54, v55
  ds_write_b32 v232, v19 offset:3808
  v_cvt_pk_f16_f32 v16, v136, v137
  ds_write_b32 v232, v16 offset:26112
  v_pk_fma_f32 v[10:11], v[8:9], v[8:9], v[202:203] op_sel:[1,1,0] op_sel_hi:[1,0,1] neg_lo:[0,1,0]
  v_pk_fma_f32 v[154:155], v[138:139], v[138:139], v[204:205] op_sel:[1,1,0] op_sel_hi:[1,0,1] neg_lo:[0,1,0]
  v_pk_fma_f32 v[56:57], v[40:41], v[8:9], v[206:207] op_sel:[1,1,0] op_sel_hi:[1,0,1] neg_lo:[0,1,0]
  v_pk_fma_f32 v[58:59], v[42:43], v[8:9], v[208:209] op_sel:[1,1,0] op_sel_hi:[1,0,1] neg_lo:[0,1,0]
  v_pk_fma_f32 v[140:141], v[124:125], v[138:139], v[210:211] op_sel:[1,1,0] op_sel_hi:[1,0,1] neg_lo:[0,1,0]
  v_pk_fma_f32 v[60:61], v[44:45], v[8:9], v[212:213] op_sel:[1,1,0] op_sel_hi:[1,0,1] neg_lo:[0,1,0]
  v_pk_fma_f32 v[142:143], v[126:127], v[138:139], v[214:215] op_sel:[1,1,0] op_sel_hi:[1,0,1] neg_lo:[0,1,0]
  v_pk_mul_f32 v[202:203], v[46:47], v[8:9] op_sel:[0,0] op_sel_hi:[0,1]
  v_pk_mul_f32 v[204:205], v[128:129], v[138:139] op_sel:[0,0] op_sel_hi:[0,1]
  v_pk_mul_f32 v[206:207], v[48:49], v[8:9] op_sel:[0,0] op_sel_hi:[0,1]
  v_pk_mul_f32 v[208:209], v[130:131], v[138:139] op_sel:[0,0] op_sel_hi:[0,1]
  v_pk_mul_f32 v[210:211], v[50:51], v[8:9] op_sel:[0,0] op_sel_hi:[0,1]
  v_pk_mul_f32 v[212:213], v[132:133], v[138:139] op_sel:[0,0] op_sel_hi:[0,1]
  v_pk_mul_f32 v[214:215], v[52:53], v[8:9] op_sel:[0,0] op_sel_hi:[0,1]
  v_cvt_pk_f16_f32 v17, v154, v155
  ds_write_b32 v232, v17 offset:31008
  v_cvt_pk_f16_f32 v18, v56, v57
  ds_write_b32 v232, v18 offset:4352
  v_cvt_pk_f16_f32 v19, v58, v59
  ds_write_b32 v232, v19 offset:4896
  v_cvt_pk_f16_f32 v16, v140, v141
  ds_write_b32 v232, v16 offset:27200
  v_cvt_pk_f16_f32 v17, v60, v61
  ds_write_b32 v232, v17 offset:5440
  v_cvt_pk_f16_f32 v18, v142, v143
  ds_write_b32 v232, v18 offset:27744
  v_pk_fma_f32 v[62:63], v[46:47], v[8:9], v[202:203] op_sel:[1,1,0] op_sel_hi:[1,0,1] neg_lo:[0,1,0]
  v_pk_fma_f32 v[144:145], v[128:129], v[138:139], v[204:205] op_sel:[1,1,0] op_sel_hi:[1,0,1] neg_lo:[0,1,0]
  v_pk_fma_f32 v[64:65], v[48:49], v[8:9], v[206:207] op_sel:[1,1,0] op_sel_hi:[1,0,1] neg_lo:[0,1,0]
  v_pk_fma_f32 v[146:147], v[130:131], v[138:139], v[208:209] op_sel:[1,1,0] op_sel_hi:[1,0,1] neg_lo:[0,1,0]
  v_pk_fma_f32 v[66:67], v[50:51], v[8:9], v[210:211] op_sel:[1,1,0] op_sel_hi:[1,0,1] neg_lo:[0,1,0]
  v_pk_fma_f32 v[148:149], v[132:133], v[138:139], v[212:213] op_sel:[1,1,0] op_sel_hi:[1,0,1] neg_lo:[0,1,0]
  v_pk_fma_f32 v[68:69], v[52:53], v[8:9], v[214:215] op_sel:[1,1,0] op_sel_hi:[1,0,1] neg_lo:[0,1,0]
  v_pk_mul_f32 v[202:203], v[134:135], v[138:139] op_sel:[0,0] op_sel_hi:[0,1]
  v_pk_mul_f32 v[204:205], v[54:55], v[8:9] op_sel:[0,0] op_sel_hi:[0,1]
  v_pk_mul_f32 v[206:207], v[136:137], v[138:139] op_sel:[0,0] op_sel_hi:[0,1]
  v_cvt_pk_f16_f32 v19, v62, v63
  ds_write_b32 v232, v19 offset:5984
  v_cvt_pk_f16_f32 v16, v144, v145
  ds_write_b32 v232, v16 offset:28288
  v_cvt_pk_f16_f32 v17, v64, v65
  ds_write_b32 v232, v17 offset:6528
  v_cvt_pk_f16_f32 v18, v146, v147
  ds_write_b32 v232, v18 offset:28832
  v_cvt_pk_f16_f32 v19, v66, v67
  ds_write_b32 v232, v19 offset:7072
  v_cvt_pk_f16_f32 v16, v148, v149
  ds_write_b32 v232, v16 offset:29376
  v_cvt_pk_f16_f32 v17, v68, v69
  ds_write_b32 v232, v17 offset:7616
  v_pk_fma_f32 v[150:151], v[134:135], v[138:139], v[202:203] op_sel:[1,1,0] op_sel_hi:[1,0,1] neg_lo:[0,1,0]
  v_pk_fma_f32 v[70:71], v[54:55], v[8:9], v[204:205] op_sel:[1,1,0] op_sel_hi:[1,0,1] neg_lo:[0,1,0]
  v_pk_fma_f32 v[152:153], v[136:137], v[138:139], v[206:207] op_sel:[1,1,0] op_sel_hi:[1,0,1] neg_lo:[0,1,0]
  v_pk_mul_f32 v[202:203], v[10:11], v[10:11] op_sel:[0,0] op_sel_hi:[0,1]
  v_pk_mul_f32 v[204:205], v[154:155], v[154:155] op_sel:[0,0] op_sel_hi:[0,1]
  v_pk_mul_f32 v[206:207], v[40:41], v[10:11] op_sel:[0,0] op_sel_hi:[0,1]
  v_pk_mul_f32 v[208:209], v[44:45], v[10:11] op_sel:[0,0] op_sel_hi:[0,1]
  v_pk_mul_f32 v[210:211], v[126:127], v[154:155] op_sel:[0,0] op_sel_hi:[0,1]
  v_pk_mul_f32 v[212:213], v[48:49], v[10:11] op_sel:[0,0] op_sel_hi:[0,1]
  v_pk_mul_f32 v[214:215], v[130:131], v[154:155] op_sel:[0,0] op_sel_hi:[0,1]
  v_cvt_pk_f16_f32 v18, v150, v151
  ds_write_b32 v232, v18 offset:29920
  v_cvt_pk_f16_f32 v19, v70, v71
  ds_write_b32 v232, v19 offset:8160
  v_cvt_pk_f16_f32 v16, v152, v153
  ds_write_b32 v232, v16 offset:30464
  v_pk_fma_f32 v[12:13], v[10:11], v[10:11], v[202:203] op_sel:[1,1,0] op_sel_hi:[1,0,1] neg_lo:[0,1,0]
  v_pk_fma_f32 v[170:171], v[154:155], v[154:155], v[204:205] op_sel:[1,1,0] op_sel_hi:[1,0,1] neg_lo:[0,1,0]
  v_pk_fma_f32 v[72:73], v[40:41], v[10:11], v[206:207] op_sel:[1,1,0] op_sel_hi:[1,0,1] neg_lo:[0,1,0]
  v_pk_fma_f32 v[74:75], v[44:45], v[10:11], v[208:209] op_sel:[1,1,0] op_sel_hi:[1,0,1] neg_lo:[0,1,0]
  v_pk_fma_f32 v[156:157], v[126:127], v[154:155], v[210:211] op_sel:[1,1,0] op_sel_hi:[1,0,1] neg_lo:[0,1,0]
  v_pk_fma_f32 v[76:77], v[48:49], v[10:11], v[212:213] op_sel:[1,1,0] op_sel_hi:[1,0,1] neg_lo:[0,1,0]
  v_pk_fma_f32 v[158:159], v[130:131], v[154:155], v[214:215] op_sel:[1,1,0] op_sel_hi:[1,0,1] neg_lo:[0,1,0]
  v_pk_mul_f32 v[202:203], v[52:53], v[10:11] op_sel:[0,0] op_sel_hi:[0,1]
  v_pk_mul_f32 v[204:205], v[134:135], v[154:155] op_sel:[0,0] op_sel_hi:[0,1]
  v_pk_mul_f32 v[206:207], v[56:57], v[10:11] op_sel:[0,0] op_sel_hi:[0,1]
  v_pk_mul_f32 v[208:209], v[138:139], v[154:155] op_sel:[0,0] op_sel_hi:[0,1]
  v_pk_mul_f32 v[210:211], v[60:61], v[10:11] op_sel:[0,0] op_sel_hi:[0,1]
  v_pk_mul_f32 v[212:213], v[142:143], v[154:155] op_sel:[0,0] op_sel_hi:[0,1]
  v_pk_mul_f32 v[214:215], v[64:65], v[10:11] op_sel:[0,0] op_sel_hi:[0,1]
  v_cvt_pk_f16_f32 v17, v170, v171
  ds_write_b32 v232, v17 offset:35360
  v_cvt_pk_f16_f32 v18, v72, v73
  ds_write_b32 v232, v18 offset:8704
  v_cvt_pk_f16_f32 v19, v74, v75
  ds_write_b32 v232, v19 offset:9248
  v_cvt_pk_f16_f32 v16, v156, v157
  ds_write_b32 v232, v16 offset:31552
  v_cvt_pk_f16_f32 v17, v76, v77
  ds_write_b32 v232, v17 offset:9792
  v_cvt_pk_f16_f32 v18, v158, v159
  ds_write_b32 v232, v18 offset:32096
  v_pk_fma_f32 v[78:79], v[52:53], v[10:11], v[202:203] op_sel:[1,1,0] op_sel_hi:[1,0,1] neg_lo:[0,1,0]
  v_pk_fma_f32 v[160:161], v[134:135], v[154:155], v[204:205] op_sel:[1,1,0] op_sel_hi:[1,0,1] neg_lo:[0,1,0]
  v_pk_fma_f32 v[80:81], v[56:57], v[10:11], v[206:207] op_sel:[1,1,0] op_sel_hi:[1,0,1] neg_lo:[0,1,0]
  v_pk_fma_f32 v[162:163], v[138:139], v[154:155], v[208:209] op_sel:[1,1,0] op_sel_hi:[1,0,1] neg_lo:[0,1,0]
  v_pk_fma_f32 v[82:83], v[60:61], v[10:11], v[210:211] op_sel:[1,1,0] op_sel_hi:[1,0,1] neg_lo:[0,1,0]
  v_pk_fma_f32 v[164:165], v[142:143], v[154:155], v[212:213] op_sel:[1,1,0] op_sel_hi:[1,0,1] neg_lo:[0,1,0]
  v_pk_fma_f32 v[84:85], v[64:65], v[10:11], v[214:215] op_sel:[1,1,0] op_sel_hi:[1,0,1] neg_lo:[0,1,0]
  v_pk_mul_f32 v[202:203], v[146:147], v[154:155] op_sel:[0,0] op_sel_hi:[0,1]
  v_pk_mul_f32 v[204:205], v[68:69], v[10:11] op_sel:[0,0] op_sel_hi:[0,1]
  v_pk_mul_f32 v[206:207], v[150:151], v[154:155] op_sel:[0,0] op_sel_hi:[0,1]
  v_cvt_pk_f16_f32 v19, v78, v79
  ds_write_b32 v232, v19 offset:10336
  v_cvt_pk_f16_f32 v16, v160, v161
  ds_write_b32 v232, v16 offset:32640
  v_cvt_pk_f16_f32 v17, v80, v81
  ds_write_b32 v232, v17 offset:10880
  v_cvt_pk_f16_f32 v18, v162, v163
  ds_write_b32 v232, v18 offset:33184
  v_cvt_pk_f16_f32 v19, v82, v83
  ds_write_b32 v232, v19 offset:11424
  v_cvt_pk_f16_f32 v16, v164, v165
  ds_write_b32 v232, v16 offset:33728
  v_cvt_pk_f16_f32 v17, v84, v85
  ds_write_b32 v232, v17 offset:11968
  v_pk_fma_f32 v[166:167], v[146:147], v[154:155], v[202:203] op_sel:[1,1,0] op_sel_hi:[1,0,1] neg_lo:[0,1,0]
  v_pk_fma_f32 v[86:87], v[68:69], v[10:11], v[204:205] op_sel:[1,1,0] op_sel_hi:[1,0,1] neg_lo:[0,1,0]
  v_pk_fma_f32 v[168:169], v[150:151], v[154:155], v[206:207] op_sel:[1,1,0] op_sel_hi:[1,0,1] neg_lo:[0,1,0]
  v_pk_mul_f32 v[202:203], v[12:13], v[12:13] op_sel:[0,0] op_sel_hi:[0,1]
  v_pk_mul_f32 v[204:205], v[170:171], v[170:171] op_sel:[0,0] op_sel_hi:[0,1]
  v_pk_mul_f32 v[206:207], v[40:41], v[12:13] op_sel:[0,0] op_sel_hi:[0,1]
  v_pk_mul_f32 v[208:209], v[48:49], v[12:13] op_sel:[0,0] op_sel_hi:[0,1]
  v_pk_mul_f32 v[210:211], v[130:131], v[170:171] op_sel:[0,0] op_sel_hi:[0,1]
  v_pk_mul_f32 v[212:213], v[56:57], v[12:13] op_sel:[0,0] op_sel_hi:[0,1]
  v_pk_mul_f32 v[214:215], v[138:139], v[170:171] op_sel:[0,0] op_sel_hi:[0,1]
  v_cvt_pk_f16_f32 v18, v166, v167
  ds_write_b32 v232, v18 offset:34272
  v_cvt_pk_f16_f32 v19, v86, v87
  ds_write_b32 v232, v19 offset:12512
  v_cvt_pk_f16_f32 v16, v168, v169
  ds_write_b32 v232, v16 offset:34816
  v_pk_fma_f32 v[14:15], v[12:13], v[12:13], v[202:203] op_sel:[1,1,0] op_sel_hi:[1,0,1] neg_lo:[0,1,0]
  v_pk_fma_f32 v[186:187], v[170:171], v[170:171], v[204:205] op_sel:[1,1,0] op_sel_hi:[1,0,1] neg_lo:[0,1,0]
  v_pk_fma_f32 v[88:89], v[40:41], v[12:13], v[206:207] op_sel:[1,1,0] op_sel_hi:[1,0,1] neg_lo:[0,1,0]
  v_pk_fma_f32 v[90:91], v[48:49], v[12:13], v[208:209] op_sel:[1,1,0] op_sel_hi:[1,0,1] neg_lo:[0,1,0]
  v_pk_fma_f32 v[172:173], v[130:131], v[170:171], v[210:211] op_sel:[1,1,0] op_sel_hi:[1,0,1] neg_lo:[0,1,0]
  v_pk_fma_f32 v[92:93], v[56:57], v[12:13], v[212:213] op_sel:[1,1,0] op_sel_hi:[1,0,1] neg_lo:[0,1,0]
  v_pk_fma_f32 v[174:175], v[138:139], v[170:171], v[214:215] op_sel:[1,1,0] op_sel_hi:[1,0,1] neg_lo:[0,1,0]
  v_pk_mul_f32 v[202:203], v[64:65], v[12:13] op_sel:[0,0] op_sel_hi:[0,1]
  v_pk_mul_f32 v[204:205], v[146:147], v[170:171] op_sel:[0,0] op_sel_hi:[0,1]
  v_pk_mul_f32 v[206:207], v[72:73], v[12:13] op_sel:[0,0] op_sel_hi:[0,1]
  v_pk_mul_f32 v[208:209], v[154:155], v[170:171] op_sel:[0,0] op_sel_hi:[0,1]
  v_pk_mul_f32 v[210:211], v[76:77], v[12:13] op_sel:[0,0] op_sel_hi:[0,1]
  v_pk_mul_f32 v[212:213], v[158:159], v[170:171] op_sel:[0,0] op_sel_hi:[0,1]
  v_pk_mul_f32 v[214:215], v[80:81], v[12:13] op_sel:[0,0] op_sel_hi:[0,1]
  v_cvt_pk_f16_f32 v17, v186, v187
  ds_write_b32 v232, v17 offset:39712
  v_cvt_pk_f16_f32 v18, v88, v89
  ds_write_b32 v232, v18 offset:13056
  v_cvt_pk_f16_f32 v19, v90, v91
  ds_write_b32 v232, v19 offset:13600
  v_cvt_pk_f16_f32 v16, v172, v173
  ds_write_b32 v232, v16 offset:35904
  v_cvt_pk_f16_f32 v17, v92, v93
  ds_write_b32 v232, v17 offset:14144
  v_cvt_pk_f16_f32 v18, v174, v175
  ds_write_b32 v232, v18 offset:36448
  v_pk_fma_f32 v[94:95], v[64:65], v[12:13], v[202:203] op_sel:[1,1,0] op_sel_hi:[1,0,1] neg_lo:[0,1,0]
  v_pk_fma_f32 v[176:177], v[146:147], v[170:171], v[204:205] op_sel:[1,1,0] op_sel_hi:[1,0,1] neg_lo:[0,1,0]
  v_pk_fma_f32 v[96:97], v[72:73], v[12:13], v[206:207] op_sel:[1,1,0] op_sel_hi:[1,0,1] neg_lo:[0,1,0]
  v_pk_fma_f32 v[178:179], v[154:155], v[170:171], v[208:209] op_sel:[1,1,0] op_sel_hi:[1,0,1] neg_lo:[0,1,0]
  v_pk_fma_f32 v[98:99], v[76:77], v[12:13], v[210:211] op_sel:[1,1,0] op_sel_hi:[1,0,1] neg_lo:[0,1,0]
  v_pk_fma_f32 v[180:181], v[158:159], v[170:171], v[212:213] op_sel:[1,1,0] op_sel_hi:[1,0,1] neg_lo:[0,1,0]
  v_pk_fma_f32 v[100:101], v[80:81], v[12:13], v[214:215] op_sel:[1,1,0] op_sel_hi:[1,0,1] neg_lo:[0,1,0]
  v_pk_mul_f32 v[202:203], v[162:163], v[170:171] op_sel:[0,0] op_sel_hi:[0,1]
  v_pk_mul_f32 v[204:205], v[84:85], v[12:13] op_sel:[0,0] op_sel_hi:[0,1]
  v_pk_mul_f32 v[206:207], v[166:167], v[170:171] op_sel:[0,0] op_sel_hi:[0,1]
  v_cvt_pk_f16_f32 v19, v94, v95
  ds_write_b32 v232, v19 offset:14688
  v_cvt_pk_f16_f32 v16, v176, v177
  ds_write_b32 v232, v16 offset:36992
  v_cvt_pk_f16_f32 v17, v96, v97
  ds_write_b32 v232, v17 offset:15232
  v_cvt_pk_f16_f32 v18, v178, v179
  ds_write_b32 v232, v18 offset:37536
  v_cvt_pk_f16_f32 v19, v98, v99
  ds_write_b32 v232, v19 offset:15776
  v_cvt_pk_f16_f32 v16, v180, v181
  ds_write_b32 v232, v16 offset:38080
  v_cvt_pk_f16_f32 v17, v100, v101
  ds_write_b32 v232, v17 offset:16320
  v_pk_fma_f32 v[182:183], v[162:163], v[170:171], v[202:203] op_sel:[1,1,0] op_sel_hi:[1,0,1] neg_lo:[0,1,0]
  v_pk_fma_f32 v[102:103], v[84:85], v[12:13], v[204:205] op_sel:[1,1,0] op_sel_hi:[1,0,1] neg_lo:[0,1,0]
  v_pk_fma_f32 v[184:185], v[166:167], v[170:171], v[206:207] op_sel:[1,1,0] op_sel_hi:[1,0,1] neg_lo:[0,1,0]
  v_pk_mul_f32 v[202:203], v[40:41], v[14:15] op_sel:[0,0] op_sel_hi:[0,1]
  v_pk_mul_f32 v[204:205], v[56:57], v[14:15] op_sel:[0,0] op_sel_hi:[0,1]
  v_pk_mul_f32 v[206:207], v[138:139], v[186:187] op_sel:[0,0] op_sel_hi:[0,1]
  v_pk_mul_f32 v[208:209], v[72:73], v[14:15] op_sel:[0,0] op_sel_hi:[0,1]
  v_pk_mul_f32 v[210:211], v[154:155], v[186:187] op_sel:[0,0] op_sel_hi:[0,1]
  v_pk_mul_f32 v[212:213], v[80:81], v[14:15] op_sel:[0,0] op_sel_hi:[0,1]
  v_pk_mul_f32 v[214:215], v[162:163], v[186:187] op_sel:[0,0] op_sel_hi:[0,1]
  v_cvt_pk_f16_f32 v18, v182, v183
  ds_write_b32 v232, v18 offset:38624
  v_cvt_pk_f16_f32 v19, v102, v103
  ds_write_b32 v232, v19 offset:16864
  v_cvt_pk_f16_f32 v16, v184, v185
  ds_write_b32 v232, v16 offset:39168
  v_pk_fma_f32 v[104:105], v[40:41], v[14:15], v[202:203] op_sel:[1,1,0] op_sel_hi:[1,0,1] neg_lo:[0,1,0]
  v_pk_fma_f32 v[106:107], v[56:57], v[14:15], v[204:205] op_sel:[1,1,0] op_sel_hi:[1,0,1] neg_lo:[0,1,0]
  v_pk_fma_f32 v[188:189], v[138:139], v[186:187], v[206:207] op_sel:[1,1,0] op_sel_hi:[1,0,1] neg_lo:[0,1,0]
  v_pk_fma_f32 v[108:109], v[72:73], v[14:15], v[208:209] op_sel:[1,1,0] op_sel_hi:[1,0,1] neg_lo:[0,1,0]
  v_pk_fma_f32 v[190:191], v[154:155], v[186:187], v[210:211] op_sel:[1,1,0] op_sel_hi:[1,0,1] neg_lo:[0,1,0]
  v_pk_fma_f32 v[110:111], v[80:81], v[14:15], v[212:213] op_sel:[1,1,0] op_sel_hi:[1,0,1] neg_lo:[0,1,0]
  v_pk_fma_f32 v[192:193], v[162:163], v[186:187], v[214:215] op_sel:[1,1,0] op_sel_hi:[1,0,1] neg_lo:[0,1,0]
  v_pk_mul_f32 v[202:203], v[88:89], v[14:15] op_sel:[0,0] op_sel_hi:[0,1]
  v_pk_mul_f32 v[204:205], v[170:171], v[186:187] op_sel:[0,0] op_sel_hi:[0,1]
  v_pk_mul_f32 v[206:207], v[92:93], v[14:15] op_sel:[0,0] op_sel_hi:[0,1]
  v_pk_mul_f32 v[208:209], v[174:175], v[186:187] op_sel:[0,0] op_sel_hi:[0,1]
  v_pk_mul_f32 v[210:211], v[96:97], v[14:15] op_sel:[0,0] op_sel_hi:[0,1]
  v_pk_mul_f32 v[212:213], v[178:179], v[186:187] op_sel:[0,0] op_sel_hi:[0,1]
  v_pk_mul_f32 v[214:215], v[100:101], v[14:15] op_sel:[0,0] op_sel_hi:[0,1]
  v_cvt_pk_f16_f32 v17, v104, v105
  ds_write_b32 v232, v17 offset:17408
  v_cvt_pk_f16_f32 v18, v106, v107
  ds_write_b32 v232, v18 offset:17952
  v_cvt_pk_f16_f32 v19, v188, v189
  ds_write_b32 v232, v19 offset:40256
  v_cvt_pk_f16_f32 v16, v108, v109
  ds_write_b32 v232, v16 offset:18496
  v_cvt_pk_f16_f32 v17, v190, v191
  ds_write_b32 v232, v17 offset:40800
  v_cvt_pk_f16_f32 v18, v110, v111
  ds_write_b32 v232, v18 offset:19040
  v_cvt_pk_f16_f32 v19, v192, v193
  ds_write_b32 v232, v19 offset:41344
  v_pk_fma_f32 v[112:113], v[88:89], v[14:15], v[202:203] op_sel:[1,1,0] op_sel_hi:[1,0,1] neg_lo:[0,1,0]
  v_pk_fma_f32 v[194:195], v[170:171], v[186:187], v[204:205] op_sel:[1,1,0] op_sel_hi:[1,0,1] neg_lo:[0,1,0]
  v_pk_fma_f32 v[114:115], v[92:93], v[14:15], v[206:207] op_sel:[1,1,0] op_sel_hi:[1,0,1] neg_lo:[0,1,0]
  v_pk_fma_f32 v[196:197], v[174:175], v[186:187], v[208:209] op_sel:[1,1,0] op_sel_hi:[1,0,1] neg_lo:[0,1,0]
  v_pk_fma_f32 v[116:117], v[96:97], v[14:15], v[210:211] op_sel:[1,1,0] op_sel_hi:[1,0,1] neg_lo:[0,1,0]
  v_pk_fma_f32 v[198:199], v[178:179], v[186:187], v[212:213] op_sel:[1,1,0] op_sel_hi:[1,0,1] neg_lo:[0,1,0]
  v_pk_fma_f32 v[118:119], v[100:101], v[14:15], v[214:215] op_sel:[1,1,0] op_sel_hi:[1,0,1] neg_lo:[0,1,0]
  v_pk_mul_f32 v[202:203], v[182:183], v[186:187] op_sel:[0,0] op_sel_hi:[0,1]
  v_cvt_pk_f16_f32 v16, v112, v113
  ds_write_b32 v232, v16 offset:19584
  v_cvt_pk_f16_f32 v17, v194, v195
  ds_write_b32 v232, v17 offset:41888
  v_cvt_pk_f16_f32 v18, v114, v115
  ds_write_b32 v232, v18 offset:20128
  v_cvt_pk_f16_f32 v19, v196, v197
  ds_write_b32 v232, v19 offset:42432
  v_cvt_pk_f16_f32 v16, v116, v117
  ds_write_b32 v232, v16 offset:20672
  v_cvt_pk_f16_f32 v17, v198, v199
  ds_write_b32 v232, v17 offset:42976
  v_cvt_pk_f16_f32 v18, v118, v119
  ds_write_b32 v232, v18 offset:21216
  v_pk_fma_f32 v[200:201], v[182:183], v[186:187], v[202:203] op_sel:[1,1,0] op_sel_hi:[1,0,1] neg_lo:[0,1,0]
  v_pk_mul_f32 v[202:203], v[104:105], v[14:15] op_sel:[0,0] op_sel_hi:[0,1]
  v_pk_fma_f32 v[120:121], v[104:105], v[14:15], v[202:203] op_sel:[1,1,0] op_sel_hi:[1,0,1] neg_lo:[0,1,0]
  v_cvt_pk_f16_f32 v19, v200, v201
  ds_write_b32 v232, v19 offset:43520
  v_cvt_pk_f16_f32 v16, v120, v121
  ds_write_b32 v232, v16 offset:21760
  v_and_b32 v2, 15, v1
  v_lshrrev_b32 v3, 4, v1
  v_lshlrev_b32 v4, 4, v3
  v_add_u32 v4, s66, v4
  s_cmp_eq_u32 s65, 0
  s_cselect_b32 s47, 0, 24
  s_cselect_b32 s48, 16, 32
  s_lshl_b32 s49, s65, 1
  s_add_u32 s50, s49, 1
  s_mov_b32 s51, 544

  v_add_u32 v6, s47, v2
  v_mad_u32_u24 v6, v6, s51, v4
  v_lshlrev_b32 v10, s49, v2
  v_max_u32 v11, 1, v10
  v_ffbh_u32 v11, v11
  v_sub_u32 v11, 28, v11
  v_max_i32 v11, 0, v11
  v_lshrrev_b32 v10, v11, v10
  v_lshl_add_u32 v10, v11, 3, v10
  v_add_u32 v10, 41, v10
  v_mad_u32_u24 v7, v10, s51, v4

  v_add_u32 v8, s48, v2
  v_mad_u32_u24 v8, v8, s51, v4
  v_lshlrev_b32 v10, s50, v2
  v_max_u32 v11, 1, v10
  v_ffbh_u32 v11, v11
  v_sub_u32 v11, 28, v11
  v_max_i32 v11, 0, v11
  v_lshrrev_b32 v10, v11, v10
  v_lshl_add_u32 v10, v11, 3, v10
  v_add_u32 v10, 41, v10
  v_mad_u32_u24 v9, v10, s51, v4

  s_lshl_b32 s46, s34, 10
  s_add_u32 s46, s46, 104512
  v_lshlrev_b32 v235, 7, v3
  v_lshl_add_u32 v235, v2, 1, v235
  v_add_u32 v235, s46, v235
  s_waitcnt vmcnt(0) lgkmcnt(0)

  s_barrier
  s_add_u32 s90, s32, 31457280
  s_addc_u32 s91, s33, 0
  s_and_b32 s92, s2, 15
  s_mul_i32 s92, s92, 256
  s_cmp_lg_u32 s34, 0
  s_cbranch_scc1 arr_skip_0
  v_mov_b32 v30, s92
  v_mov_b32 v31, 1
  s_mov_b64 exec, 1

  s_mov_b32 s93, 200000
  v_mov_b32 v32, 0
  v_cmp_ne_u32 vcc, 1, v247
  s_cbranch_vccz zf_done
zf_poll:
  global_load_dword v33, v32, s[30:31] sc1
  s_waitcnt vmcnt(0)
  v_cmp_ne_u32 vcc, 1, v33
  s_cbranch_vccz zf_done
  s_sub_u32 s93, s93, 1
  s_cbranch_scc0 zf_poll

zf_done:
  global_atomic_add v30, v31, s[90:91] sc1

  s_mov_b64 exec, -1
arr_skip_0:
  ds_read_b128 v[40:43], v6 offset:0
  ds_read_b128 v[44:47], v7 offset:0
  ds_read_b128 v[104:107], v8 offset:0
  ds_read_b128 v[108:111], v9 offset:0
  ds_read_b128 v[48:51], v6 offset:64
  ds_read_b128 v[52:55], v7 offset:64
  ds_read_b128 v[112:115], v8 offset:64
  ds_read_b128 v[116:119], v9 offset:64
  ds_read_b128 v[56:59], v6 offset:128
  ds_read_b128 v[60:63], v7 offset:128
  ds_read_b128 v[120:123], v8 offset:128
  ds_read_b128 v[124:127], v9 offset:128
  s_waitcnt lgkmcnt(8)
  v_mfma_f32_16x16x32_f16 v[16:19], v[40:43], v[44:47], 0
  v_mfma_f32_16x16x32_f16 v[20:23], v[104:107], v[108:111], 0
  ds_read_b128 v[64:67], v6 offset:192
  ds_read_b128 v[68:71], v7 offset:192
  ds_read_b128 v[128:131], v8 offset:192
  ds_read_b128 v[132:135], v9 offset:192
  s_waitcnt lgkmcnt(8)
  v_mfma_f32_16x16x32_f16 v[16:19], v[48:51], v[52:55], v[16:19]
  v_mfma_f32_16x16x32_f16 v[20:23], v[112:115], v[116:119], v[20:23]
  ds_read_b128 v[72:75], v6 offset:256
  ds_read_b128 v[76:79], v7 offset:256
  ds_read_b128 v[136:139], v8 offset:256
  ds_read_b128 v[140:143], v9 offset:256
  s_waitcnt lgkmcnt(8)
  v_mfma_f32_16x16x32_f16 v[16:19], v[56:59], v[60:63], v[16:19]
  v_mfma_f32_16x16x32_f16 v[20:23], v[120:123], v[124:127], v[20:23]
  ds_read_b128 v[80:83], v6 offset:320
  ds_read_b128 v[84:87], v7 offset:320
  ds_read_b128 v[144:147], v8 offset:320
  ds_read_b128 v[148:151], v9 offset:320
  s_waitcnt lgkmcnt(8)
  v_mfma_f32_16x16x32_f16 v[16:19], v[64:67], v[68:71], v[16:19]
  v_mfma_f32_16x16x32_f16 v[20:23], v[128:131], v[132:135], v[20:23]
  ds_read_b128 v[88:91], v6 offset:384
  ds_read_b128 v[92:95], v7 offset:384
  ds_read_b128 v[152:155], v8 offset:384
  ds_read_b128 v[156:159], v9 offset:384
  s_waitcnt lgkmcnt(8)
  v_mfma_f32_16x16x32_f16 v[16:19], v[72:75], v[76:79], v[16:19]
  v_mfma_f32_16x16x32_f16 v[20:23], v[136:139], v[140:143], v[20:23]
  ds_read_b128 v[96:99], v6 offset:448
  ds_read_b128 v[100:103], v7 offset:448
  ds_read_b128 v[160:163], v8 offset:448
  ds_read_b128 v[164:167], v9 offset:448
  s_waitcnt lgkmcnt(8)
  v_mfma_f32_16x16x32_f16 v[16:19], v[80:83], v[84:87], v[16:19]
  v_mfma_f32_16x16x32_f16 v[20:23], v[144:147], v[148:151], v[20:23]
  s_waitcnt lgkmcnt(4)
  v_mfma_f32_16x16x32_f16 v[16:19], v[88:91], v[92:95], v[16:19]
  v_mfma_f32_16x16x32_f16 v[20:23], v[152:155], v[156:159], v[20:23]
  s_waitcnt lgkmcnt(0)
  v_mfma_f32_16x16x32_f16 v[16:19], v[96:99], v[100:103], v[16:19]
  v_mfma_f32_16x16x32_f16 v[20:23], v[160:163], v[164:167], v[20:23]
  v_lshlrev_b32 v10, 3, v0
  v_sub_u32 v10, 2047, v10
  s_mov_b32 s46, 104000

  v_subrev_u32 v12, 0, v10
  v_max_i32 v12, 0, v12
  v_cvt_f32_u32 v13, v12
  v_cvt_pk_bf16_f32 v13, v13, v13
  v_and_b32 v13, 0xffff, v13
  v_subrev_u32 v236, 17024, v13
  v_cmp_gt_u32 vcc, 128, v12
  v_cndmask_b32 v236, v236, v12, vcc
  v_lshrrev_b32 v14, 7, v236
  v_med3_u32 v14, v14, 2, 4
  v_lshl_add_u32 v236, v14, 7, v236
  v_lshl_add_u32 v236, v236, 1, s46

  v_cvt_f16_f32 v24, v16
  v_cvt_f16_f32 v25, v17
  v_cvt_f16_f32 v26, v18
  v_cvt_f16_f32 v27, v19
  v_cvt_f16_f32 v28, v20
  v_cvt_f16_f32 v29, v21
  v_cvt_f16_f32 v30, v22
  v_cvt_f16_f32 v31, v23
  ds_write_b16 v235, v24 offset:0
  ds_write_b16 v235, v25 offset:32
  ds_write_b16 v235, v26 offset:64
  ds_write_b16 v235, v27 offset:96
  ds_write_b16 v235, v28 offset:512
  ds_write_b16 v235, v29 offset:544
  ds_write_b16 v235, v30 offset:576
  ds_write_b16 v235, v31 offset:608
  v_subrev_u32 v12, 1, v10
  v_max_i32 v12, 0, v12
  v_cvt_f32_u32 v13, v12
  v_cvt_pk_bf16_f32 v13, v13, v13
  v_and_b32 v13, 0xffff, v13
  v_subrev_u32 v237, 17024, v13
  v_cmp_gt_u32 vcc, 128, v12
  v_cndmask_b32 v237, v237, v12, vcc
  v_lshrrev_b32 v14, 7, v237
  v_med3_u32 v14, v14, 2, 4
  v_lshl_add_u32 v237, v14, 7, v237
  v_lshl_add_u32 v237, v237, 1, s46

  v_subrev_u32 v12, 2, v10
  v_max_i32 v12, 0, v12
  v_cvt_f32_u32 v13, v12
  v_cvt_pk_bf16_f32 v13, v13, v13
  v_and_b32 v13, 0xffff, v13
  v_subrev_u32 v238, 17024, v13
  v_cmp_gt_u32 vcc, 128, v12
  v_cndmask_b32 v238, v238, v12, vcc
  v_lshrrev_b32 v14, 7, v238
  v_med3_u32 v14, v14, 2, 4
  v_lshl_add_u32 v238, v14, 7, v238
  v_lshl_add_u32 v238, v238, 1, s46

  v_subrev_u32 v12, 3, v10
  v_max_i32 v12, 0, v12
  v_cvt_f32_u32 v13, v12
  v_cvt_pk_bf16_f32 v13, v13, v13
  v_and_b32 v13, 0xffff, v13
  v_subrev_u32 v239, 17024, v13
  v_cmp_gt_u32 vcc, 128, v12
  v_cndmask_b32 v239, v239, v12, vcc
  v_lshrrev_b32 v14, 7, v239
  v_med3_u32 v14, v14, 2, 4
  v_lshl_add_u32 v239, v14, 7, v239
  v_lshl_add_u32 v239, v239, 1, s46

  v_subrev_u32 v12, 4, v10
  v_max_i32 v12, 0, v12
  v_cvt_f32_u32 v13, v12
  v_cvt_pk_bf16_f32 v13, v13, v13
  v_and_b32 v13, 0xffff, v13
  v_subrev_u32 v240, 17024, v13
  v_cmp_gt_u32 vcc, 128, v12
  v_cndmask_b32 v240, v240, v12, vcc
  v_lshrrev_b32 v14, 7, v240
  v_med3_u32 v14, v14, 2, 4
  v_lshl_add_u32 v240, v14, 7, v240
  v_lshl_add_u32 v240, v240, 1, s46

  v_subrev_u32 v12, 5, v10
  v_max_i32 v12, 0, v12
  v_cvt_f32_u32 v13, v12
  v_cvt_pk_bf16_f32 v13, v13, v13
  v_and_b32 v13, 0xffff, v13
  v_subrev_u32 v241, 17024, v13
  v_cmp_gt_u32 vcc, 128, v12
  v_cndmask_b32 v241, v241, v12, vcc
  v_lshrrev_b32 v14, 7, v241
  v_med3_u32 v14, v14, 2, 4
  v_lshl_add_u32 v241, v14, 7, v241
  v_lshl_add_u32 v241, v241, 1, s46

  v_subrev_u32 v12, 6, v10
  v_max_i32 v12, 0, v12
  v_cvt_f32_u32 v13, v12
  v_cvt_pk_bf16_f32 v13, v13, v13
  v_and_b32 v13, 0xffff, v13
  v_subrev_u32 v242, 17024, v13
  v_cmp_gt_u32 vcc, 128, v12
  v_cndmask_b32 v242, v242, v12, vcc
  v_lshrrev_b32 v14, 7, v242
  v_med3_u32 v14, v14, 2, 4
  v_lshl_add_u32 v242, v14, 7, v242
  v_lshl_add_u32 v242, v242, 1, s46

  v_subrev_u32 v12, 7, v10
  v_max_i32 v12, 0, v12
  v_cvt_f32_u32 v13, v12
  v_cvt_pk_bf16_f32 v13, v13, v13
  v_and_b32 v13, 0xffff, v13
  v_subrev_u32 v243, 17024, v13
  v_cmp_gt_u32 vcc, 128, v12
  v_cndmask_b32 v243, v243, v12, vcc
  v_lshrrev_b32 v14, 7, v243
  v_med3_u32 v14, v14, 2, 4
  v_lshl_add_u32 v243, v14, 7, v243
  v_lshl_add_u32 v243, v243, 1, s46

  v_subrev_u32 v12, 8, v10
  v_max_i32 v12, 0, v12
  v_cvt_f32_u32 v13, v12
  v_cvt_pk_bf16_f32 v13, v13, v13
  v_and_b32 v13, 0xffff, v13
  v_subrev_u32 v244, 17024, v13
  v_cmp_gt_u32 vcc, 128, v12
  v_cndmask_b32 v244, v244, v12, vcc
  v_lshrrev_b32 v14, 7, v244
  v_med3_u32 v14, v14, 2, 4
  v_lshl_add_u32 v244, v14, 7, v244
  v_lshl_add_u32 v244, v244, 1, s46

  v_subrev_u32 v12, 9, v10
  v_max_i32 v12, 0, v12
  v_cvt_f32_u32 v13, v12
  v_cvt_pk_bf16_f32 v13, v13, v13
  v_and_b32 v13, 0xffff, v13
  v_subrev_u32 v245, 17024, v13
  v_cmp_gt_u32 vcc, 128, v12
  v_cndmask_b32 v245, v245, v12, vcc
  v_lshrrev_b32 v14, 7, v245
  v_med3_u32 v14, v14, 2, 4
  v_lshl_add_u32 v245, v14, 7, v245
  v_lshl_add_u32 v245, v245, 1, s46

  v_subrev_u32 v12, 10, v10
  v_max_i32 v12, 0, v12
  v_cvt_f32_u32 v13, v12
  v_cvt_pk_bf16_f32 v13, v13, v13
  v_and_b32 v13, 0xffff, v13
  v_subrev_u32 v246, 17024, v13
  v_cmp_gt_u32 vcc, 128, v12
  v_cndmask_b32 v246, v246, v12, vcc
  v_lshrrev_b32 v14, 7, v246
  v_med3_u32 v14, v14, 2, 4
  v_lshl_add_u32 v246, v14, 7, v246
  v_lshl_add_u32 v246, v246, 1, s46

  s_waitcnt lgkmcnt(0)
  s_barrier
  ds_read_u16 v40, v236 offset:0
  ds_read_u16 v41, v237 offset:0
  ds_read_u16 v42, v238 offset:0
  ds_read_u16 v43, v239 offset:0
  ds_read_u16 v44, v240 offset:0
  ds_read_u16 v45, v241 offset:0
  ds_read_u16 v46, v242 offset:0
  ds_read_u16 v47, v243 offset:0
  ds_read_u16 v48, v244 offset:0
  ds_read_u16 v49, v245 offset:0
  ds_read_u16 v50, v246 offset:0
  ds_read_u16 v52, v236 offset:2048
  ds_read_u16 v53, v237 offset:2048
  ds_read_u16 v54, v238 offset:2048
  ds_read_u16 v55, v239 offset:2048
  ds_read_u16 v56, v240 offset:2048
  ds_read_u16 v57, v241 offset:2048
  ds_read_u16 v58, v242 offset:2048
  ds_read_u16 v59, v243 offset:2048
  ds_read_u16 v60, v244 offset:2048
  ds_read_u16 v61, v245 offset:2048
  ds_read_u16 v62, v246 offset:2048
  s_add_u32 s52, s32, 25165824
  s_addc_u32 s53, s33, 0
  s_mul_i32 s46, s37, 4224
  v_lshlrev_b32 v9, 4, v0
  v_add_u32 v10, s46, v9
  v_add_u32 v11, 4224, v10
  v_add_u32 v9, 114688, v9
  v_mov_b32 v104, 0
  v_mov_b32 v105, 0
  v_mov_b32 v106, 0
  v_mov_b32 v107, 0
  v_add_u32 v12, 4096, v10
  v_add_u32 v13, 4096, v11
  v_cmp_ne_u32 vcc, 255, v0
  s_waitcnt lgkmcnt(0)

  v_cndmask_b32 v48, 0, v48, vcc
  v_cndmask_b32 v49, 0, v49, vcc
  v_cndmask_b32 v50, 0, v50, vcc
  v_cndmask_b32 v60, 0, v60, vcc
  v_cndmask_b32 v61, 0, v61, vcc
  v_cndmask_b32 v62, 0, v62, vcc
  v_lshl_or_b32 v72, v44, 16, v43
  v_lshl_or_b32 v73, v46, 16, v45
  v_lshl_or_b32 v74, v48, 16, v47
  v_lshl_or_b32 v75, v50, 16, v49
  ds_write_b128 v9, v[72:75] offset:0
  v_lshl_or_b32 v76, v43, 16, v42
  v_lshl_or_b32 v77, v45, 16, v44
  v_lshl_or_b32 v78, v47, 16, v46
  v_lshl_or_b32 v79, v49, 16, v48
  ds_write_b128 v9, v[76:79] offset:4160
  v_lshl_or_b32 v80, v42, 16, v41
  v_lshl_or_b32 v81, v44, 16, v43
  v_lshl_or_b32 v82, v46, 16, v45
  v_lshl_or_b32 v83, v48, 16, v47
  ds_write_b128 v9, v[80:83] offset:8320
  v_lshl_or_b32 v84, v41, 16, v40
  v_lshl_or_b32 v85, v43, 16, v42
  v_lshl_or_b32 v86, v45, 16, v44
  v_lshl_or_b32 v87, v47, 16, v46
  ds_write_b128 v9, v[84:87] offset:12480
  v_lshl_or_b32 v88, v56, 16, v55
  v_lshl_or_b32 v89, v58, 16, v57
  v_lshl_or_b32 v90, v60, 16, v59
  v_lshl_or_b32 v91, v62, 16, v61
  ds_write_b128 v9, v[88:91] offset:16640
  v_lshl_or_b32 v92, v55, 16, v54
  v_lshl_or_b32 v93, v57, 16, v56
  v_lshl_or_b32 v94, v59, 16, v58
  v_lshl_or_b32 v95, v61, 16, v60
  ds_write_b128 v9, v[92:95] offset:20800
  v_lshl_or_b32 v96, v54, 16, v53
  v_lshl_or_b32 v97, v56, 16, v55
  v_lshl_or_b32 v98, v58, 16, v57
  v_lshl_or_b32 v99, v60, 16, v59
  ds_write_b128 v9, v[96:99] offset:24960
  v_lshl_or_b32 v100, v53, 16, v52
  v_lshl_or_b32 v101, v55, 16, v54
  v_lshl_or_b32 v102, v57, 16, v56
  v_lshl_or_b32 v103, v59, 16, v58
  ds_write_b128 v9, v[100:103] offset:29120
  global_store_dwordx4 v10, v[84:87], s[52:53]
  global_store_dwordx4 v11, v[100:103], s[52:53]
  v_mul_u32_u24 v2, 4160, v1
  v_add_u32 v2, 118784, v2
  s_cmp_lg_u32 s34, 0
  s_cbranch_scc1 kg_skip_7
  s_mov_b64 exec, 1
  global_store_dwordx4 v12, v[104:107], s[52:53]
  global_store_dwordx4 v13, v[104:107], s[52:53]
  s_mov_b64 exec, 0xff
  ds_write_b128 v2, v[104:107]
  ds_write_b128 v2, v[104:107] offset:16
  s_mov_b64 exec, -1

kg_skip_7:
  s_mul_i32 s64, s34, 7168
  s_mul_i32 s44, s39, 114688
  s_add_u32 s44, s44, s64
  s_add_u32 s44, s44, 33554432
  v_lshlrev_b32 v244, 4, v1
  v_add_u32 v244, s44, v244
  v_add_u32 v245, 4096, v244
  s_add_u32 s64, s64, 0
  s_add_u32 s65, s64, 4096

  s_add_u32 s66, s64, 28672
  s_add_u32 s67, s65, 28672

  s_add_u32 s68, s66, 28672
  s_add_u32 s69, s67, 28672

  s_add_u32 s70, s68, 28672
  s_add_u32 s71, s69, 28672

  s_add_u32 s90, s32, 31457280
  s_addc_u32 s91, s33, 0
  s_cmp_lg_u32 s34, 0
  s_cbranch_scc1 wt_skip_0

  v_mul_u32_u24 v2, 256, v1
  s_mov_b64 exec, 65535
  s_mov_b32 s92, 200000

wt_poll_0:
  global_load_dword v3, v2, s[90:91] sc1
  s_waitcnt vmcnt(0)
  v_cmp_ne_u32 vcc, 16, v3
  s_cbranch_vccz wt_done_0

  s_sleep 12
  s_sub_u32 s92, s92, 1
  s_cbranch_scc0 wt_poll_0

wt_done_0:
  s_mov_b64 exec, -1
wt_skip_0:
  s_waitcnt lgkmcnt(0)
  s_barrier
  s_add_u32 s40, s32, 30408704
  s_addc_u32 s41, s33, 0
  s_mul_i32 s43, s39, 7168
  v_subrev_u32 v5, 128, v0
  v_lshlrev_b32 v2, 2, v5
  v_add_u32 v3, s43, v2
  v_add_u32 v4, 3584, v3
  v_cmp_gt_u32 vcc, 112, v5
  s_and_saveexec_b64 s[46:47], vcc
  s_cbranch_execz csr_8

  global_load_dword v8, v3, s[40:41] offset:0
  global_load_dword v9, v3, s[40:41] offset:448
  global_load_dword v10, v3, s[40:41] offset:896
  global_load_dword v11, v3, s[40:41] offset:1344
  global_load_dword v12, v3, s[40:41] offset:1792
  global_load_dword v13, v3, s[40:41] offset:2240
  global_load_dword v14, v3, s[40:41] offset:2688
  global_load_dword v15, v3, s[40:41] offset:3136
  global_load_dword v16, v4, s[40:41] offset:0
  global_load_dword v17, v4, s[40:41] offset:448
  global_load_dword v18, v4, s[40:41] offset:896
  global_load_dword v19, v4, s[40:41] offset:1344
  global_load_dword v20, v4, s[40:41] offset:1792
  global_load_dword v21, v4, s[40:41] offset:2240
  global_load_dword v22, v4, s[40:41] offset:2688
  global_load_dword v23, v4, s[40:41] offset:3136
  s_mul_i32 s43, s39, 224
  v_lshlrev_b32 v6, 1, v5
  v_add_u32 v6, s43, v6
  global_load_ushort v24, v6, s[22:23]
  s_waitcnt vmcnt(0)

  v_add_f32 v8, v8, v16
  v_add_f32 v9, v9, v17
  v_add_f32 v10, v10, v18
  v_add_f32 v11, v11, v19
  v_add_f32 v12, v12, v20
  v_add_f32 v13, v13, v21
  v_add_f32 v14, v14, v22
  v_add_f32 v15, v15, v23
  v_add_f32 v8, v8, v12
  v_add_f32 v9, v9, v13
  v_add_f32 v10, v10, v14
  v_add_f32 v11, v11, v15
  v_add_f32 v8, v8, v10
  v_add_f32 v9, v9, v11
  v_add_f32 v8, v8, v9
  v_lshlrev_b32 v24, 16, v24
  v_add_u32 v2, 162880, v2
  ds_write_b32 v2, v8 offset:448
  ds_write_b32 v2, v24

csr_8:
  s_mov_b64 exec, s[46:47]
  s_lshl_b32 s59, s37, 12
  s_add_u32 s59, s59, 0
  v_lshlrev_b32 v238, 3, v0
  v_add_u32 v238, s59, v238
  v_lshlrev_b32 v239, 4, v0
  v_add_u32 v239, 29360128, v239
  v_add_u32 v237, 8192, v239

  global_load_dwordx4 v[208:211], v239, s[32:33]
  v_add_u32 v239, 4096, v239
  global_load_dwordx4 v[212:215], v237, s[32:33]
  v_add_u32 v237, 4096, v237
  global_load_dwordx2 v[204:205], v238, s[32:33]
  v_add_u32 v236, 4096, v238
  global_load_dwordx2 v[206:207], v236, s[32:33]
  v_add_u32 v238, 2048, v238
  global_load_dwordx4 v[220:223], v239, s[32:33]
  v_add_u32 v239, 4096, v239
  global_load_dwordx4 v[224:227], v237, s[32:33]
  v_add_u32 v237, 4096, v237
  global_load_dwordx2 v[216:217], v238, s[32:33]
  v_add_u32 v236, 4096, v238
  global_load_dwordx2 v[218:219], v236, s[32:33]
  v_add_u32 v238, 2048, v238
  v_lshlrev_b32 v2, 3, v0
  v_lshlrev_b32 v3, 4, v0
  s_lshr_b32 s41, s34, 1
  s_and_b32 s42, s34, 1
  s_lshl_b32 s43, s37, 2
  s_add_u32 s43, s43, 29491200
  v_mov_b32 v5, s43
  global_load_dwordx2 v[240:241], v5, s[32:33]
  s_lshl_b32 s43, s37, 1
  s_load_dword s52, s[16:17], s43
  v_mov_b32 v8, 0
  v_mov_b32 v9, 0
  v_mov_b32 v10, 0
  v_mov_b32 v11, 0
  v_add_u32 v5, 147968, v3
  v_cmp_gt_u32 vcc, 30, v0
  s_and_saveexec_b64 s[54:55], vcc
  s_cbranch_execz cv_z_0
  ds_write_b128 v5, v[8:11]
  ds_write_b128 v5, v[8:11] offset:4608

cv_z_0:
  s_mov_b64 exec, s[54:55]
  s_mov_b32 s58, 0xffff0000
  v_mov_b32 v12, 0x3b000000
  v_mov_b32 v13, 0x3b000000
  v_mov_b32 v14, 0x3727c5ac
  v_mov_b32 v15, 0x3727c5ac
  v_add_u32 v7, 148448, v2
  v_add_u32 v235, 157184, v2
  v_and_b32 v2, 15, v1
  v_lshrrev_b32 v3, 4, v1
  v_and_b32 v4, 3, v2
  s_lshl_b32 s43, s41, 2
  v_add_u32 v4, s43, v4
  v_mul_u32_u24 v4, 4160, v4
  v_lshrrev_b32 v5, 2, v2
  v_lshlrev_b32 v6, 1, v3
  v_sub_u32 v5, v6, v5
  v_lshl_add_u32 v4, v5, 3, v4
  v_add_u32 v230, 116760, v4
  s_lshl_b32 s43, s42, 8
  s_sub_u32 s43, 115160, s43
  v_add_u32 v4, s43, v4
  v_lshlrev_b32 v5, 5, v2
  v_lshl_add_u32 v5, v3, 4, v5
  s_mul_i32 s43, s41, 4608
  s_add_u32 s43, s43, 147968
  v_add_u32 v231, s43, v5
  s_add_u32 s43, s43, 448
  s_lshl_b32 s53, s42, 8
  s_sub_u32 s43, s43, s53
  v_add_u32 v5, s43, v5
  v_lshlrev_b32 v6, 6, v2
  v_lshl_add_u32 v6, v3, 4, v6
  s_lshl_b32 s43, s34, 12
  s_add_u32 s43, s43, 114688
  v_add_u32 v6, s43, v6
  v_lshlrev_b32 v232, 5, v2
  v_lshl_add_u32 v232, v3, 3, v232
  s_lshl_b32 s43, s41, 11
  s_add_u32 s43, s43, 157184
  v_add_u32 v233, s43, v232
  s_mul_i32 s43, s41, 4608
  s_add_u32 s43, s43, 148448
  v_add_u32 v232, s43, v232
  v_lshrrev_b32 v234, 1, v2
  v_lshlrev_b32 v234, 15, v234
  v_and_b32 v8, 1, v2
  v_lshl_add_u32 v234, v8, 5, v234
  v_lshl_add_u32 v234, v3, 3, v234
  s_add_u32 s43, s37, s41
  s_lshl_b32 s43, s43, 6
  s_add_u32 s43, s43, 2097152
  v_add_u32 v234, s43, v234

  s_waitcnt vmcnt(7)
  v_pk_mul_f32 v[208:209], v[208:209], v[12:13]
  v_pk_mul_f32 v[212:213], v[212:213], v[12:13]
  v_pk_fma_f32 v[212:213], v[208:209], v[208:209], v[212:213] neg_lo:[1,0,0] neg_hi:[1,0,0]
  v_cvt_pk_bf16_f32 v16, v208, v209
  v_max_f32 v212, 0, v212
  v_max_f32 v213, 0, v213
  v_cvt_pk_bf16_f32 v20, v212, v213
  v_lshlrev_b32 v208, 16, v16
  v_and_b32 v209, s58, v16
  v_lshlrev_b32 v212, 16, v20
  v_and_b32 v213, s58, v20
  v_pk_add_f32 v[212:213], v[212:213], v[14:15]

  s_mov_b32 m0, s64
  s_nop 0
  global_load_lds_dwordx4 v244, s[32:33] offset:0
  v_pk_mul_f32 v[210:211], v[210:211], v[12:13]
  v_pk_mul_f32 v[214:215], v[214:215], v[12:13]
  v_pk_fma_f32 v[214:215], v[210:211], v[210:211], v[214:215] neg_lo:[1,0,0] neg_hi:[1,0,0]
  v_cvt_pk_bf16_f32 v17, v210, v211
  v_max_f32 v214, 0, v214
  v_max_f32 v215, 0, v215
  v_cvt_pk_bf16_f32 v21, v214, v215
  v_lshlrev_b32 v210, 16, v17
  v_and_b32 v211, s58, v17
  v_lshlrev_b32 v214, 16, v21
  v_and_b32 v215, s58, v21
  v_pk_add_f32 v[214:215], v[214:215], v[14:15]

  v_cvt_pk_bf16_f32 v20, v212, v213
  s_mov_b32 m0, s64
  s_nop 0
  global_load_lds_dwordx4 v244, s[32:33] offset:1024
  v_lshlrev_b32 v212, 16, v20
  v_and_b32 v213, s58, v20
  v_sqrt_f32 v212, v212
  v_sqrt_f32 v213, v213

  v_cvt_pk_bf16_f32 v21, v214, v215
  v_lshlrev_b32 v214, 16, v21
  v_and_b32 v215, s58, v21
  v_sqrt_f32 v214, v214
  v_sqrt_f32 v215, v215

  s_nop 0
  v_cvt_pk_bf16_f32 v20, v212, v213
  v_lshlrev_b32 v212, 16, v20
  s_mov_b32 m0, s64
  s_nop 0
  global_load_lds_dwordx4 v244, s[32:33] offset:2048
  v_and_b32 v213, s58, v20
  v_rcp_f32 v212, v212
  v_rcp_f32 v213, v213

  v_cvt_pk_bf16_f32 v21, v214, v215
  v_lshlrev_b32 v214, 16, v21
  v_and_b32 v215, s58, v21
  v_rcp_f32 v214, v214
  v_rcp_f32 v215, v215

  s_nop 0
  s_waitcnt vmcnt(8)
  v_lshlrev_b32 v32, 16, v204
  v_and_b32 v33, s58, v204
  s_mov_b32 m0, s64
  s_nop 0
  global_load_lds_dwordx4 v244, s[32:33] offset:3072
  v_pk_add_f32 v[32:33], v[32:33], v[208:209] neg_lo:[0,1] neg_hi:[0,1]
  v_cvt_pk_bf16_f32 v184, v32, v33
  v_lshlrev_b32 v32, 16, v184
  v_and_b32 v33, s58, v184
  v_pk_mul_f32 v[32:33], v[32:33], v[212:213]
  v_cvt_pk_bf16_f32 v184, v32, v33
  v_lshlrev_b32 v32, 16, v184
  v_and_b32 v33, s58, v184
  v_cvt_pk_f16_f32 v24, v32, v33

  v_lshlrev_b32 v34, 16, v205
  v_and_b32 v35, s58, v205
  v_pk_add_f32 v[34:35], v[34:35], v[210:211] neg_lo:[0,1] neg_hi:[0,1]
  v_cvt_pk_bf16_f32 v185, v34, v35
  s_mov_b32 m0, s65
  s_nop 0
  global_load_lds_dwordx4 v245, s[32:33] offset:0
  v_lshlrev_b32 v34, 16, v185
  v_and_b32 v35, s58, v185
  v_pk_mul_f32 v[34:35], v[34:35], v[214:215]
  v_cvt_pk_bf16_f32 v185, v34, v35
  v_lshlrev_b32 v34, 16, v185
  v_and_b32 v35, s58, v185
  v_cvt_pk_f16_f32 v25, v34, v35

  ds_write_b64 v7, v[24:25] offset:0
  ds_write_b64 v235, v[204:205] offset:0
  v_lshlrev_b32 v36, 16, v206
  v_and_b32 v37, s58, v206
  v_pk_add_f32 v[36:37], v[36:37], v[208:209] neg_lo:[0,1] neg_hi:[0,1]
  v_cvt_pk_bf16_f32 v186, v36, v37
  s_mov_b32 m0, s65
  s_nop 0
  global_load_lds_dwordx4 v245, s[32:33] offset:1024
  v_lshlrev_b32 v36, 16, v186
  v_and_b32 v37, s58, v186
  v_pk_mul_f32 v[36:37], v[36:37], v[212:213]
  v_cvt_pk_bf16_f32 v186, v36, v37
  v_lshlrev_b32 v36, 16, v186
  v_and_b32 v37, s58, v186
  v_cvt_pk_f16_f32 v26, v36, v37

  v_lshlrev_b32 v38, 16, v207
  v_and_b32 v39, s58, v207
  v_pk_add_f32 v[38:39], v[38:39], v[210:211] neg_lo:[0,1] neg_hi:[0,1]
  v_cvt_pk_bf16_f32 v187, v38, v39
  v_lshlrev_b32 v38, 16, v187
  v_and_b32 v39, s58, v187
  v_pk_mul_f32 v[38:39], v[38:39], v[214:215]
  v_cvt_pk_bf16_f32 v187, v38, v39
  v_lshlrev_b32 v38, 16, v187
  v_and_b32 v39, s58, v187
  v_cvt_pk_f16_f32 v27, v38, v39

  ds_write_b64 v7, v[26:27] offset:4608
  ds_write_b64 v235, v[206:207] offset:2048
  s_waitcnt vmcnt(6) lgkmcnt(0)
  s_barrier
  s_cmp_lg_u32 s42, 0
  s_cbranch_scc1 pa_9
  ds_read_b64 v[40:41], v230 offset:1984
  ds_read_b64 v[42:43], v230 offset:1992
  ds_read_b128 v[56:59], v231 offset:1984
  ds_read_b128 v[72:75], v231 offset:448
  ds_read_b64 v[44:45], v230 offset:1920
  ds_read_b64 v[46:47], v230 offset:1928
  ds_read_b128 v[60:63], v231 offset:1920
  ds_read_b128 v[76:79], v231 offset:384
  ds_read_b64 v[48:49], v230 offset:1856
  ds_read_b64 v[50:51], v230 offset:1864
  ds_read_b128 v[64:67], v231 offset:1856
  ds_read_b128 v[80:83], v231 offset:320
  ds_read_b64 v[52:53], v230 offset:1792
  ds_read_b64 v[54:55], v230 offset:1800
  ds_read_b128 v[68:71], v231 offset:1792
  ds_read_b128 v[84:87], v231 offset:256
  s_waitcnt lgkmcnt(0)
  v_mfma_f32_16x16x32_f16 v[140:143], v[40:43], v[56:59], 0
  ds_read_b64 v[88:89], v230 offset:1728
  ds_read_b64 v[90:91], v230 offset:1736
  v_mfma_f32_16x16x32_f16 v[136:139], v[40:43], v[72:75], 0
  ds_read_b128 v[104:107], v231 offset:1728
  ds_read_b128 v[120:123], v231 offset:192
  v_mfma_f32_16x16x32_f16 v[140:143], v[44:47], v[60:63], v[140:143]
  ds_read_b64 v[92:93], v230 offset:1664
  ds_read_b64 v[94:95], v230 offset:1672
  v_mfma_f32_16x16x32_f16 v[136:139], v[44:47], v[76:79], v[136:139]
  ds_read_b128 v[108:111], v231 offset:1664
  ds_read_b128 v[124:127], v231 offset:128
  v_mfma_f32_16x16x32_f16 v[140:143], v[48:51], v[64:67], v[140:143]
  ds_read_b64 v[96:97], v230 offset:1600
  ds_read_b64 v[98:99], v230 offset:1608
  v_mfma_f32_16x16x32_f16 v[136:139], v[48:51], v[80:83], v[136:139]
  ds_read_b128 v[112:115], v231 offset:1600
  ds_read_b128 v[128:131], v231 offset:64
  v_mfma_f32_16x16x32_f16 v[140:143], v[52:55], v[68:71], v[140:143]
  ds_read_b64 v[100:101], v230 offset:1536
  ds_read_b64 v[102:103], v230 offset:1544
  v_mfma_f32_16x16x32_f16 v[136:139], v[52:55], v[84:87], v[136:139]
  ds_read_b128 v[116:119], v231 offset:1536
  ds_read_b128 v[132:135], v231 offset:0
  s_waitcnt lgkmcnt(0)
  v_mfma_f32_16x16x32_f16 v[140:143], v[88:91], v[104:107], v[140:143]
  ds_read_b64 v[40:41], v230 offset:1472
  ds_read_b64 v[42:43], v230 offset:1480
  v_mfma_f32_16x16x32_f16 v[136:139], v[88:91], v[120:123], v[136:139]
  ds_read_b128 v[56:59], v231 offset:1472
  ds_read_b64 v[44:45], v230 offset:1408
  v_mfma_f32_16x16x32_f16 v[140:143], v[92:95], v[108:111], v[140:143]
  ds_read_b64 v[46:47], v230 offset:1416
  ds_read_b128 v[60:63], v231 offset:1408
  v_mfma_f32_16x16x32_f16 v[136:139], v[92:95], v[124:127], v[136:139]
  ds_read_b64 v[48:49], v230 offset:1344
  ds_read_b64 v[50:51], v230 offset:1352
  v_mfma_f32_16x16x32_f16 v[140:143], v[96:99], v[112:115], v[140:143]
  ds_read_b128 v[64:67], v231 offset:1344
  ds_read_b64 v[52:53], v230 offset:1280
  v_mfma_f32_16x16x32_f16 v[136:139], v[96:99], v[128:131], v[136:139]
  ds_read_b64 v[54:55], v230 offset:1288
  ds_read_b128 v[68:71], v231 offset:1280
  v_mfma_f32_16x16x32_f16 v[140:143], v[100:103], v[116:119], v[140:143]
  v_mfma_f32_16x16x32_f16 v[136:139], v[100:103], v[132:135], v[136:139]
  s_waitcnt lgkmcnt(0)
  v_mfma_f32_16x16x32_f16 v[140:143], v[40:43], v[56:59], v[140:143]
  ds_read_b64 v[88:89], v230 offset:1216
  ds_read_b64 v[90:91], v230 offset:1224
  ds_read_b128 v[104:107], v231 offset:1216
  v_mfma_f32_16x16x32_f16 v[140:143], v[44:47], v[60:63], v[140:143]
  ds_read_b64 v[92:93], v230 offset:1152
  ds_read_b64 v[94:95], v230 offset:1160
  ds_read_b128 v[108:111], v231 offset:1152
  v_mfma_f32_16x16x32_f16 v[140:143], v[48:51], v[64:67], v[140:143]
  ds_read_b64 v[96:97], v230 offset:1088
  ds_read_b64 v[98:99], v230 offset:1096
  ds_read_b128 v[112:115], v231 offset:1088
  v_mfma_f32_16x16x32_f16 v[140:143], v[52:55], v[68:71], v[140:143]
  ds_read_b64 v[100:101], v230 offset:1024
  ds_read_b64 v[102:103], v230 offset:1032
  ds_read_b128 v[116:119], v231 offset:1024
  s_waitcnt lgkmcnt(0)
  v_mfma_f32_16x16x32_f16 v[140:143], v[88:91], v[104:107], v[140:143]
  ds_read_b64 v[40:41], v230 offset:960
  ds_read_b64 v[42:43], v230 offset:968
  ds_read_b128 v[56:59], v231 offset:960
  v_mfma_f32_16x16x32_f16 v[140:143], v[92:95], v[108:111], v[140:143]
  ds_read_b64 v[44:45], v230 offset:896
  ds_read_b64 v[46:47], v230 offset:904
  ds_read_b128 v[60:63], v231 offset:896
  v_mfma_f32_16x16x32_f16 v[140:143], v[96:99], v[112:115], v[140:143]
  ds_read_b64 v[48:49], v230 offset:832
  ds_read_b64 v[50:51], v230 offset:840
  ds_read_b128 v[64:67], v231 offset:832
  v_mfma_f32_16x16x32_f16 v[140:143], v[100:103], v[116:119], v[140:143]
  ds_read_b64 v[52:53], v230 offset:768
  ds_read_b64 v[54:55], v230 offset:776
  ds_read_b128 v[68:71], v231 offset:768
  s_waitcnt lgkmcnt(0)
  v_mfma_f32_16x16x32_f16 v[140:143], v[40:43], v[56:59], v[140:143]
  ds_read_b64 v[88:89], v230 offset:704
  ds_read_b64 v[90:91], v230 offset:712
  ds_read_b128 v[104:107], v231 offset:704
  v_mfma_f32_16x16x32_f16 v[140:143], v[44:47], v[60:63], v[140:143]
  ds_read_b64 v[92:93], v230 offset:640
  ds_read_b64 v[94:95], v230 offset:648
  ds_read_b128 v[108:111], v231 offset:640
  v_mfma_f32_16x16x32_f16 v[140:143], v[48:51], v[64:67], v[140:143]
  ds_read_b64 v[96:97], v230 offset:576
  ds_read_b64 v[98:99], v230 offset:584
  ds_read_b128 v[112:115], v231 offset:576
  v_mfma_f32_16x16x32_f16 v[140:143], v[52:55], v[68:71], v[140:143]
  ds_read_b64 v[100:101], v230 offset:512
  ds_read_b64 v[102:103], v230 offset:520
  ds_read_b128 v[116:119], v231 offset:512
  s_waitcnt lgkmcnt(0)
  v_mfma_f32_16x16x32_f16 v[140:143], v[88:91], v[104:107], v[140:143]
  ds_read_b64 v[40:41], v230 offset:448
  ds_read_b64 v[42:43], v230 offset:456
  ds_read_b128 v[56:59], v231 offset:448
  v_mfma_f32_16x16x32_f16 v[140:143], v[92:95], v[108:111], v[140:143]
  ds_read_b64 v[44:45], v230 offset:384
  ds_read_b64 v[46:47], v230 offset:392
  ds_read_b128 v[60:63], v231 offset:384
  v_mfma_f32_16x16x32_f16 v[140:143], v[96:99], v[112:115], v[140:143]
  ds_read_b64 v[48:49], v230 offset:320
  ds_read_b64 v[50:51], v230 offset:328
  ds_read_b128 v[64:67], v231 offset:320
  v_mfma_f32_16x16x32_f16 v[140:143], v[100:103], v[116:119], v[140:143]
  ds_read_b64 v[52:53], v230 offset:256
  ds_read_b64 v[54:55], v230 offset:264
  ds_read_b128 v[68:71], v231 offset:256
  s_waitcnt lgkmcnt(0)
  v_mfma_f32_16x16x32_f16 v[140:143], v[40:43], v[56:59], v[140:143]
  ds_read_b64 v[88:89], v230 offset:192
  ds_read_b64 v[90:91], v230 offset:200
  ds_read_b128 v[104:107], v231 offset:192
  v_mfma_f32_16x16x32_f16 v[140:143], v[44:47], v[60:63], v[140:143]
  ds_read_b64 v[92:93], v230 offset:128
  ds_read_b64 v[94:95], v230 offset:136
  ds_read_b128 v[108:111], v231 offset:128
  v_mfma_f32_16x16x32_f16 v[140:143], v[48:51], v[64:67], v[140:143]
  ds_read_b64 v[96:97], v230 offset:64
  ds_read_b64 v[98:99], v230 offset:72
  ds_read_b128 v[112:115], v231 offset:64
  v_mfma_f32_16x16x32_f16 v[140:143], v[52:55], v[68:71], v[140:143]
  ds_read_b64 v[100:101], v230 offset:0
  ds_read_b64 v[102:103], v230 offset:8
  ds_read_b128 v[116:119], v231 offset:0
  s_waitcnt lgkmcnt(0)
  v_mfma_f32_16x16x32_f16 v[140:143], v[88:91], v[104:107], v[140:143]
  ds_read_b64 v[144:145], v232 offset:0
  ds_read_b64 v[146:147], v233 offset:0
  v_mfma_f32_16x16x32_f16 v[140:143], v[92:95], v[108:111], v[140:143]
  ds_read_b64 v[148:149], v232 offset:1536
  ds_read_b64 v[150:151], v233 offset:1536
  v_mfma_f32_16x16x32_f16 v[140:143], v[96:99], v[112:115], v[140:143]
  v_mfma_f32_16x16x32_f16 v[140:143], v[100:103], v[116:119], v[140:143]
  v_add_u32 v188, 0, v234
  v_add_u32 v189, 786432, v234
  s_branch pb_10
pa_9:
  ds_read_b64 v[40:41], v230 offset:1984
  ds_read_b64 v[42:43], v230 offset:1992
  ds_read_b128 v[56:59], v231 offset:1472
  ds_read_b128 v[72:75], v231 offset:960
  ds_read_b64 v[44:45], v230 offset:1920
  ds_read_b64 v[46:47], v230 offset:1928
  ds_read_b128 v[60:63], v231 offset:1408
  ds_read_b128 v[76:79], v231 offset:896
  ds_read_b64 v[48:49], v230 offset:1856
  ds_read_b64 v[50:51], v230 offset:1864
  ds_read_b128 v[64:67], v231 offset:1344
  ds_read_b128 v[80:83], v231 offset:832
  ds_read_b64 v[52:53], v230 offset:1792
  ds_read_b64 v[54:55], v230 offset:1800
  ds_read_b128 v[68:71], v231 offset:1280
  ds_read_b128 v[84:87], v231 offset:768
  s_waitcnt lgkmcnt(0)
  v_mfma_f32_16x16x32_f16 v[140:143], v[40:43], v[56:59], 0
  ds_read_b64 v[88:89], v230 offset:1728
  ds_read_b64 v[90:91], v230 offset:1736
  v_mfma_f32_16x16x32_f16 v[136:139], v[40:43], v[72:75], 0
  ds_read_b128 v[104:107], v231 offset:1216
  ds_read_b128 v[120:123], v231 offset:704
  v_mfma_f32_16x16x32_f16 v[140:143], v[44:47], v[60:63], v[140:143]
  ds_read_b64 v[92:93], v230 offset:1664
  ds_read_b64 v[94:95], v230 offset:1672
  v_mfma_f32_16x16x32_f16 v[136:139], v[44:47], v[76:79], v[136:139]
  ds_read_b128 v[108:111], v231 offset:1152
  ds_read_b128 v[124:127], v231 offset:640
  v_mfma_f32_16x16x32_f16 v[140:143], v[48:51], v[64:67], v[140:143]
  ds_read_b64 v[96:97], v230 offset:1600
  ds_read_b64 v[98:99], v230 offset:1608
  v_mfma_f32_16x16x32_f16 v[136:139], v[48:51], v[80:83], v[136:139]
  ds_read_b128 v[112:115], v231 offset:1088
  ds_read_b128 v[128:131], v231 offset:576
  v_mfma_f32_16x16x32_f16 v[140:143], v[52:55], v[68:71], v[140:143]
  ds_read_b64 v[100:101], v230 offset:1536
  ds_read_b64 v[102:103], v230 offset:1544
  v_mfma_f32_16x16x32_f16 v[136:139], v[52:55], v[84:87], v[136:139]
  ds_read_b128 v[116:119], v231 offset:1024
  ds_read_b128 v[132:135], v231 offset:512
  s_waitcnt lgkmcnt(0)
  v_mfma_f32_16x16x32_f16 v[140:143], v[88:91], v[104:107], v[140:143]
  ds_read_b64 v[40:41], v230 offset:1472
  ds_read_b64 v[42:43], v230 offset:1480
  v_mfma_f32_16x16x32_f16 v[136:139], v[88:91], v[120:123], v[136:139]
  ds_read_b128 v[56:59], v231 offset:960
  ds_read_b128 v[72:75], v231 offset:448
  v_mfma_f32_16x16x32_f16 v[140:143], v[92:95], v[108:111], v[140:143]
  ds_read_b64 v[44:45], v230 offset:1408
  ds_read_b64 v[46:47], v230 offset:1416
  v_mfma_f32_16x16x32_f16 v[136:139], v[92:95], v[124:127], v[136:139]
  ds_read_b128 v[60:63], v231 offset:896
  ds_read_b128 v[76:79], v231 offset:384
  v_mfma_f32_16x16x32_f16 v[140:143], v[96:99], v[112:115], v[140:143]
  ds_read_b64 v[48:49], v230 offset:1344
  ds_read_b64 v[50:51], v230 offset:1352
  v_mfma_f32_16x16x32_f16 v[136:139], v[96:99], v[128:131], v[136:139]
  ds_read_b128 v[64:67], v231 offset:832
  ds_read_b128 v[80:83], v231 offset:320
  v_mfma_f32_16x16x32_f16 v[140:143], v[100:103], v[116:119], v[140:143]
  ds_read_b64 v[52:53], v230 offset:1280
  ds_read_b64 v[54:55], v230 offset:1288
  v_mfma_f32_16x16x32_f16 v[136:139], v[100:103], v[132:135], v[136:139]
  ds_read_b128 v[68:71], v231 offset:768
  ds_read_b128 v[84:87], v231 offset:256
  s_waitcnt lgkmcnt(0)
  v_mfma_f32_16x16x32_f16 v[140:143], v[40:43], v[56:59], v[140:143]
  ds_read_b64 v[88:89], v230 offset:1216
  ds_read_b64 v[90:91], v230 offset:1224
  v_mfma_f32_16x16x32_f16 v[136:139], v[40:43], v[72:75], v[136:139]
  ds_read_b128 v[104:107], v231 offset:704
  ds_read_b128 v[120:123], v231 offset:192
  v_mfma_f32_16x16x32_f16 v[140:143], v[44:47], v[60:63], v[140:143]
  ds_read_b64 v[92:93], v230 offset:1152
  ds_read_b64 v[94:95], v230 offset:1160
  v_mfma_f32_16x16x32_f16 v[136:139], v[44:47], v[76:79], v[136:139]
  ds_read_b128 v[108:111], v231 offset:640
  ds_read_b128 v[124:127], v231 offset:128
  v_mfma_f32_16x16x32_f16 v[140:143], v[48:51], v[64:67], v[140:143]
  ds_read_b64 v[96:97], v230 offset:1088
  ds_read_b64 v[98:99], v230 offset:1096
  v_mfma_f32_16x16x32_f16 v[136:139], v[48:51], v[80:83], v[136:139]
  ds_read_b128 v[112:115], v231 offset:576
  ds_read_b128 v[128:131], v231 offset:64
  v_mfma_f32_16x16x32_f16 v[140:143], v[52:55], v[68:71], v[140:143]
  ds_read_b64 v[100:101], v230 offset:1024
  ds_read_b64 v[102:103], v230 offset:1032
  v_mfma_f32_16x16x32_f16 v[136:139], v[52:55], v[84:87], v[136:139]
  ds_read_b128 v[116:119], v231 offset:512
  ds_read_b128 v[132:135], v231 offset:0
  s_waitcnt lgkmcnt(0)
  v_mfma_f32_16x16x32_f16 v[140:143], v[88:91], v[104:107], v[140:143]
  ds_read_b64 v[40:41], v230 offset:960
  ds_read_b64 v[42:43], v230 offset:968
  v_mfma_f32_16x16x32_f16 v[136:139], v[88:91], v[120:123], v[136:139]
  ds_read_b128 v[56:59], v231 offset:448
  ds_read_b64 v[44:45], v230 offset:896
  v_mfma_f32_16x16x32_f16 v[140:143], v[92:95], v[108:111], v[140:143]
  ds_read_b64 v[46:47], v230 offset:904
  ds_read_b128 v[60:63], v231 offset:384
  v_mfma_f32_16x16x32_f16 v[136:139], v[92:95], v[124:127], v[136:139]
  ds_read_b64 v[48:49], v230 offset:832
  ds_read_b64 v[50:51], v230 offset:840
  v_mfma_f32_16x16x32_f16 v[140:143], v[96:99], v[112:115], v[140:143]
  ds_read_b128 v[64:67], v231 offset:320
  ds_read_b64 v[52:53], v230 offset:768
  v_mfma_f32_16x16x32_f16 v[136:139], v[96:99], v[128:131], v[136:139]
  ds_read_b64 v[54:55], v230 offset:776
  ds_read_b128 v[68:71], v231 offset:256
  v_mfma_f32_16x16x32_f16 v[140:143], v[100:103], v[116:119], v[140:143]
  v_mfma_f32_16x16x32_f16 v[136:139], v[100:103], v[132:135], v[136:139]
  s_waitcnt lgkmcnt(0)
  v_mfma_f32_16x16x32_f16 v[140:143], v[40:43], v[56:59], v[140:143]
  ds_read_b64 v[88:89], v230 offset:704
  ds_read_b64 v[90:91], v230 offset:712
  ds_read_b128 v[104:107], v231 offset:192
  v_mfma_f32_16x16x32_f16 v[140:143], v[44:47], v[60:63], v[140:143]
  ds_read_b64 v[92:93], v230 offset:640
  ds_read_b64 v[94:95], v230 offset:648
  ds_read_b128 v[108:111], v231 offset:128
  v_mfma_f32_16x16x32_f16 v[140:143], v[48:51], v[64:67], v[140:143]
  ds_read_b64 v[96:97], v230 offset:576
  ds_read_b64 v[98:99], v230 offset:584
  ds_read_b128 v[112:115], v231 offset:64
  v_mfma_f32_16x16x32_f16 v[140:143], v[52:55], v[68:71], v[140:143]
  ds_read_b64 v[100:101], v230 offset:512
  ds_read_b64 v[102:103], v230 offset:520
  ds_read_b128 v[116:119], v231 offset:0
  s_waitcnt lgkmcnt(0)
  v_mfma_f32_16x16x32_f16 v[140:143], v[88:91], v[104:107], v[140:143]
  ds_read_b64 v[144:145], v232 offset:512
  ds_read_b64 v[146:147], v233 offset:512
  v_mfma_f32_16x16x32_f16 v[140:143], v[92:95], v[108:111], v[140:143]
  ds_read_b64 v[148:149], v232 offset:1024
  ds_read_b64 v[150:151], v233 offset:1024
  v_mfma_f32_16x16x32_f16 v[140:143], v[96:99], v[112:115], v[140:143]
  v_mfma_f32_16x16x32_f16 v[140:143], v[100:103], v[116:119], v[140:143]
  v_add_u32 v188, 262144, v234
  v_add_u32 v189, 524288, v234
pb_10:
  s_waitcnt lgkmcnt(0)
  s_lshl_b32 s54, s52, 16
  s_and_b32 s55, s52, 0xffff0000
  s_cmp_eq_u32 s41, 0
  s_cselect_b32 s56, s54, s55
  s_mov_b32 s57, s56
  s_cselect_b64 vcc, 0, -1
  s_nop 1
  v_cndmask_b32 v8, v240, v241, vcc
  v_mov_b32 v9, v8

  v_cvt_f32_f16 v152, v144
  v_cvt_f32_f16_sdwa v153, v144 dst_sel:DWORD dst_unused:UNUSED_PAD src0_sel:WORD_1
  v_cvt_f32_f16 v154, v145
  v_cvt_f32_f16_sdwa v155, v145 dst_sel:DWORD dst_unused:UNUSED_PAD src0_sel:WORD_1
  v_cvt_f32_f16 v156, v148
  v_cvt_f32_f16_sdwa v157, v148 dst_sel:DWORD dst_unused:UNUSED_PAD src0_sel:WORD_1
  v_cvt_f32_f16 v158, v149
  v_cvt_f32_f16_sdwa v159, v149 dst_sel:DWORD dst_unused:UNUSED_PAD src0_sel:WORD_1
  v_pk_mul_f32 v[136:137], v[136:137], v[8:9]
  v_pk_mul_f32 v[152:153], v[152:153], s[56:57]
  v_cvt_pk_bf16_f32 v160, v136, v137
  v_cvt_pk_bf16_f32 v161, v152, v153
  v_lshlrev_b32 v136, 16, v160
  v_and_b32 v137, s58, v160
  v_lshlrev_b32 v152, 16, v161
  v_and_b32 v153, s58, v161
  v_pk_add_f32 v[136:137], v[136:137], v[152:153]
  v_lshlrev_b32 v152, 16, v146
  v_and_b32 v153, s58, v146
  v_cvt_pk_bf16_f32 v160, v136, v137
  v_lshlrev_b32 v136, 16, v160
  v_and_b32 v137, s58, v160
  v_pk_add_f32 v[136:137], v[136:137], v[152:153]
  v_cvt_pk_bf16_f32 v164, v136, v137

  v_pk_mul_f32 v[138:139], v[138:139], v[8:9]
  v_pk_mul_f32 v[154:155], v[154:155], s[56:57]
  v_cvt_pk_bf16_f32 v162, v138, v139
  v_cvt_pk_bf16_f32 v163, v154, v155
  v_lshlrev_b32 v138, 16, v162
  v_and_b32 v139, s58, v162
  v_lshlrev_b32 v154, 16, v163
  v_and_b32 v155, s58, v163
  v_pk_add_f32 v[138:139], v[138:139], v[154:155]
  v_lshlrev_b32 v154, 16, v147
  v_and_b32 v155, s58, v147
  v_cvt_pk_bf16_f32 v162, v138, v139
  v_lshlrev_b32 v138, 16, v162
  v_and_b32 v139, s58, v162
  v_pk_add_f32 v[138:139], v[138:139], v[154:155]
  v_cvt_pk_bf16_f32 v165, v138, v139

  global_store_dwordx2 v188, v[164:165], s[32:33] sc1
  v_pk_mul_f32 v[140:141], v[140:141], v[8:9]
  v_pk_mul_f32 v[156:157], v[156:157], s[56:57]
  v_cvt_pk_bf16_f32 v160, v140, v141
  v_cvt_pk_bf16_f32 v161, v156, v157
  v_lshlrev_b32 v140, 16, v160
  v_and_b32 v141, s58, v160
  v_lshlrev_b32 v156, 16, v161
  v_and_b32 v157, s58, v161
  v_pk_add_f32 v[140:141], v[140:141], v[156:157]
  v_lshlrev_b32 v156, 16, v150
  v_and_b32 v157, s58, v150
  v_cvt_pk_bf16_f32 v160, v140, v141
  v_lshlrev_b32 v140, 16, v160
  v_and_b32 v141, s58, v160
  v_pk_add_f32 v[140:141], v[140:141], v[156:157]
  v_cvt_pk_bf16_f32 v166, v140, v141

  v_pk_mul_f32 v[142:143], v[142:143], v[8:9]
  v_pk_mul_f32 v[158:159], v[158:159], s[56:57]
  v_cvt_pk_bf16_f32 v162, v142, v143
  v_cvt_pk_bf16_f32 v163, v158, v159
  v_lshlrev_b32 v142, 16, v162
  v_and_b32 v143, s58, v162
  v_lshlrev_b32 v158, 16, v163
  v_and_b32 v159, s58, v163
  v_pk_add_f32 v[142:143], v[142:143], v[158:159]
  v_lshlrev_b32 v158, 16, v151
  v_and_b32 v159, s58, v151
  v_cvt_pk_bf16_f32 v162, v142, v143
  v_lshlrev_b32 v142, 16, v162
  v_and_b32 v143, s58, v162
  v_pk_add_f32 v[142:143], v[142:143], v[158:159]
  v_cvt_pk_bf16_f32 v167, v142, v143

  global_store_dwordx2 v189, v[166:167], s[32:33] sc1
  s_waitcnt vmcnt(11)
  v_pk_mul_f32 v[220:221], v[220:221], v[12:13]
  v_pk_mul_f32 v[224:225], v[224:225], v[12:13]
  v_pk_fma_f32 v[224:225], v[220:221], v[220:221], v[224:225] neg_lo:[1,0,0] neg_hi:[1,0,0]
  v_cvt_pk_bf16_f32 v16, v220, v221
  v_max_f32 v224, 0, v224
  v_max_f32 v225, 0, v225
  v_cvt_pk_bf16_f32 v20, v224, v225
  v_lshlrev_b32 v220, 16, v16
  v_and_b32 v221, s58, v16
  v_lshlrev_b32 v224, 16, v20
  v_and_b32 v225, s58, v20
  v_pk_add_f32 v[224:225], v[224:225], v[14:15]

  s_mov_b32 m0, s65
  s_nop 0
  global_load_lds_dwordx4 v245, s[32:33] offset:2048
  v_add_u32 v244, 28672, v244
  v_add_u32 v245, 28672, v245
  v_pk_mul_f32 v[222:223], v[222:223], v[12:13]
  v_pk_mul_f32 v[226:227], v[226:227], v[12:13]
  v_pk_fma_f32 v[226:227], v[222:223], v[222:223], v[226:227] neg_lo:[1,0,0] neg_hi:[1,0,0]
  v_cvt_pk_bf16_f32 v17, v222, v223
  v_max_f32 v226, 0, v226
  v_max_f32 v227, 0, v227
  v_cvt_pk_bf16_f32 v21, v226, v227
  v_lshlrev_b32 v222, 16, v17
  v_and_b32 v223, s58, v17
  v_lshlrev_b32 v226, 16, v21
  v_and_b32 v227, s58, v21
  v_pk_add_f32 v[226:227], v[226:227], v[14:15]

  v_cvt_pk_bf16_f32 v20, v224, v225
  s_mov_b32 m0, s66
  s_nop 0
  global_load_lds_dwordx4 v244, s[32:33] offset:0
  v_lshlrev_b32 v224, 16, v20
  v_and_b32 v225, s58, v20
  v_sqrt_f32 v224, v224
  v_sqrt_f32 v225, v225

  v_cvt_pk_bf16_f32 v21, v226, v227
  v_lshlrev_b32 v226, 16, v21
  v_and_b32 v227, s58, v21
  v_sqrt_f32 v226, v226
  v_sqrt_f32 v227, v227

  s_nop 0
  v_cvt_pk_bf16_f32 v20, v224, v225
  v_lshlrev_b32 v224, 16, v20
  s_mov_b32 m0, s66
  s_nop 0
  global_load_lds_dwordx4 v244, s[32:33] offset:1024
  v_and_b32 v225, s58, v20
  v_rcp_f32 v224, v224
  v_rcp_f32 v225, v225

  v_cvt_pk_bf16_f32 v21, v226, v227
  v_lshlrev_b32 v226, 16, v21
  v_and_b32 v227, s58, v21
  v_rcp_f32 v226, v226
  v_rcp_f32 v227, v227

  s_nop 0
  s_waitcnt vmcnt(12)
  v_lshlrev_b32 v32, 16, v216
  v_and_b32 v33, s58, v216
  s_mov_b32 m0, s66
  s_nop 0
  global_load_lds_dwordx4 v244, s[32:33] offset:2048
  v_pk_add_f32 v[32:33], v[32:33], v[220:221] neg_lo:[0,1] neg_hi:[0,1]
  v_cvt_pk_bf16_f32 v184, v32, v33
  v_lshlrev_b32 v32, 16, v184
  v_and_b32 v33, s58, v184
  v_pk_mul_f32 v[32:33], v[32:33], v[224:225]
  v_cvt_pk_bf16_f32 v184, v32, v33
  v_lshlrev_b32 v32, 16, v184
  v_and_b32 v33, s58, v184
  v_cvt_pk_f16_f32 v24, v32, v33

  v_lshlrev_b32 v34, 16, v217
  v_and_b32 v35, s58, v217
  v_pk_add_f32 v[34:35], v[34:35], v[222:223] neg_lo:[0,1] neg_hi:[0,1]
  v_cvt_pk_bf16_f32 v185, v34, v35
  s_mov_b32 m0, s66
  s_nop 0
  global_load_lds_dwordx4 v244, s[32:33] offset:3072
  v_lshlrev_b32 v34, 16, v185
  v_and_b32 v35, s58, v185
  v_pk_mul_f32 v[34:35], v[34:35], v[226:227]
  v_cvt_pk_bf16_f32 v185, v34, v35
  v_lshlrev_b32 v34, 16, v185
  v_and_b32 v35, s58, v185
  v_cvt_pk_f16_f32 v25, v34, v35

  ds_write_b64 v7, v[24:25] offset:2048
  v_lshlrev_b32 v36, 16, v218
  v_and_b32 v37, s58, v218
  v_pk_add_f32 v[36:37], v[36:37], v[220:221] neg_lo:[0,1] neg_hi:[0,1]
  v_cvt_pk_bf16_f32 v186, v36, v37
  v_lshlrev_b32 v36, 16, v186
  s_mov_b32 m0, s67
  s_nop 0
  global_load_lds_dwordx4 v245, s[32:33] offset:0
  v_and_b32 v37, s58, v186
  v_pk_mul_f32 v[36:37], v[36:37], v[224:225]
  v_cvt_pk_bf16_f32 v186, v36, v37
  v_lshlrev_b32 v36, 16, v186
  v_and_b32 v37, s58, v186
  v_cvt_pk_f16_f32 v26, v36, v37

  v_lshlrev_b32 v38, 16, v219
  v_and_b32 v39, s58, v219
  v_pk_add_f32 v[38:39], v[38:39], v[222:223] neg_lo:[0,1] neg_hi:[0,1]
  v_cvt_pk_bf16_f32 v187, v38, v39
  v_lshlrev_b32 v38, 16, v187
  v_and_b32 v39, s58, v187
  v_pk_mul_f32 v[38:39], v[38:39], v[226:227]
  v_cvt_pk_bf16_f32 v187, v38, v39
  v_lshlrev_b32 v38, 16, v187
  v_and_b32 v39, s58, v187
  v_cvt_pk_f16_f32 v27, v38, v39

  ds_write_b64 v7, v[26:27] offset:6656
  s_waitcnt vmcnt(6) lgkmcnt(0)
  s_barrier
  s_cmp_lg_u32 s34, 0
  s_cbranch_scc1 w0_11
  s_and_b32 s93, s2, 15
  s_lshl_b32 s93, s93, 8
  s_add_u32 s93, s93, 31461376
  v_mov_b32 v246, s93
  v_mov_b32 v247, 1
  s_mov_b64 exec, 1
  global_atomic_add v246, v247, s[32:33] sc1
  s_mov_b64 exec, -1
  s_nop 3

w0_11:
  ds_read_b64 v[40:41], v4 offset:3584
  ds_read_b64 v[42:43], v4 offset:3592
  ds_read_b128 v[88:91], v5 offset:2048
  ds_read_b128 v[92:95], v5 offset:2560
  ds_read_b128 v[96:99], v5 offset:3072
  ds_read_b128 v[100:103], v5 offset:3584
  ds_read_b128 v[84:87], v5 offset:1536
  ds_read_b128 v[80:83], v5 offset:1024
  ds_read_b128 v[76:79], v5 offset:512
  ds_read_b128 v[72:75], v5 offset:0
  ds_read_b64 v[44:45], v4 offset:3072
  ds_read_b64 v[46:47], v4 offset:3080
  ds_read_b64 v[48:49], v4 offset:2560
  ds_read_b64 v[50:51], v4 offset:2568
  ds_read_b64 v[52:53], v4 offset:2048
  ds_read_b64 v[54:55], v4 offset:2056
  ds_read_b64 v[56:57], v4 offset:1536
  ds_read_b64 v[58:59], v4 offset:1544
  ds_read_b64 v[60:61], v4 offset:1024
  ds_read_b64 v[62:63], v4 offset:1032
  ds_read_b64 v[64:65], v4 offset:512
  ds_read_b64 v[66:67], v4 offset:520
  ds_read_b64 v[68:69], v4 offset:0
  ds_read_b64 v[70:71], v4 offset:8
  v_subrev_u32 v4, 64, v4
  v_subrev_u32 v5, 64, v5
  s_waitcnt lgkmcnt(0)
  v_mfma_f32_16x16x32_f16 v[168:171], v[40:43], v[88:91], 0
  ds_read_b64 v[104:105], v4 offset:3584
  v_mfma_f32_16x16x32_f16 v[172:175], v[40:43], v[92:95], 0
  s_mov_b32 m0, s67
  s_nop 0
  global_load_lds_dwordx4 v245, s[32:33] offset:1024
  ds_read_b64 v[106:107], v4 offset:3592
  v_mfma_f32_16x16x32_f16 v[176:179], v[40:43], v[96:99], 0
  ds_read_b128 v[152:155], v5 offset:2048
  v_mfma_f32_16x16x32_f16 v[180:183], v[40:43], v[100:103], 0
  ds_read_b128 v[156:159], v5 offset:2560
  v_mfma_f32_16x16x32_f16 v[168:171], v[44:47], v[84:87], v[168:171]
  ds_read_b128 v[160:163], v5 offset:3072
  v_mfma_f32_16x16x32_f16 v[172:175], v[44:47], v[88:91], v[172:175]
  s_mov_b32 m0, s67
  s_nop 0
  global_load_lds_dwordx4 v245, s[32:33] offset:2048
  v_add_u32 v244, 28672, v244
  v_add_u32 v245, 28672, v245
  ds_read_b128 v[164:167], v5 offset:3584
  v_mfma_f32_16x16x32_f16 v[176:179], v[44:47], v[92:95], v[176:179]
  ds_read_b128 v[148:151], v5 offset:1536
  v_mfma_f32_16x16x32_f16 v[180:183], v[44:47], v[96:99], v[180:183]
  ds_read_b128 v[144:147], v5 offset:1024
  v_mfma_f32_16x16x32_f16 v[168:171], v[48:51], v[80:83], v[168:171]
  ds_read_b128 v[140:143], v5 offset:512
  v_mfma_f32_16x16x32_f16 v[172:175], v[48:51], v[84:87], v[172:175]
  s_mov_b32 m0, s68
  s_nop 0
  global_load_lds_dwordx4 v244, s[32:33] offset:0
  ds_read_b128 v[136:139], v5 offset:0
  v_mfma_f32_16x16x32_f16 v[176:179], v[48:51], v[88:91], v[176:179]
  ds_read_b64 v[108:109], v4 offset:3072
  v_mfma_f32_16x16x32_f16 v[180:183], v[48:51], v[92:95], v[180:183]
  ds_read_b64 v[110:111], v4 offset:3080
  v_mfma_f32_16x16x32_f16 v[168:171], v[52:55], v[76:79], v[168:171]
  ds_read_b64 v[112:113], v4 offset:2560
  v_mfma_f32_16x16x32_f16 v[172:175], v[52:55], v[80:83], v[172:175]
  s_mov_b32 m0, s68
  s_nop 0
  global_load_lds_dwordx4 v244, s[32:33] offset:1024
  ds_read_b64 v[114:115], v4 offset:2568
  v_mfma_f32_16x16x32_f16 v[176:179], v[52:55], v[84:87], v[176:179]
  ds_read_b64 v[116:117], v4 offset:2048
  v_mfma_f32_16x16x32_f16 v[180:183], v[52:55], v[88:91], v[180:183]
  ds_read_b64 v[118:119], v4 offset:2056
  v_mfma_f32_16x16x32_f16 v[168:171], v[56:59], v[72:75], v[168:171]
  ds_read_b64 v[120:121], v4 offset:1536
  v_mfma_f32_16x16x32_f16 v[172:175], v[56:59], v[76:79], v[172:175]
  s_mov_b32 m0, s68
  s_nop 0
  global_load_lds_dwordx4 v244, s[32:33] offset:2048
  ds_read_b64 v[122:123], v4 offset:1544
  v_mfma_f32_16x16x32_f16 v[176:179], v[56:59], v[80:83], v[176:179]
  ds_read_b64 v[124:125], v4 offset:1024
  v_mfma_f32_16x16x32_f16 v[180:183], v[56:59], v[84:87], v[180:183]
  ds_read_b64 v[126:127], v4 offset:1032
  v_mfma_f32_16x16x32_f16 v[172:175], v[60:63], v[72:75], v[172:175]
  ds_read_b64 v[128:129], v4 offset:512
  v_mfma_f32_16x16x32_f16 v[176:179], v[60:63], v[76:79], v[176:179]
  s_mov_b32 m0, s68
  s_nop 0
  global_load_lds_dwordx4 v244, s[32:33] offset:3072
  ds_read_b64 v[130:131], v4 offset:520
  v_mfma_f32_16x16x32_f16 v[180:183], v[60:63], v[80:83], v[180:183]
  ds_read_b64 v[132:133], v4 offset:0
  v_mfma_f32_16x16x32_f16 v[176:179], v[64:67], v[72:75], v[176:179]
  ds_read_b64 v[134:135], v4 offset:8
  v_mfma_f32_16x16x32_f16 v[180:183], v[64:67], v[76:79], v[180:183]
  v_subrev_u32 v4, 64, v4
  v_subrev_u32 v5, 64, v5
  v_mfma_f32_16x16x32_f16 v[180:183], v[68:71], v[72:75], v[180:183]
  s_waitcnt lgkmcnt(0)
  v_mfma_f32_16x16x32_f16 v[168:171], v[104:107], v[152:155], v[168:171]
  ds_read_b64 v[40:41], v4 offset:3584
  v_mfma_f32_16x16x32_f16 v[172:175], v[104:107], v[156:159], v[172:175]
  s_mov_b32 m0, s69
  s_nop 0
  global_load_lds_dwordx4 v245, s[32:33] offset:0
  ds_read_b64 v[42:43], v4 offset:3592
  v_mfma_f32_16x16x32_f16 v[176:179], v[104:107], v[160:163], v[176:179]
  ds_read_b128 v[88:91], v5 offset:2048
  v_mfma_f32_16x16x32_f16 v[180:183], v[104:107], v[164:167], v[180:183]
  ds_read_b128 v[92:95], v5 offset:2560
  v_mfma_f32_16x16x32_f16 v[168:171], v[108:111], v[148:151], v[168:171]
  ds_read_b128 v[96:99], v5 offset:3072
  v_mfma_f32_16x16x32_f16 v[172:175], v[108:111], v[152:155], v[172:175]
  s_mov_b32 m0, s69
  s_nop 0
  global_load_lds_dwordx4 v245, s[32:33] offset:1024
  ds_read_b128 v[100:103], v5 offset:3584
  v_mfma_f32_16x16x32_f16 v[176:179], v[108:111], v[156:159], v[176:179]
  ds_read_b128 v[84:87], v5 offset:1536
  v_mfma_f32_16x16x32_f16 v[180:183], v[108:111], v[160:163], v[180:183]
  ds_read_b128 v[80:83], v5 offset:1024
  v_mfma_f32_16x16x32_f16 v[168:171], v[112:115], v[144:147], v[168:171]
  ds_read_b128 v[76:79], v5 offset:512
  v_mfma_f32_16x16x32_f16 v[172:175], v[112:115], v[148:151], v[172:175]
  s_mov_b32 m0, s69
  s_nop 0
  global_load_lds_dwordx4 v245, s[32:33] offset:2048
  v_add_u32 v244, 28672, v244
  v_add_u32 v245, 28672, v245
  ds_read_b128 v[72:75], v5 offset:0
  v_mfma_f32_16x16x32_f16 v[176:179], v[112:115], v[152:155], v[176:179]
  ds_read_b64 v[44:45], v4 offset:3072
  v_mfma_f32_16x16x32_f16 v[180:183], v[112:115], v[156:159], v[180:183]
  ds_read_b64 v[46:47], v4 offset:3080
  v_mfma_f32_16x16x32_f16 v[168:171], v[116:119], v[140:143], v[168:171]
  ds_read_b64 v[48:49], v4 offset:2560
  v_mfma_f32_16x16x32_f16 v[172:175], v[116:119], v[144:147], v[172:175]
  s_mov_b32 m0, s70
  s_nop 0
  global_load_lds_dwordx4 v244, s[32:33] offset:0
  ds_read_b64 v[50:51], v4 offset:2568
  v_mfma_f32_16x16x32_f16 v[176:179], v[116:119], v[148:151], v[176:179]
  ds_read_b64 v[52:53], v4 offset:2048
  v_mfma_f32_16x16x32_f16 v[180:183], v[116:119], v[152:155], v[180:183]
  ds_read_b64 v[54:55], v4 offset:2056
  v_mfma_f32_16x16x32_f16 v[168:171], v[120:123], v[136:139], v[168:171]
  ds_read_b64 v[56:57], v4 offset:1536
  v_mfma_f32_16x16x32_f16 v[172:175], v[120:123], v[140:143], v[172:175]
  s_mov_b32 m0, s70
  s_nop 0
  global_load_lds_dwordx4 v244, s[32:33] offset:1024
  ds_read_b64 v[58:59], v4 offset:1544
  v_mfma_f32_16x16x32_f16 v[176:179], v[120:123], v[144:147], v[176:179]
  ds_read_b64 v[60:61], v4 offset:1024
  v_mfma_f32_16x16x32_f16 v[180:183], v[120:123], v[148:151], v[180:183]
  ds_read_b64 v[62:63], v4 offset:1032
  v_mfma_f32_16x16x32_f16 v[172:175], v[124:127], v[136:139], v[172:175]
  ds_read_b64 v[64:65], v4 offset:512
  v_mfma_f32_16x16x32_f16 v[176:179], v[124:127], v[140:143], v[176:179]
  ds_read_b64 v[66:67], v4 offset:520
  v_mfma_f32_16x16x32_f16 v[180:183], v[124:127], v[144:147], v[180:183]
  ds_read_b64 v[68:69], v4 offset:0
  v_mfma_f32_16x16x32_f16 v[176:179], v[128:131], v[136:139], v[176:179]
  ds_read_b64 v[70:71], v4 offset:8
  v_mfma_f32_16x16x32_f16 v[180:183], v[128:131], v[140:143], v[180:183]
  v_subrev_u32 v4, 64, v4
  v_subrev_u32 v5, 64, v5
  v_mfma_f32_16x16x32_f16 v[180:183], v[132:135], v[136:139], v[180:183]
  s_waitcnt lgkmcnt(0)
  v_mfma_f32_16x16x32_f16 v[168:171], v[40:43], v[88:91], v[168:171]
  ds_read_b64 v[104:105], v4 offset:3584
  v_mfma_f32_16x16x32_f16 v[172:175], v[40:43], v[92:95], v[172:175]
  s_mov_b32 m0, s70
  s_nop 0
  global_load_lds_dwordx4 v244, s[32:33] offset:2048
  ds_read_b64 v[106:107], v4 offset:3592
  v_mfma_f32_16x16x32_f16 v[176:179], v[40:43], v[96:99], v[176:179]
  ds_read_b128 v[152:155], v5 offset:2048
  v_mfma_f32_16x16x32_f16 v[180:183], v[40:43], v[100:103], v[180:183]
  ds_read_b128 v[156:159], v5 offset:2560
  v_mfma_f32_16x16x32_f16 v[168:171], v[44:47], v[84:87], v[168:171]
  ds_read_b128 v[160:163], v5 offset:3072
  v_mfma_f32_16x16x32_f16 v[172:175], v[44:47], v[88:91], v[172:175]
  s_mov_b32 m0, s70
  s_nop 0
  global_load_lds_dwordx4 v244, s[32:33] offset:3072
  ds_read_b128 v[164:167], v5 offset:3584
  v_mfma_f32_16x16x32_f16 v[176:179], v[44:47], v[92:95], v[176:179]
  ds_read_b128 v[148:151], v5 offset:1536
  v_mfma_f32_16x16x32_f16 v[180:183], v[44:47], v[96:99], v[180:183]
  ds_read_b128 v[144:147], v5 offset:1024
  v_mfma_f32_16x16x32_f16 v[168:171], v[48:51], v[80:83], v[168:171]
  ds_read_b128 v[140:143], v5 offset:512
  v_mfma_f32_16x16x32_f16 v[172:175], v[48:51], v[84:87], v[172:175]
  s_mov_b32 m0, s71
  s_nop 0
  global_load_lds_dwordx4 v245, s[32:33] offset:0
  ds_read_b128 v[136:139], v5 offset:0
  v_mfma_f32_16x16x32_f16 v[176:179], v[48:51], v[88:91], v[176:179]
  ds_read_b64 v[108:109], v4 offset:3072
  v_mfma_f32_16x16x32_f16 v[180:183], v[48:51], v[92:95], v[180:183]
  ds_read_b64 v[110:111], v4 offset:3080
  v_mfma_f32_16x16x32_f16 v[168:171], v[52:55], v[76:79], v[168:171]
  ds_read_b64 v[112:113], v4 offset:2560
  v_mfma_f32_16x16x32_f16 v[172:175], v[52:55], v[80:83], v[172:175]
  s_mov_b32 m0, s71
  s_nop 0
  global_load_lds_dwordx4 v245, s[32:33] offset:1024
  ds_read_b64 v[114:115], v4 offset:2568
  v_mfma_f32_16x16x32_f16 v[176:179], v[52:55], v[84:87], v[176:179]
  ds_read_b64 v[116:117], v4 offset:2048
  v_mfma_f32_16x16x32_f16 v[180:183], v[52:55], v[88:91], v[180:183]
  ds_read_b64 v[118:119], v4 offset:2056
  v_mfma_f32_16x16x32_f16 v[168:171], v[56:59], v[72:75], v[168:171]
  ds_read_b64 v[120:121], v4 offset:1536
  v_mfma_f32_16x16x32_f16 v[172:175], v[56:59], v[76:79], v[172:175]
  s_mov_b32 m0, s71
  s_nop 0
  global_load_lds_dwordx4 v245, s[32:33] offset:2048
  ds_read_b64 v[122:123], v4 offset:1544
  v_mfma_f32_16x16x32_f16 v[176:179], v[56:59], v[80:83], v[176:179]
  ds_read_b64 v[124:125], v4 offset:1024
  v_mfma_f32_16x16x32_f16 v[180:183], v[56:59], v[84:87], v[180:183]
  ds_read_b64 v[126:127], v4 offset:1032
  v_mfma_f32_16x16x32_f16 v[172:175], v[60:63], v[72:75], v[172:175]
  ds_read_b64 v[128:129], v4 offset:512
  v_mfma_f32_16x16x32_f16 v[176:179], v[60:63], v[76:79], v[176:179]
  ds_read_b64 v[130:131], v4 offset:520
  v_mfma_f32_16x16x32_f16 v[180:183], v[60:63], v[80:83], v[180:183]
  ds_read_b64 v[132:133], v4 offset:0
  v_mfma_f32_16x16x32_f16 v[176:179], v[64:67], v[72:75], v[176:179]
  ds_read_b64 v[134:135], v4 offset:8
  v_mfma_f32_16x16x32_f16 v[180:183], v[64:67], v[76:79], v[180:183]
  v_subrev_u32 v4, 64, v4
  v_subrev_u32 v5, 64, v5
  v_mfma_f32_16x16x32_f16 v[180:183], v[68:71], v[72:75], v[180:183]
  s_waitcnt lgkmcnt(0)
  s_cmp_lg_u32 s34, 0
  s_cbranch_scc1 w0_12
  v_lshlrev_b32 v246, 8, v1
  v_add_u32 v246, 31461376, v246
  s_mov_b64 exec, 0xffff
  global_load_dword v247, v246, s[32:33] sc1
  s_mov_b64 exec, -1
  s_nop 3

w0_12:
  v_mfma_f32_16x16x32_f16 v[168:171], v[104:107], v[152:155], v[168:171]
  v_mfma_f32_16x16x32_f16 v[172:175], v[104:107], v[156:159], v[172:175]
  v_mfma_f32_16x16x32_f16 v[176:179], v[104:107], v[160:163], v[176:179]
  v_mfma_f32_16x16x32_f16 v[180:183], v[104:107], v[164:167], v[180:183]
  v_mfma_f32_16x16x32_f16 v[168:171], v[108:111], v[148:151], v[168:171]
  v_mfma_f32_16x16x32_f16 v[172:175], v[108:111], v[152:155], v[172:175]
  v_mfma_f32_16x16x32_f16 v[176:179], v[108:111], v[156:159], v[176:179]
  v_mfma_f32_16x16x32_f16 v[180:183], v[108:111], v[160:163], v[180:183]
  v_mfma_f32_16x16x32_f16 v[168:171], v[112:115], v[144:147], v[168:171]
  v_mfma_f32_16x16x32_f16 v[172:175], v[112:115], v[148:151], v[172:175]
  v_mfma_f32_16x16x32_f16 v[176:179], v[112:115], v[152:155], v[176:179]
  v_mfma_f32_16x16x32_f16 v[180:183], v[112:115], v[156:159], v[180:183]
  v_mfma_f32_16x16x32_f16 v[168:171], v[116:119], v[140:143], v[168:171]
  v_mfma_f32_16x16x32_f16 v[172:175], v[116:119], v[144:147], v[172:175]
  v_mfma_f32_16x16x32_f16 v[176:179], v[116:119], v[148:151], v[176:179]
  v_mfma_f32_16x16x32_f16 v[180:183], v[116:119], v[152:155], v[180:183]
  v_mfma_f32_16x16x32_f16 v[168:171], v[120:123], v[136:139], v[168:171]
  v_mfma_f32_16x16x32_f16 v[172:175], v[120:123], v[140:143], v[172:175]
  v_mfma_f32_16x16x32_f16 v[176:179], v[120:123], v[144:147], v[176:179]
  v_mfma_f32_16x16x32_f16 v[180:183], v[120:123], v[148:151], v[180:183]
  v_mfma_f32_16x16x32_f16 v[172:175], v[124:127], v[136:139], v[172:175]
  v_mfma_f32_16x16x32_f16 v[176:179], v[124:127], v[140:143], v[176:179]
  v_mfma_f32_16x16x32_f16 v[180:183], v[124:127], v[144:147], v[180:183]
  v_mfma_f32_16x16x32_f16 v[176:179], v[128:131], v[136:139], v[176:179]
  v_mfma_f32_16x16x32_f16 v[180:183], v[128:131], v[140:143], v[180:183]
  v_mfma_f32_16x16x32_f16 v[180:183], v[132:135], v[136:139], v[180:183]
  s_cmp_lg_u32 s34, 0
  s_cbranch_scc1 w0_15
  s_mov_b64 exec, 0xffff
  s_waitcnt vmcnt(0)
  s_mov_b32 s93, 200000
  v_cmp_ne_u32 vcc, 16, v247
  s_cbranch_vccz gd_14
  gp_13:
  s_sleep 12
  global_load_dword v247, v246, s[32:33] sc1
  s_waitcnt vmcnt(0)
  v_cmp_ne_u32 vcc, 16, v247
  s_cbranch_vccz gd_14
  s_sub_u32 s93, s93, 1
  s_cbranch_scc0 gp_13
  gd_14:
  s_mov_b64 exec, -1

w0_15:
  s_barrier
  s_nop 7
  ds_write_b128 v6, v[168:171] offset:0
  ds_write_b128 v6, v[172:175] offset:1024
  ds_write_b128 v6, v[176:179] offset:2048
  ds_write_b128 v6, v[180:183] offset:3072
  s_add_u32 s40, s32, 2097152
  s_addc_u32 s41, s33, 0
  s_lshl_b32 s44, s38, 1
  s_lshr_b32 s45, s34, 1
  s_add_u32 s44, s44, s45
  s_lshl_b32 s44, s44, 15
  s_and_b32 s45, s34, 1
  s_lshl_b32 s45, s45, 5
  s_add_u32 s44, s44, s45
  v_lshrrev_b32 v2, 1, v1
  v_and_b32 v3, 0x13, v2
  v_and_b32 v4, 4, v2
  v_lshl_or_b32 v3, v4, 1, v3
  v_and_b32 v4, 8, v2
  v_lshrrev_b32 v4, 1, v4
  v_or_b32 v3, v3, v4
  v_lshlrev_b32 v4, 6, v3
  v_and_b32 v3, 1, v1
  v_lshl_add_u32 v4, v3, 4, v4
  v_add_u32 v4, s44, v4
  s_mul_i32 s64, s34, 6144
  s_add_u32 s64, s64, 131072

  s_add_u32 s65, s64, 1024
  s_add_u32 s66, s64, 2048
  s_add_u32 s67, s64, 3072
  s_add_u32 s68, s64, 4096
  s_add_u32 s69, s64, 5120
  s_mov_b32 m0, s64
  s_nop 0
  global_load_lds_dwordx4 v4, s[40:41]
  v_add_u32 v4, 2048, v4
  s_mov_b32 m0, s65
  s_nop 0
  global_load_lds_dwordx4 v4, s[40:41]
  v_add_u32 v4, 2048, v4
  s_mov_b32 m0, s66
  s_nop 0
  global_load_lds_dwordx4 v4, s[40:41]
  v_add_u32 v4, 2048, v4
  s_mov_b32 m0, s67
  s_nop 0
  global_load_lds_dwordx4 v4, s[40:41]
  v_add_u32 v4, 2048, v4
  s_mov_b32 m0, s68
  s_nop 0
  global_load_lds_dwordx4 v4, s[40:41]
  v_add_u32 v4, 2048, v4
  s_mov_b32 m0, s69
  s_nop 0
  global_load_lds_dwordx4 v4, s[40:41]
  v_add_u32 v4, 2048, v4
  v_lshrrev_b32 v242, 3, v0
  v_lshlrev_b32 v242, 15, v242
  v_and_b32 v243, 7, v0
  v_lshl_add_u32 v242, v243, 3, v242
  s_lshl_b32 s43, s37, 6
  s_add_u32 s43, s43, 3145728
  v_add_u32 v242, s43, v242
  v_lshlrev_b32 v3, 4, v0
  v_add_u32 v3, 114688, v3
  v_mov_b32 v8, v240
  v_mov_b32 v9, v240
  v_mov_b32 v10, v241
  v_mov_b32 v11, v241
  s_mov_b32 s56, s54
  s_mov_b32 s57, s54
  s_mov_b32 s60, s55
  s_mov_b32 s61, s55
  s_waitcnt lgkmcnt(0)
  s_barrier

  ds_read_b128 v[40:43], v3 offset:0
  ds_read_b128 v[44:47], v3 offset:4096
  ds_read_b128 v[48:51], v3 offset:8192
  ds_read_b128 v[52:55], v3 offset:12288
  v_lshlrev_b32 v60, 16, v184
  v_and_b32 v61, s58, v184
  v_lshlrev_b32 v62, 16, v185
  v_and_b32 v63, s58, v185
  v_lshlrev_b32 v64, 16, v186
  v_and_b32 v65, s58, v186
  v_lshlrev_b32 v66, 16, v187
  v_and_b32 v67, s58, v187
  s_waitcnt lgkmcnt(2)
  v_pk_add_f32 v[40:41], v[40:41], v[44:45]
  v_pk_mul_f32 v[40:41], v[40:41], v[8:9]
  v_pk_mul_f32 v[60:61], v[60:61], s[56:57]
  v_cvt_pk_bf16_f32 v70, v40, v41
  v_cvt_pk_bf16_f32 v71, v60, v61
  v_lshlrev_b32 v40, 16, v70
  v_and_b32 v41, s58, v70
  v_lshlrev_b32 v60, 16, v71
  v_and_b32 v61, s58, v71
  v_pk_add_f32 v[40:41], v[40:41], v[60:61]
  v_lshlrev_b32 v60, 16, v216
  v_and_b32 v61, s58, v216
  v_cvt_pk_bf16_f32 v70, v40, v41
  v_lshlrev_b32 v40, 16, v70
  v_and_b32 v41, s58, v70
  v_pk_add_f32 v[40:41], v[40:41], v[60:61]
  v_cvt_pk_bf16_f32 v76, v40, v41

  v_pk_add_f32 v[42:43], v[42:43], v[46:47]
  v_pk_mul_f32 v[42:43], v[42:43], v[8:9]
  v_pk_mul_f32 v[62:63], v[62:63], s[56:57]
  v_cvt_pk_bf16_f32 v72, v42, v43
  v_cvt_pk_bf16_f32 v73, v62, v63
  v_lshlrev_b32 v42, 16, v72
  v_and_b32 v43, s58, v72
  v_lshlrev_b32 v62, 16, v73
  v_and_b32 v63, s58, v73
  v_pk_add_f32 v[42:43], v[42:43], v[62:63]
  v_lshlrev_b32 v62, 16, v217
  v_and_b32 v63, s58, v217
  v_cvt_pk_bf16_f32 v72, v42, v43
  v_lshlrev_b32 v42, 16, v72
  v_and_b32 v43, s58, v72
  v_pk_add_f32 v[42:43], v[42:43], v[62:63]
  v_cvt_pk_bf16_f32 v77, v42, v43

  global_store_dwordx2 v242, v[76:77], s[32:33] offset:0 sc1
  s_waitcnt lgkmcnt(0)
  v_pk_add_f32 v[48:49], v[48:49], v[52:53]
  v_pk_mul_f32 v[48:49], v[48:49], v[10:11]
  v_pk_mul_f32 v[64:65], v[64:65], s[60:61]
  v_cvt_pk_bf16_f32 v70, v48, v49
  v_cvt_pk_bf16_f32 v71, v64, v65
  v_lshlrev_b32 v48, 16, v70
  v_and_b32 v49, s58, v70
  v_lshlrev_b32 v64, 16, v71
  v_and_b32 v65, s58, v71
  v_pk_add_f32 v[48:49], v[48:49], v[64:65]
  v_lshlrev_b32 v64, 16, v218
  v_and_b32 v65, s58, v218
  v_cvt_pk_bf16_f32 v70, v48, v49
  v_lshlrev_b32 v48, 16, v70
  v_and_b32 v49, s58, v70
  v_pk_add_f32 v[48:49], v[48:49], v[64:65]
  v_cvt_pk_bf16_f32 v78, v48, v49

  v_pk_add_f32 v[50:51], v[50:51], v[54:55]
  v_pk_mul_f32 v[50:51], v[50:51], v[10:11]
  v_pk_mul_f32 v[66:67], v[66:67], s[60:61]
  v_cvt_pk_bf16_f32 v72, v50, v51
  v_cvt_pk_bf16_f32 v73, v66, v67
  v_lshlrev_b32 v50, 16, v72
  v_and_b32 v51, s58, v72
  v_lshlrev_b32 v66, 16, v73
  v_and_b32 v67, s58, v73
  v_pk_add_f32 v[50:51], v[50:51], v[66:67]
  v_lshlrev_b32 v66, 16, v219
  v_and_b32 v67, s58, v219
  v_cvt_pk_bf16_f32 v72, v50, v51
  v_lshlrev_b32 v50, 16, v72
  v_and_b32 v51, s58, v72
  v_pk_add_f32 v[50:51], v[50:51], v[66:67]
  v_cvt_pk_bf16_f32 v79, v50, v51

  global_store_dwordx2 v242, v[78:79], s[32:33] offset:64 sc1
  s_add_u32 s42, s32, 8388608
  s_addc_u32 s43, s33, 0
  s_add_u32 s90, s32, 31465472
  s_addc_u32 s91, s33, 0
  v_and_b32 v2, 15, v1
  v_lshrrev_b32 v3, 4, v1
  v_lshlrev_b32 v6, 4, v1
  v_add_u32 v6, 0, v6
  v_add_u32 v7, 57344, v6
  v_and_b32 v9, 1, v3
  v_lshlrev_b32 v9, 2, v9
  v_lshrrev_b32 v10, 1, v3
  v_lshl_add_u32 v9, v10, 4, v9
  v_lshrrev_b32 v10, 2, v2
  v_add_u32 v9, v9, v10
  v_lshlrev_b32 v9, 5, v9
  v_and_b32 v10, 3, v2
  v_lshl_add_u32 v9, v10, 3, v9
  v_add_u32 v9, s64, v9
  v_mov_b32 v11, 0x3f803f80
  v_accvgpr_write_b32 a224, v11
  v_accvgpr_write_b32 a225, v11
  v_accvgpr_write_b32 a226, v11
  v_accvgpr_write_b32 a227, v11
  v_lshlrev_b32 v13, 4, v3
  v_add_u32 v13, 162880, v13
  v_and_b32 v5, 1, v3
  v_lshlrev_b32 v5, 1, v5
  v_lshrrev_b32 v10, 1, v3
  v_add_u32 v5, v5, v10
  v_lshlrev_b32 v5, 11, v5
  v_add_u32 v5, v5, v2
  s_lshl_b32 s45, s38, 6
  s_lshl_b32 s46, s34, 4
  s_add_u32 s45, s45, s46
  v_add_u32 v5, s45, v5
  v_lshlrev_b32 v5, 4, v5
  s_mul_i32 s46, s39, 458752
  v_add_u32 v5, s46, v5
  v_lshlrev_b32 v12, 11, v10
  v_add_u32 v12, v12, v2
  v_add_u32 v12, s45, v12
  v_lshlrev_b32 v12, 4, v12
  v_and_b32 v10, 1, v3
  v_lshl_add_u32 v12, v10, 3, v12
  s_add_u32 s46, s46, 393216
  v_add_u32 v12, s46, v12
  s_mov_b32 s56, 0x3b000000
  s_mov_b32 s57, 0x3727c5ac
  s_mov_b32 s58, 0xffff0000
  s_mov_b32 s70, 0xc0135761
  s_mov_b32 s71, 0xc0135761
  v_mov_b32 v14, 0xbdd2d3e8
  v_mov_b32 v15, 0xbdd2d3e8
  s_lshr_b32 s47, s36, 3
  s_lshl_b32 s48, s35, 2
  s_add_u32 s47, s47, s48
  s_lshl_b32 s48, s47, 5
  s_and_b32 s49, s36, 7
  v_lshlrev_b32 v248, 11, v3
  v_add_u32 v248, v248, v2
  v_add_u32 v248, s48, v248
  v_lshlrev_b32 v248, 4, v248
  s_mul_i32 s50, s34, 1835008
  v_add_u32 v248, s50, v248
  s_lshl_b32 s50, s47, 15
  s_lshl_b32 s51, s49, 12
  s_add_u32 s50, s50, s51
  v_lshlrev_b32 v249, 4, v0
  v_add_u32 v249, s50, v249
  s_lshl_b32 s50, s49, 3
  s_lshl_b32 s51, s34, 1
  s_add_u32 s50, s50, s51
  v_lshrrev_b32 v250, 5, v1
  v_add_u32 v250, s50, v250
  v_lshlrev_b32 v251, 4, v250
  global_load_dwordx4 v[244:247], v251, s[26:27]
  s_lshl_b32 s92, s38, 8
  s_waitcnt vmcnt(9) lgkmcnt(0)
  s_barrier

  s_and_b32 s84, s36, 7
  s_mul_i32 s84, s84, 56
  s_mul_i32 s85, s34, 14
  s_add_u32 s84, s84, s85
  s_lshl_b32 s84, s84, 12
  s_add_u32 s84, s84, 35651584
  v_lshlrev_b32 v252, 4, v1
  v_add_u32 v252, s84, v252

  ds_read_b128 v[16:19], v6 offset:0
  ds_read_b128 v[20:23], v6 offset:1024
  ds_read_b128 v[24:27], v6 offset:2048
  ds_read_b128 v[28:31], v6 offset:3072
  ds_read_b128 v[32:35], v6 offset:4096
  ds_read_b128 v[36:39], v6 offset:5120
  ds_read_b128 v[40:43], v6 offset:6144
  s_waitcnt vmcnt(8)
  ds_read_b64_tr_b16 v[100:101], v9 offset:0
  ds_read_b64_tr_b16 v[102:103], v9 offset:256
  ds_read_b128 v[44:47], v6 offset:7168
  ds_read_b128 v[48:51], v6 offset:8192
  ds_read_b128 v[52:55], v6 offset:9216
  ds_read_b128 v[56:59], v6 offset:10240
  ds_read_b128 v[60:63], v6 offset:11264
  ds_read_b128 v[64:67], v6 offset:12288
  ds_read_b128 v[68:71], v6 offset:13312
  s_waitcnt vmcnt(7)
  ds_read_b64_tr_b16 v[104:105], v9 offset:1024
  ds_read_b64_tr_b16 v[106:107], v9 offset:1280
  s_waitcnt lgkmcnt(9)
  v_mfma_f32_16x16x32_bf16 a[228:231], a[224:227], v[100:103], 0
  s_mov_b32 m0, s64
  s_nop 0
  global_load_lds_dwordx4 v4, s[40:41]
  v_add_u32 v4, 2048, v4
  ds_read_b128 v[72:75], v6 offset:14336
  v_mfma_f32_16x16x32_bf16 a[236:239], v[100:103], v[100:103], 0
  ds_read_b128 v[76:79], v6 offset:15360
  v_mfma_f32_16x16x32_bf16 v[112:115], v[16:19], v[100:103], 0
  ds_read_b128 v[80:83], v6 offset:16384
  v_mfma_f32_16x16x32_bf16 v[116:119], v[20:23], v[100:103], 0
  ds_read_b128 v[84:87], v6 offset:17408
  v_mfma_f32_16x16x32_bf16 v[120:123], v[24:27], v[100:103], 0
  ds_read_b128 v[88:91], v6 offset:18432
  v_mfma_f32_16x16x32_bf16 v[124:127], v[28:31], v[100:103], 0
  ds_read_b128 v[92:95], v6 offset:19456
  v_mfma_f32_16x16x32_bf16 v[128:131], v[32:35], v[100:103], 0
  ds_read_b128 v[96:99], v6 offset:20480
  v_mfma_f32_16x16x32_bf16 v[132:135], v[36:39], v[100:103], 0
  s_waitcnt vmcnt(7)
  ds_read_b64_tr_b16 v[108:109], v9 offset:2048
  v_mfma_f32_16x16x32_bf16 v[136:139], v[40:43], v[100:103], 0
  ds_read_b64_tr_b16 v[110:111], v9 offset:2304
  global_load_dwordx4 a[0:3], v252, s[32:33] offset:0
  global_load_dwordx4 a[4:7], v252, s[32:33] offset:1024
  s_waitcnt lgkmcnt(9)
  v_mfma_f32_16x16x32_bf16 a[228:231], a[224:227], v[104:107], a[228:231]
  s_mov_b32 m0, s65
  s_nop 0
  global_load_lds_dwordx4 v4, s[40:41]
  v_add_u32 v4, 2048, v4
  ds_read_b128 v[16:19], v6 offset:21504
  v_mfma_f32_16x16x32_bf16 a[236:239], v[104:107], v[104:107], a[236:239]
  ds_read_b128 v[20:23], v6 offset:22528
  v_mfma_f32_16x16x32_bf16 v[112:115], v[44:47], v[104:107], v[112:115]
  ds_read_b128 v[24:27], v6 offset:23552
  v_mfma_f32_16x16x32_bf16 v[116:119], v[48:51], v[104:107], v[116:119]
  ds_read_b128 v[28:31], v6 offset:24576
  v_mfma_f32_16x16x32_bf16 v[120:123], v[52:55], v[104:107], v[120:123]
  ds_read_b128 v[32:35], v6 offset:25600
  v_mfma_f32_16x16x32_bf16 v[124:127], v[56:59], v[104:107], v[124:127]
  ds_read_b128 v[36:39], v6 offset:26624
  v_mfma_f32_16x16x32_bf16 v[128:131], v[60:63], v[104:107], v[128:131]
  ds_read_b128 v[40:43], v6 offset:27648
  v_mfma_f32_16x16x32_bf16 v[132:135], v[64:67], v[104:107], v[132:135]
  s_waitcnt vmcnt(9)
  ds_read_b64_tr_b16 v[100:101], v9 offset:3072
  v_mfma_f32_16x16x32_bf16 v[136:139], v[68:71], v[104:107], v[136:139]
  ds_read_b64_tr_b16 v[102:103], v9 offset:3328
  global_load_dwordx4 a[8:11], v252, s[32:33] offset:2048
  global_load_dwordx4 a[12:15], v252, s[32:33] offset:3072
  v_add_u32 v252, 4096, v252
  s_waitcnt lgkmcnt(9)
  v_mfma_f32_16x16x32_bf16 a[228:231], a[224:227], v[108:111], a[228:231]
  s_mov_b32 m0, s66
  s_nop 0
  global_load_lds_dwordx4 v4, s[40:41]
  v_add_u32 v4, 2048, v4
  ds_read_b128 v[44:47], v6 offset:28672
  v_mfma_f32_16x16x32_bf16 a[236:239], v[108:111], v[108:111], a[236:239]
  ds_read_b128 v[48:51], v6 offset:29696
  v_mfma_f32_16x16x32_bf16 v[112:115], v[72:75], v[108:111], v[112:115]
  ds_read_b128 v[52:55], v6 offset:30720
  v_mfma_f32_16x16x32_bf16 v[116:119], v[76:79], v[108:111], v[116:119]
  ds_read_b128 v[56:59], v6 offset:31744
  v_mfma_f32_16x16x32_bf16 v[120:123], v[80:83], v[108:111], v[120:123]
  ds_read_b128 v[60:63], v6 offset:32768
  v_mfma_f32_16x16x32_bf16 v[124:127], v[84:87], v[108:111], v[124:127]
  ds_read_b128 v[64:67], v6 offset:33792
  v_mfma_f32_16x16x32_bf16 v[128:131], v[88:91], v[108:111], v[128:131]
  ds_read_b128 v[68:71], v6 offset:34816
  v_mfma_f32_16x16x32_bf16 v[132:135], v[92:95], v[108:111], v[132:135]
  s_waitcnt vmcnt(11)
  ds_read_b64_tr_b16 v[104:105], v9 offset:4096
  v_mfma_f32_16x16x32_bf16 v[136:139], v[96:99], v[108:111], v[136:139]
  ds_read_b64_tr_b16 v[106:107], v9 offset:4352
  global_load_dwordx4 a[16:19], v252, s[32:33] offset:0
  global_load_dwordx4 a[20:23], v252, s[32:33] offset:1024
  s_waitcnt lgkmcnt(9)
  s_waitcnt vmcnt(10)
  s_barrier
  s_cmp_lg_u32 s34, 0
  s_cbranch_scc1 w0_16
  s_and_b32 s93, s2, 15
  s_lshl_b32 s93, s93, 8
  s_add_u32 s93, s93, 31490048
  v_mov_b32 v251, s93
  v_mov_b32 v11, 1
  s_mov_b64 exec, 1
  global_atomic_add v251, v11, s[32:33] sc1
  s_mov_b64 exec, -1
  s_nop 3

w0_16:
  v_mfma_f32_16x16x32_bf16 a[228:231], a[224:227], v[100:103], a[228:231]
  s_mov_b32 m0, s67
  s_nop 0
  global_load_lds_dwordx4 v4, s[40:41]
  v_add_u32 v4, 2048, v4
  ds_read_b128 v[72:75], v6 offset:35840
  v_mfma_f32_16x16x32_bf16 a[236:239], v[100:103], v[100:103], a[236:239]
  ds_read_b128 v[76:79], v6 offset:36864
  v_mfma_f32_16x16x32_bf16 v[112:115], v[16:19], v[100:103], v[112:115]
  ds_read_b128 v[80:83], v6 offset:37888
  v_mfma_f32_16x16x32_bf16 v[116:119], v[20:23], v[100:103], v[116:119]
  ds_read_b128 v[84:87], v6 offset:38912
  v_mfma_f32_16x16x32_bf16 v[120:123], v[24:27], v[100:103], v[120:123]
  ds_read_b128 v[88:91], v6 offset:39936
  v_mfma_f32_16x16x32_bf16 v[124:127], v[28:31], v[100:103], v[124:127]
  ds_read_b128 v[92:95], v6 offset:40960
  v_mfma_f32_16x16x32_bf16 v[128:131], v[32:35], v[100:103], v[128:131]
  ds_read_b128 v[96:99], v6 offset:41984
  v_mfma_f32_16x16x32_bf16 v[132:135], v[36:39], v[100:103], v[132:135]
  s_waitcnt vmcnt(13)
  ds_read_b64_tr_b16 v[108:109], v9 offset:5120
  v_mfma_f32_16x16x32_bf16 v[136:139], v[40:43], v[100:103], v[136:139]
  ds_read_b64_tr_b16 v[110:111], v9 offset:5376
  global_load_dwordx4 a[24:27], v252, s[32:33] offset:2048
  global_load_dwordx4 a[28:31], v252, s[32:33] offset:3072
  v_add_u32 v252, 4096, v252
  s_waitcnt lgkmcnt(9)
  v_mfma_f32_16x16x32_bf16 a[228:231], a[224:227], v[104:107], a[228:231]
  s_mov_b32 m0, s68
  s_nop 0
  global_load_lds_dwordx4 v4, s[40:41]
  v_add_u32 v4, 2048, v4
  ds_read_b128 v[16:19], v6 offset:43008
  v_mfma_f32_16x16x32_bf16 a[236:239], v[104:107], v[104:107], a[236:239]
  ds_read_b128 v[20:23], v6 offset:44032
  v_mfma_f32_16x16x32_bf16 v[112:115], v[44:47], v[104:107], v[112:115]
  ds_read_b128 v[24:27], v6 offset:45056
  v_mfma_f32_16x16x32_bf16 v[116:119], v[48:51], v[104:107], v[116:119]
  ds_read_b128 v[28:31], v6 offset:46080
  v_mfma_f32_16x16x32_bf16 v[120:123], v[52:55], v[104:107], v[120:123]
  ds_read_b128 v[32:35], v6 offset:47104
  v_mfma_f32_16x16x32_bf16 v[124:127], v[56:59], v[104:107], v[124:127]
  ds_read_b128 v[36:39], v6 offset:48128
  v_mfma_f32_16x16x32_bf16 v[128:131], v[60:63], v[104:107], v[128:131]
  ds_read_b128 v[40:43], v6 offset:49152
  v_mfma_f32_16x16x32_bf16 v[132:135], v[64:67], v[104:107], v[132:135]
  s_waitcnt vmcnt(12)
  ds_read_b64_tr_b16 v[100:101], v9 offset:0
  v_mfma_f32_16x16x32_bf16 v[136:139], v[68:71], v[104:107], v[136:139]
  ds_read_b64_tr_b16 v[102:103], v9 offset:256
  global_load_dwordx4 a[32:35], v252, s[32:33] offset:0
  global_load_dwordx4 a[36:39], v252, s[32:33] offset:1024
  s_waitcnt lgkmcnt(9)
  v_mfma_f32_16x16x32_bf16 a[228:231], a[224:227], v[108:111], a[228:231]
  s_mov_b32 m0, s69
  s_nop 0
  global_load_lds_dwordx4 v4, s[40:41]
  v_add_u32 v4, 2048, v4
  ds_read_b128 v[44:47], v6 offset:50176
  v_mfma_f32_16x16x32_bf16 a[236:239], v[108:111], v[108:111], a[236:239]
  ds_read_b128 v[48:51], v6 offset:51200
  v_mfma_f32_16x16x32_bf16 v[112:115], v[72:75], v[108:111], v[112:115]
  ds_read_b128 v[52:55], v6 offset:52224
  v_mfma_f32_16x16x32_bf16 v[116:119], v[76:79], v[108:111], v[116:119]
  ds_read_b128 v[56:59], v6 offset:53248
  v_mfma_f32_16x16x32_bf16 v[120:123], v[80:83], v[108:111], v[120:123]
  ds_read_b128 v[60:63], v6 offset:54272
  v_mfma_f32_16x16x32_bf16 v[124:127], v[84:87], v[108:111], v[124:127]
  ds_read_b128 v[64:67], v6 offset:55296
  v_mfma_f32_16x16x32_bf16 v[128:131], v[88:91], v[108:111], v[128:131]
  ds_read_b128 v[68:71], v6 offset:56320
  v_mfma_f32_16x16x32_bf16 v[132:135], v[92:95], v[108:111], v[132:135]
  s_waitcnt vmcnt(12)
  ds_read_b64_tr_b16 v[104:105], v9 offset:1024
  v_mfma_f32_16x16x32_bf16 v[136:139], v[96:99], v[108:111], v[136:139]
  ds_read_b64_tr_b16 v[106:107], v9 offset:1280
  global_load_dwordx4 a[40:43], v252, s[32:33] offset:2048
  global_load_dwordx4 a[44:47], v252, s[32:33] offset:3072
  v_add_u32 v252, 4096, v252
  s_waitcnt lgkmcnt(9)
  v_mfma_f32_16x16x32_bf16 a[228:231], a[224:227], v[100:103], a[228:231]
  s_mov_b32 m0, s64
  s_nop 0
  global_load_lds_dwordx4 v4, s[40:41]
  v_add_u32 v4, 2048, v4
  ds_read_b128 v[72:75], v7 offset:0
  v_mfma_f32_16x16x32_bf16 a[236:239], v[100:103], v[100:103], a[236:239]
  ds_read_b128 v[76:79], v7 offset:1024
  v_mfma_f32_16x16x32_bf16 v[112:115], v[16:19], v[100:103], v[112:115]
  ds_read_b128 v[80:83], v7 offset:2048
  v_mfma_f32_16x16x32_bf16 v[116:119], v[20:23], v[100:103], v[116:119]
  ds_read_b128 v[84:87], v7 offset:3072
  v_mfma_f32_16x16x32_bf16 v[120:123], v[24:27], v[100:103], v[120:123]
  ds_read_b128 v[88:91], v7 offset:4096
  v_mfma_f32_16x16x32_bf16 v[124:127], v[28:31], v[100:103], v[124:127]
  ds_read_b128 v[92:95], v7 offset:5120
  v_mfma_f32_16x16x32_bf16 v[128:131], v[32:35], v[100:103], v[128:131]
  ds_read_b128 v[96:99], v7 offset:6144
  v_mfma_f32_16x16x32_bf16 v[132:135], v[36:39], v[100:103], v[132:135]
  s_waitcnt vmcnt(12)
  ds_read_b64_tr_b16 v[108:109], v9 offset:2048
  v_mfma_f32_16x16x32_bf16 v[136:139], v[40:43], v[100:103], v[136:139]
  ds_read_b64_tr_b16 v[110:111], v9 offset:2304
  global_load_dwordx4 a[48:51], v252, s[32:33] offset:0
  global_load_dwordx4 a[52:55], v252, s[32:33] offset:1024
  s_waitcnt lgkmcnt(9)
  v_mfma_f32_16x16x32_bf16 a[228:231], a[224:227], v[104:107], a[228:231]
  s_mov_b32 m0, s65
  s_nop 0
  global_load_lds_dwordx4 v4, s[40:41]
  v_add_u32 v4, 2048, v4
  ds_read_b128 v[16:19], v7 offset:7168
  v_mfma_f32_16x16x32_bf16 a[236:239], v[104:107], v[104:107], a[236:239]
  ds_read_b128 v[20:23], v7 offset:8192
  v_mfma_f32_16x16x32_bf16 v[112:115], v[44:47], v[104:107], v[112:115]
  ds_read_b128 v[24:27], v7 offset:9216
  v_mfma_f32_16x16x32_bf16 v[116:119], v[48:51], v[104:107], v[116:119]
  ds_read_b128 v[28:31], v7 offset:10240
  v_mfma_f32_16x16x32_bf16 v[120:123], v[52:55], v[104:107], v[120:123]
  ds_read_b128 v[32:35], v7 offset:11264
  v_mfma_f32_16x16x32_bf16 v[124:127], v[56:59], v[104:107], v[124:127]
  ds_read_b128 v[36:39], v7 offset:12288
  v_mfma_f32_16x16x32_bf16 v[128:131], v[60:63], v[104:107], v[128:131]
  ds_read_b128 v[40:43], v7 offset:13312
  v_mfma_f32_16x16x32_bf16 v[132:135], v[64:67], v[104:107], v[132:135]
  s_waitcnt vmcnt(12)
  ds_read_b64_tr_b16 v[100:101], v9 offset:3072
  v_mfma_f32_16x16x32_bf16 v[136:139], v[68:71], v[104:107], v[136:139]
  ds_read_b64_tr_b16 v[102:103], v9 offset:3328
  global_load_dwordx4 a[56:59], v252, s[32:33] offset:2048
  global_load_dwordx4 a[60:63], v252, s[32:33] offset:3072
  v_add_u32 v252, 4096, v252
  s_waitcnt lgkmcnt(9)
  v_mfma_f32_16x16x32_bf16 a[228:231], a[224:227], v[108:111], a[228:231]
  s_mov_b32 m0, s66
  s_nop 0
  global_load_lds_dwordx4 v4, s[40:41]
  v_add_u32 v4, 2048, v4
  ds_read_b128 v[44:47], v7 offset:14336
  v_mfma_f32_16x16x32_bf16 a[236:239], v[108:111], v[108:111], a[236:239]
  ds_read_b128 v[48:51], v7 offset:15360
  v_mfma_f32_16x16x32_bf16 v[112:115], v[72:75], v[108:111], v[112:115]
  ds_read_b128 v[52:55], v7 offset:16384
  v_mfma_f32_16x16x32_bf16 v[116:119], v[76:79], v[108:111], v[116:119]
  ds_read_b128 v[56:59], v7 offset:17408
  v_mfma_f32_16x16x32_bf16 v[120:123], v[80:83], v[108:111], v[120:123]
  ds_read_b128 v[60:63], v7 offset:18432
  v_mfma_f32_16x16x32_bf16 v[124:127], v[84:87], v[108:111], v[124:127]
  ds_read_b128 v[64:67], v7 offset:19456
  v_mfma_f32_16x16x32_bf16 v[128:131], v[88:91], v[108:111], v[128:131]
  ds_read_b128 v[68:71], v7 offset:20480
  v_mfma_f32_16x16x32_bf16 v[132:135], v[92:95], v[108:111], v[132:135]
  s_waitcnt vmcnt(12)
  ds_read_b64_tr_b16 v[104:105], v9 offset:4096
  v_mfma_f32_16x16x32_bf16 v[136:139], v[96:99], v[108:111], v[136:139]
  ds_read_b64_tr_b16 v[106:107], v9 offset:4352
  global_load_dwordx4 a[64:67], v252, s[32:33] offset:0
  global_load_dwordx4 a[68:71], v252, s[32:33] offset:1024
  s_waitcnt lgkmcnt(9)
  v_mfma_f32_16x16x32_bf16 a[228:231], a[224:227], v[100:103], a[228:231]
  s_mov_b32 m0, s67
  s_nop 0
  global_load_lds_dwordx4 v4, s[40:41]
  v_add_u32 v4, 1017856, v4
  ds_read_b128 v[72:75], v7 offset:21504
  v_mfma_f32_16x16x32_bf16 a[236:239], v[100:103], v[100:103], a[236:239]
  ds_read_b128 v[76:79], v7 offset:22528
  v_mfma_f32_16x16x32_bf16 v[112:115], v[16:19], v[100:103], v[112:115]
  ds_read_b128 v[80:83], v7 offset:23552
  v_mfma_f32_16x16x32_bf16 v[116:119], v[20:23], v[100:103], v[116:119]
  ds_read_b128 v[84:87], v7 offset:24576
  v_mfma_f32_16x16x32_bf16 v[120:123], v[24:27], v[100:103], v[120:123]
  ds_read_b128 v[88:91], v7 offset:25600
  v_mfma_f32_16x16x32_bf16 v[124:127], v[28:31], v[100:103], v[124:127]
  ds_read_b128 v[92:95], v7 offset:26624
  v_mfma_f32_16x16x32_bf16 v[128:131], v[32:35], v[100:103], v[128:131]
  ds_read_b128 v[96:99], v7 offset:27648
  v_mfma_f32_16x16x32_bf16 v[132:135], v[36:39], v[100:103], v[132:135]
  s_waitcnt vmcnt(12)
  ds_read_b64_tr_b16 v[108:109], v9 offset:5120
  v_mfma_f32_16x16x32_bf16 v[136:139], v[40:43], v[100:103], v[136:139]
  ds_read_b64_tr_b16 v[110:111], v9 offset:5376
  global_load_dwordx4 a[72:75], v252, s[32:33] offset:2048
  global_load_dwordx4 a[76:79], v252, s[32:33] offset:3072
  v_add_u32 v252, 4096, v252
  s_waitcnt lgkmcnt(9)
  v_mfma_f32_16x16x32_bf16 a[228:231], a[224:227], v[104:107], a[228:231]
  ds_read_b128 v[16:19], v7 offset:28672
  ds_read_b128 v[20:23], v7 offset:29696
  v_mfma_f32_16x16x32_bf16 a[236:239], v[104:107], v[104:107], a[236:239]
  ds_read_b128 v[24:27], v7 offset:30720
  v_mfma_f32_16x16x32_bf16 v[112:115], v[44:47], v[104:107], v[112:115]
  ds_read_b128 v[28:31], v7 offset:31744
  v_mfma_f32_16x16x32_bf16 v[116:119], v[48:51], v[104:107], v[116:119]
  ds_read_b128 v[32:35], v7 offset:32768
  v_mfma_f32_16x16x32_bf16 v[120:123], v[52:55], v[104:107], v[120:123]
  ds_read_b128 v[36:39], v7 offset:33792
  v_mfma_f32_16x16x32_bf16 v[124:127], v[56:59], v[104:107], v[124:127]
  ds_read_b128 v[40:43], v7 offset:34816
  v_mfma_f32_16x16x32_bf16 v[128:131], v[60:63], v[104:107], v[128:131]
  s_waitcnt vmcnt(11)
  ds_read_b64_tr_b16 v[100:101], v9 offset:0
  v_mfma_f32_16x16x32_bf16 v[132:135], v[64:67], v[104:107], v[132:135]
  ds_read_b64_tr_b16 v[102:103], v9 offset:256
  v_mfma_f32_16x16x32_bf16 v[136:139], v[68:71], v[104:107], v[136:139]
  global_load_dwordx4 a[80:83], v252, s[32:33] offset:0
  global_load_dwordx4 a[84:87], v252, s[32:33] offset:1024
  s_waitcnt lgkmcnt(9)
  v_mfma_f32_16x16x32_bf16 a[228:231], a[224:227], v[108:111], a[228:231]
  ds_read_b128 v[44:47], v7 offset:35840
  ds_read_b128 v[48:51], v7 offset:36864
  v_mfma_f32_16x16x32_bf16 a[236:239], v[108:111], v[108:111], a[236:239]
  ds_read_b128 v[52:55], v7 offset:37888
  v_mfma_f32_16x16x32_bf16 v[112:115], v[72:75], v[108:111], v[112:115]
  ds_read_b128 v[56:59], v7 offset:38912
  v_mfma_f32_16x16x32_bf16 v[116:119], v[76:79], v[108:111], v[116:119]
  ds_read_b128 v[60:63], v7 offset:39936
  v_mfma_f32_16x16x32_bf16 v[120:123], v[80:83], v[108:111], v[120:123]
  ds_read_b128 v[64:67], v7 offset:40960
  v_mfma_f32_16x16x32_bf16 v[124:127], v[84:87], v[108:111], v[124:127]
  ds_read_b128 v[68:71], v7 offset:41984
  v_mfma_f32_16x16x32_bf16 v[128:131], v[88:91], v[108:111], v[128:131]
  s_waitcnt vmcnt(10)
  ds_read_b64_tr_b16 v[104:105], v9 offset:1024
  v_mfma_f32_16x16x32_bf16 v[132:135], v[92:95], v[108:111], v[132:135]
  ds_read_b64_tr_b16 v[106:107], v9 offset:1280
  v_mfma_f32_16x16x32_bf16 v[136:139], v[96:99], v[108:111], v[136:139]
  global_load_dwordx4 a[88:91], v252, s[32:33] offset:2048
  global_load_dwordx4 a[92:95], v252, s[32:33] offset:3072
  v_add_u32 v252, 4096, v252
  s_waitcnt lgkmcnt(9)
  v_mfma_f32_16x16x32_bf16 a[228:231], a[224:227], v[100:103], a[228:231]
  ds_read_b128 v[72:75], v7 offset:43008
  ds_read_b128 v[76:79], v7 offset:44032
  v_mfma_f32_16x16x32_bf16 a[236:239], v[100:103], v[100:103], a[236:239]
  ds_read_b128 v[80:83], v7 offset:45056
  v_mfma_f32_16x16x32_bf16 v[112:115], v[16:19], v[100:103], v[112:115]
  ds_read_b128 v[84:87], v7 offset:46080
  v_mfma_f32_16x16x32_bf16 v[116:119], v[20:23], v[100:103], v[116:119]
  ds_read_b128 v[88:91], v7 offset:47104
  v_mfma_f32_16x16x32_bf16 v[120:123], v[24:27], v[100:103], v[120:123]
  ds_read_b128 v[92:95], v7 offset:48128
  v_mfma_f32_16x16x32_bf16 v[124:127], v[28:31], v[100:103], v[124:127]
  ds_read_b128 v[96:99], v7 offset:49152
  v_mfma_f32_16x16x32_bf16 v[128:131], v[32:35], v[100:103], v[128:131]
  s_waitcnt vmcnt(9)
  ds_read_b64_tr_b16 v[108:109], v9 offset:2048
  v_mfma_f32_16x16x32_bf16 v[132:135], v[36:39], v[100:103], v[132:135]
  ds_read_b64_tr_b16 v[110:111], v9 offset:2304
  v_mfma_f32_16x16x32_bf16 v[136:139], v[40:43], v[100:103], v[136:139]
  global_load_dwordx4 a[96:99], v252, s[32:33] offset:0
  global_load_dwordx4 a[100:103], v252, s[32:33] offset:1024
  s_waitcnt lgkmcnt(9)
  s_cmp_lg_u32 s34, 0
  s_cbranch_scc1 w0_17
  v_lshlrev_b32 v251, 8, v1
  v_add_u32 v251, 31490048, v251
  s_mov_b64 exec, 0xffff
  global_load_dword v11, v251, s[32:33] sc1
  s_mov_b64 exec, -1
  s_nop 3

w0_17:
  v_mfma_f32_16x16x32_bf16 a[228:231], a[224:227], v[104:107], a[228:231]
  ds_read_b128 v[16:19], v7 offset:50176
  ds_read_b128 v[20:23], v7 offset:51200
  v_mfma_f32_16x16x32_bf16 a[236:239], v[104:107], v[104:107], a[236:239]
  ds_read_b128 v[24:27], v7 offset:52224
  v_mfma_f32_16x16x32_bf16 v[112:115], v[44:47], v[104:107], v[112:115]
  ds_read_b128 v[28:31], v7 offset:53248
  v_mfma_f32_16x16x32_bf16 v[116:119], v[48:51], v[104:107], v[116:119]
  ds_read_b128 v[32:35], v7 offset:54272
  v_mfma_f32_16x16x32_bf16 v[120:123], v[52:55], v[104:107], v[120:123]
  ds_read_b128 v[36:39], v7 offset:55296
  v_mfma_f32_16x16x32_bf16 v[124:127], v[56:59], v[104:107], v[124:127]
  ds_read_b128 v[40:43], v7 offset:56320
  v_mfma_f32_16x16x32_bf16 v[128:131], v[60:63], v[104:107], v[128:131]
  s_waitcnt vmcnt(8)
  ds_read_b64_tr_b16 v[100:101], v9 offset:3072
  v_mfma_f32_16x16x32_bf16 v[132:135], v[64:67], v[104:107], v[132:135]
  ds_read_b64_tr_b16 v[102:103], v9 offset:3328
  v_mfma_f32_16x16x32_bf16 v[136:139], v[68:71], v[104:107], v[136:139]
  global_load_dwordx4 a[104:107], v252, s[32:33] offset:2048
  global_load_dwordx4 a[108:111], v252, s[32:33] offset:3072
  v_add_u32 v252, 4096, v252
  s_waitcnt lgkmcnt(9)
  v_mfma_f32_16x16x32_bf16 a[228:231], a[224:227], v[108:111], a[228:231]
  ds_read_b128 v[160:163], v13 offset:0
  ds_read_b128 v[164:167], v13 offset:448
  v_mfma_f32_16x16x32_bf16 a[236:239], v[108:111], v[108:111], a[236:239]
  ds_read_b128 v[168:171], v13 offset:64
  v_mfma_f32_16x16x32_bf16 v[112:115], v[72:75], v[108:111], v[112:115]
  ds_read_b128 v[172:175], v13 offset:512
  v_mfma_f32_16x16x32_bf16 v[116:119], v[76:79], v[108:111], v[116:119]
  v_mfma_f32_16x16x32_bf16 v[120:123], v[80:83], v[108:111], v[120:123]
  v_mfma_f32_16x16x32_bf16 v[124:127], v[84:87], v[108:111], v[124:127]
  v_mfma_f32_16x16x32_bf16 v[128:131], v[88:91], v[108:111], v[128:131]
  v_mfma_f32_16x16x32_bf16 v[132:135], v[92:95], v[108:111], v[132:135]
  v_mfma_f32_16x16x32_bf16 v[136:139], v[96:99], v[108:111], v[136:139]
  global_load_dwordx4 a[112:115], v252, s[32:33] offset:0
  global_load_dwordx4 a[116:119], v252, s[32:33] offset:1024
  s_waitcnt lgkmcnt(4)
  v_mfma_f32_16x16x32_bf16 a[228:231], a[224:227], v[100:103], a[228:231]
  v_mfma_f32_16x16x32_bf16 a[236:239], v[100:103], v[100:103], a[236:239]
  v_mfma_f32_16x16x32_bf16 v[112:115], v[16:19], v[100:103], v[112:115]
  v_mfma_f32_16x16x32_bf16 v[116:119], v[20:23], v[100:103], v[116:119]
  v_mfma_f32_16x16x32_bf16 v[120:123], v[24:27], v[100:103], v[120:123]
  v_mfma_f32_16x16x32_bf16 v[124:127], v[28:31], v[100:103], v[124:127]
  v_mfma_f32_16x16x32_bf16 v[128:131], v[32:35], v[100:103], v[128:131]
  v_mfma_f32_16x16x32_bf16 v[132:135], v[36:39], v[100:103], v[132:135]
  v_mfma_f32_16x16x32_bf16 v[136:139], v[40:43], v[100:103], v[136:139]
  global_load_dwordx4 a[120:123], v252, s[32:33] offset:2048
  global_load_dwordx4 a[124:127], v252, s[32:33] offset:3072
  v_add_u32 v252, 4096, v252
  s_cmp_lg_u32 s34, 0
  s_cbranch_scc1 w0_20
  s_mov_b64 exec, 0xffff
  s_waitcnt vmcnt(0)
  s_mov_b32 s93, 200000
  v_cmp_ne_u32 vcc, 16, v11
  s_cbranch_vccz gd_19
  gp_18:
  s_sleep 12
  global_load_dword v11, v251, s[32:33] sc1
  s_waitcnt vmcnt(0)
  v_cmp_ne_u32 vcc, 16, v11
  s_cbranch_vccz gd_19
  s_sub_u32 s93, s93, 1
  s_cbranch_scc0 gp_18
  gd_19:
  s_mov_b64 exec, -1

w0_20:
  s_barrier
  v_accvgpr_read_b32 v8, a228
  v_accvgpr_read_b32 v140, a236
  v_accvgpr_read_b32 v141, a237
  v_accvgpr_read_b32 v142, a238
  v_accvgpr_read_b32 v143, a239
  v_and_b32 v144, 3, v2
  v_cmp_eq_u32 vcc, 1, v144
  v_cndmask_b32 v10, v140, v141, vcc
  v_cmp_eq_u32 vcc, 2, v144
  v_cndmask_b32 v10, v10, v142, vcc
  v_cmp_eq_u32 vcc, 3, v144
  v_cndmask_b32 v10, v10, v143, vcc
  v_lshrrev_b32 v144, 2, v2
  v_cmp_eq_u32 vcc, v144, v3
  v_cndmask_b32 v10, 0, v10, vcc

  v_mov_b32 v140, v10
  s_nop 1
  v_permlane16_swap_b32 v10, v140
  s_nop 1
  s_mov_b32 m0, s68
  s_nop 0
  global_load_lds_dwordx4 v4, s[40:41]
  v_add_u32 v4, 2048, v4
  v_add_f32 v10, v10, v140
  v_mov_b32 v140, v10
  s_nop 1
  v_permlane32_swap_b32 v10, v140
  s_nop 1
  v_add_f32 v10, v10, v140
  v_mul_f32 v8, s56, v8
  v_mul_f32 v10, s56, v10
  v_fma_f32 v10, -v8, v8, v10
  v_max_f32 v10, 0, v10
  v_cvt_pk_bf16_f32 v140, v10, v10
  v_and_b32 v140, s58, v140
  v_add_f32 v140, s57, v140
  v_cvt_pk_bf16_f32 v140, v140, v140
  v_and_b32 v140, s58, v140
  v_sqrt_f32 v140, v140
  s_nop 0
  v_cvt_pk_bf16_f32 v140, v140, v140
  v_and_b32 v140, s58, v140
  v_rcp_f32 v140, v140
  s_mov_b32 m0, s69
  s_nop 0
  global_load_lds_dwordx4 v4, s[40:41]
  v_add_u32 v4, 2048, v4
  s_nop 0
  v_mul_f32 v10, v10, v140
  v_mul_f32 v10, v10, v140
  v_cvt_pk_bf16_f32 v10, v10, v10
  v_and_b32 v10, s58, v10
  v_add_f32 v10, s57, v10
  v_cvt_pk_bf16_f32 v10, v10, v10
  v_and_b32 v10, s58, v10
  v_sqrt_f32 v10, v10
  s_nop 0
  v_cvt_pk_bf16_f32 v10, v10, v10
  v_and_b32 v10, s58, v10
  v_rcp_f32 v10, v10
  s_nop 0
  v_mul_f32 v10, v10, v140
  v_mul_f32 v8, v8, v10

  s_waitcnt lgkmcnt(0)
  v_pk_fma_f32 v[140:141], v[8:9], v[164:165], v[160:161] op_sel:[0,0,0] op_sel_hi:[0,1,1] neg_lo:[1,0,0] neg_hi:[1,0,0]
  v_pk_fma_f32 v[142:143], v[8:9], v[166:167], v[162:163] op_sel:[0,0,0] op_sel_hi:[0,1,1] neg_lo:[1,0,0] neg_hi:[1,0,0]
  s_mov_b32 m0, s64
  s_nop 0
  global_load_lds_dwordx4 v4, s[40:41]
  v_add_u32 v4, 2048, v4
  v_pk_fma_f32 v[144:145], v[8:9], v[172:173], v[168:169] op_sel:[0,0,0] op_sel_hi:[0,1,1] neg_lo:[1,0,0] neg_hi:[1,0,0]
  v_pk_fma_f32 v[146:147], v[8:9], v[174:175], v[170:171] op_sel:[0,0,0] op_sel_hi:[0,1,1] neg_lo:[1,0,0] neg_hi:[1,0,0]
  ds_read_b128 v[160:163], v13 offset:128
  ds_read_b128 v[164:167], v13 offset:576
  ds_read_b128 v[168:171], v13 offset:192
  ds_read_b128 v[172:175], v13 offset:640
  v_pk_fma_f32 v[112:113], v[10:11], v[112:113], v[140:141] op_sel:[0,0,0] op_sel_hi:[0,1,1]
  v_pk_fma_f32 v[114:115], v[10:11], v[114:115], v[142:143] op_sel:[0,0,0] op_sel_hi:[0,1,1]
  v_pk_fma_f32 v[116:117], v[10:11], v[116:117], v[144:145] op_sel:[0,0,0] op_sel_hi:[0,1,1]
  v_pk_fma_f32 v[118:119], v[10:11], v[118:119], v[146:147] op_sel:[0,0,0] op_sel_hi:[0,1,1]
  v_pk_mul_f32 v[140:141], v[112:113], v[112:113]
  v_pk_mul_f32 v[142:143], v[114:115], v[114:115]
  v_pk_mul_f32 v[144:145], v[116:117], v[116:117]
  v_pk_mul_f32 v[146:147], v[118:119], v[118:119]
  v_pk_fma_f32 v[140:141], v[140:141], v[14:15], s[70:71]
  v_pk_fma_f32 v[142:143], v[142:143], v[14:15], s[70:71]
  v_pk_fma_f32 v[144:145], v[144:145], v[14:15], s[70:71]
  v_pk_fma_f32 v[146:147], v[146:147], v[14:15], s[70:71]
  v_pk_mul_f32 v[140:141], v[140:141], v[112:113]
  v_pk_mul_f32 v[142:143], v[142:143], v[114:115]
  s_mov_b32 m0, s65
  s_nop 0
  global_load_lds_dwordx4 v4, s[40:41]
  v_add_u32 v4, 2048, v4
  v_pk_mul_f32 v[144:145], v[144:145], v[116:117]
  v_pk_mul_f32 v[146:147], v[146:147], v[118:119]
  v_exp_f32 v140, v140
  v_exp_f32 v141, v141
  v_exp_f32 v142, v142
  v_exp_f32 v143, v143
  v_exp_f32 v144, v144
  v_exp_f32 v145, v145
  v_exp_f32 v146, v146
  v_exp_f32 v147, v147
  s_nop 0
  v_pk_add_f32 v[140:141], v[140:141], 1.0 op_sel_hi:[1,0]
  v_pk_add_f32 v[142:143], v[142:143], 1.0 op_sel_hi:[1,0]
  v_pk_add_f32 v[144:145], v[144:145], 1.0 op_sel_hi:[1,0]
  v_pk_add_f32 v[146:147], v[146:147], 1.0 op_sel_hi:[1,0]
  v_rcp_f32 v140, v140
  v_rcp_f32 v141, v141
  v_rcp_f32 v142, v142
  v_rcp_f32 v143, v143
  v_rcp_f32 v144, v144
  s_mov_b32 m0, s66
  s_nop 0
  global_load_lds_dwordx4 v4, s[40:41]
  v_add_u32 v4, 2048, v4
  v_rcp_f32 v145, v145
  v_rcp_f32 v146, v146
  v_rcp_f32 v147, v147
  s_nop 0
  v_pk_mul_f32 v[112:113], v[112:113], v[140:141]
  v_pk_mul_f32 v[114:115], v[114:115], v[142:143]
  v_pk_mul_f32 v[116:117], v[116:117], v[144:145]
  v_pk_mul_f32 v[118:119], v[118:119], v[146:147]
  v_cvt_pk_bf16_f32 v148, v112, v113
  v_cvt_pk_bf16_f32 v149, v114, v115
  v_cvt_pk_bf16_f32 v150, v116, v117
  v_cvt_pk_bf16_f32 v151, v118, v119
  s_nop 1
  v_permlane16_swap_b32 v148, v150
  v_permlane16_swap_b32 v149, v151
  s_nop 1
  global_store_dwordx4 v5, v[148:151], s[42:43] sc1
  v_add_u32 v5, 0x20000, v5

  s_waitcnt lgkmcnt(0)
  s_mov_b32 m0, s67
  s_nop 0
  global_load_lds_dwordx4 v4, s[40:41]
  v_add_u32 v4, 2048, v4
  v_pk_fma_f32 v[140:141], v[8:9], v[164:165], v[160:161] op_sel:[0,0,0] op_sel_hi:[0,1,1] neg_lo:[1,0,0] neg_hi:[1,0,0]
  v_pk_fma_f32 v[142:143], v[8:9], v[166:167], v[162:163] op_sel:[0,0,0] op_sel_hi:[0,1,1] neg_lo:[1,0,0] neg_hi:[1,0,0]
  v_pk_fma_f32 v[144:145], v[8:9], v[172:173], v[168:169] op_sel:[0,0,0] op_sel_hi:[0,1,1] neg_lo:[1,0,0] neg_hi:[1,0,0]
  v_pk_fma_f32 v[146:147], v[8:9], v[174:175], v[170:171] op_sel:[0,0,0] op_sel_hi:[0,1,1] neg_lo:[1,0,0] neg_hi:[1,0,0]
  ds_read_b128 v[160:163], v13 offset:256
  ds_read_b128 v[164:167], v13 offset:704
  ds_read_b128 v[168:171], v13 offset:320
  ds_read_b128 v[172:175], v13 offset:768
  v_pk_fma_f32 v[120:121], v[10:11], v[120:121], v[140:141] op_sel:[0,0,0] op_sel_hi:[0,1,1]
  v_pk_fma_f32 v[122:123], v[10:11], v[122:123], v[142:143] op_sel:[0,0,0] op_sel_hi:[0,1,1]
  v_pk_fma_f32 v[124:125], v[10:11], v[124:125], v[144:145] op_sel:[0,0,0] op_sel_hi:[0,1,1]
  v_pk_fma_f32 v[126:127], v[10:11], v[126:127], v[146:147] op_sel:[0,0,0] op_sel_hi:[0,1,1]
  v_pk_mul_f32 v[140:141], v[120:121], v[120:121]
  v_pk_mul_f32 v[142:143], v[122:123], v[122:123]
  v_pk_mul_f32 v[144:145], v[124:125], v[124:125]
  v_pk_mul_f32 v[146:147], v[126:127], v[126:127]
  v_pk_fma_f32 v[140:141], v[140:141], v[14:15], s[70:71]
  v_pk_fma_f32 v[142:143], v[142:143], v[14:15], s[70:71]
  v_pk_fma_f32 v[144:145], v[144:145], v[14:15], s[70:71]
  v_pk_fma_f32 v[146:147], v[146:147], v[14:15], s[70:71]
  v_pk_mul_f32 v[140:141], v[140:141], v[120:121]
  v_pk_mul_f32 v[142:143], v[142:143], v[122:123]
  v_pk_mul_f32 v[144:145], v[144:145], v[124:125]
  v_pk_mul_f32 v[146:147], v[146:147], v[126:127]
  v_exp_f32 v140, v140
  v_exp_f32 v141, v141
  v_exp_f32 v142, v142
  v_exp_f32 v143, v143
  v_exp_f32 v144, v144
  v_exp_f32 v145, v145
  v_exp_f32 v146, v146
  v_exp_f32 v147, v147
  s_nop 0
  v_pk_add_f32 v[140:141], v[140:141], 1.0 op_sel_hi:[1,0]
  v_pk_add_f32 v[142:143], v[142:143], 1.0 op_sel_hi:[1,0]
  v_pk_add_f32 v[144:145], v[144:145], 1.0 op_sel_hi:[1,0]
  v_pk_add_f32 v[146:147], v[146:147], 1.0 op_sel_hi:[1,0]
  v_rcp_f32 v140, v140
  v_rcp_f32 v141, v141
  v_rcp_f32 v142, v142
  v_rcp_f32 v143, v143
  v_rcp_f32 v144, v144
  v_rcp_f32 v145, v145
  v_rcp_f32 v146, v146
  v_rcp_f32 v147, v147
  s_nop 0
  v_pk_mul_f32 v[120:121], v[120:121], v[140:141]
  v_pk_mul_f32 v[122:123], v[122:123], v[142:143]
  v_pk_mul_f32 v[124:125], v[124:125], v[144:145]
  v_pk_mul_f32 v[126:127], v[126:127], v[146:147]
  v_cvt_pk_bf16_f32 v152, v120, v121
  v_cvt_pk_bf16_f32 v153, v122, v123
  v_cvt_pk_bf16_f32 v154, v124, v125
  v_cvt_pk_bf16_f32 v155, v126, v127
  s_nop 1
  v_permlane16_swap_b32 v152, v154
  v_permlane16_swap_b32 v153, v155
  s_nop 1
  global_store_dwordx4 v5, v[152:155], s[42:43] sc1
  v_add_u32 v5, 0x20000, v5

  s_waitcnt lgkmcnt(0)
  v_pk_fma_f32 v[140:141], v[8:9], v[164:165], v[160:161] op_sel:[0,0,0] op_sel_hi:[0,1,1] neg_lo:[1,0,0] neg_hi:[1,0,0]
  v_pk_fma_f32 v[142:143], v[8:9], v[166:167], v[162:163] op_sel:[0,0,0] op_sel_hi:[0,1,1] neg_lo:[1,0,0] neg_hi:[1,0,0]
  v_pk_fma_f32 v[144:145], v[8:9], v[172:173], v[168:169] op_sel:[0,0,0] op_sel_hi:[0,1,1] neg_lo:[1,0,0] neg_hi:[1,0,0]
  v_pk_fma_f32 v[146:147], v[8:9], v[174:175], v[170:171] op_sel:[0,0,0] op_sel_hi:[0,1,1] neg_lo:[1,0,0] neg_hi:[1,0,0]
  ds_read_b128 v[160:163], v13 offset:384
  ds_read_b128 v[164:167], v13 offset:832
  v_pk_fma_f32 v[128:129], v[10:11], v[128:129], v[140:141] op_sel:[0,0,0] op_sel_hi:[0,1,1]
  v_pk_fma_f32 v[130:131], v[10:11], v[130:131], v[142:143] op_sel:[0,0,0] op_sel_hi:[0,1,1]
  v_pk_fma_f32 v[132:133], v[10:11], v[132:133], v[144:145] op_sel:[0,0,0] op_sel_hi:[0,1,1]
  v_pk_fma_f32 v[134:135], v[10:11], v[134:135], v[146:147] op_sel:[0,0,0] op_sel_hi:[0,1,1]
  v_pk_mul_f32 v[140:141], v[128:129], v[128:129]
  v_pk_mul_f32 v[142:143], v[130:131], v[130:131]
  v_pk_mul_f32 v[144:145], v[132:133], v[132:133]
  v_pk_mul_f32 v[146:147], v[134:135], v[134:135]
  v_pk_fma_f32 v[140:141], v[140:141], v[14:15], s[70:71]
  v_pk_fma_f32 v[142:143], v[142:143], v[14:15], s[70:71]
  v_pk_fma_f32 v[144:145], v[144:145], v[14:15], s[70:71]
  v_pk_fma_f32 v[146:147], v[146:147], v[14:15], s[70:71]
  v_pk_mul_f32 v[140:141], v[140:141], v[128:129]
  v_pk_mul_f32 v[142:143], v[142:143], v[130:131]
  v_pk_mul_f32 v[144:145], v[144:145], v[132:133]
  v_pk_mul_f32 v[146:147], v[146:147], v[134:135]
  v_exp_f32 v140, v140
  v_exp_f32 v141, v141
  v_exp_f32 v142, v142
  v_exp_f32 v143, v143
  v_exp_f32 v144, v144
  v_exp_f32 v145, v145
  v_exp_f32 v146, v146
  v_exp_f32 v147, v147
  s_nop 0
  v_pk_add_f32 v[140:141], v[140:141], 1.0 op_sel_hi:[1,0]
  v_pk_add_f32 v[142:143], v[142:143], 1.0 op_sel_hi:[1,0]
  v_pk_add_f32 v[144:145], v[144:145], 1.0 op_sel_hi:[1,0]
  v_pk_add_f32 v[146:147], v[146:147], 1.0 op_sel_hi:[1,0]
  v_rcp_f32 v140, v140
  v_rcp_f32 v141, v141
  v_rcp_f32 v142, v142
  v_rcp_f32 v143, v143
  v_rcp_f32 v144, v144
  v_rcp_f32 v145, v145
  v_rcp_f32 v146, v146
  v_rcp_f32 v147, v147
  s_nop 0
  v_pk_mul_f32 v[128:129], v[128:129], v[140:141]
  v_pk_mul_f32 v[130:131], v[130:131], v[142:143]
  v_pk_mul_f32 v[132:133], v[132:133], v[144:145]
  v_pk_mul_f32 v[134:135], v[134:135], v[146:147]
  v_cvt_pk_bf16_f32 v148, v128, v129
  v_cvt_pk_bf16_f32 v149, v130, v131
  v_cvt_pk_bf16_f32 v150, v132, v133
  v_cvt_pk_bf16_f32 v151, v134, v135
  s_nop 1
  v_permlane16_swap_b32 v148, v150
  v_permlane16_swap_b32 v149, v151
  s_nop 1
  global_store_dwordx4 v5, v[148:151], s[42:43] sc1
  v_add_u32 v5, 0xfffc4000, v5

  s_waitcnt lgkmcnt(0)
  v_pk_fma_f32 v[140:141], v[8:9], v[164:165], v[160:161] op_sel:[0,0,0] op_sel_hi:[0,1,1] neg_lo:[1,0,0] neg_hi:[1,0,0]
  v_pk_fma_f32 v[142:143], v[8:9], v[166:167], v[162:163] op_sel:[0,0,0] op_sel_hi:[0,1,1] neg_lo:[1,0,0] neg_hi:[1,0,0]
  v_pk_fma_f32 v[136:137], v[10:11], v[136:137], v[140:141] op_sel:[0,0,0] op_sel_hi:[0,1,1]
  v_pk_fma_f32 v[138:139], v[10:11], v[138:139], v[142:143] op_sel:[0,0,0] op_sel_hi:[0,1,1]
  v_pk_mul_f32 v[140:141], v[136:137], v[136:137]
  v_pk_mul_f32 v[142:143], v[138:139], v[138:139]
  v_pk_fma_f32 v[140:141], v[140:141], v[14:15], s[70:71]
  v_pk_fma_f32 v[142:143], v[142:143], v[14:15], s[70:71]
  v_pk_mul_f32 v[140:141], v[140:141], v[136:137]
  v_pk_mul_f32 v[142:143], v[142:143], v[138:139]
  v_exp_f32 v140, v140
  v_exp_f32 v141, v141
  v_exp_f32 v142, v142
  v_exp_f32 v143, v143
  s_nop 0
  v_pk_add_f32 v[140:141], v[140:141], 1.0 op_sel_hi:[1,0]
  v_pk_add_f32 v[142:143], v[142:143], 1.0 op_sel_hi:[1,0]
  v_rcp_f32 v140, v140
  v_rcp_f32 v141, v141
  v_rcp_f32 v142, v142
  v_rcp_f32 v143, v143
  s_nop 0
  v_pk_mul_f32 v[136:137], v[136:137], v[140:141]
  v_pk_mul_f32 v[138:139], v[138:139], v[142:143]
  v_cvt_pk_bf16_f32 v152, v136, v137
  v_cvt_pk_bf16_f32 v153, v138, v139
  global_store_dwordx2 v12, v[152:153], s[42:43] sc1
  v_add_u32 v12, 16384, v12
  ds_read_b128 v[16:19], v6 offset:0
  ds_read_b128 v[20:23], v6 offset:1024
  ds_read_b128 v[24:27], v6 offset:2048
  ds_read_b128 v[28:31], v6 offset:3072
  ds_read_b128 v[32:35], v6 offset:4096
  ds_read_b128 v[36:39], v6 offset:5120
  ds_read_b128 v[40:43], v6 offset:6144
  s_waitcnt vmcnt(9)
  ds_read_b64_tr_b16 v[100:101], v9 offset:4096
  ds_read_b64_tr_b16 v[102:103], v9 offset:4352
  ds_read_b128 v[44:47], v6 offset:7168
  ds_read_b128 v[48:51], v6 offset:8192
  ds_read_b128 v[52:55], v6 offset:9216
  ds_read_b128 v[56:59], v6 offset:10240
  ds_read_b128 v[60:63], v6 offset:11264
  ds_read_b128 v[64:67], v6 offset:12288
  ds_read_b128 v[68:71], v6 offset:13312
  s_waitcnt vmcnt(8)
  ds_read_b64_tr_b16 v[104:105], v9 offset:5120
  ds_read_b64_tr_b16 v[106:107], v9 offset:5376
  s_waitcnt lgkmcnt(9)
  v_mfma_f32_16x16x32_bf16 a[228:231], a[224:227], v[100:103], 0
  s_mov_b32 m0, s68
  s_nop 0
  global_load_lds_dwordx4 v4, s[40:41]
  v_add_u32 v4, 2048, v4
  ds_read_b128 v[72:75], v6 offset:14336
  v_mfma_f32_16x16x32_bf16 a[236:239], v[100:103], v[100:103], 0
  ds_read_b128 v[76:79], v6 offset:15360
  v_mfma_f32_16x16x32_bf16 v[112:115], v[16:19], v[100:103], 0
  ds_read_b128 v[80:83], v6 offset:16384
  v_mfma_f32_16x16x32_bf16 v[116:119], v[20:23], v[100:103], 0
  ds_read_b128 v[84:87], v6 offset:17408
  v_mfma_f32_16x16x32_bf16 v[120:123], v[24:27], v[100:103], 0
  ds_read_b128 v[88:91], v6 offset:18432
  v_mfma_f32_16x16x32_bf16 v[124:127], v[28:31], v[100:103], 0
  ds_read_b128 v[92:95], v6 offset:19456
  v_mfma_f32_16x16x32_bf16 v[128:131], v[32:35], v[100:103], 0
  ds_read_b128 v[96:99], v6 offset:20480
  v_mfma_f32_16x16x32_bf16 v[132:135], v[36:39], v[100:103], 0
  s_waitcnt vmcnt(8)
  ds_read_b64_tr_b16 v[108:109], v9 offset:0
  v_mfma_f32_16x16x32_bf16 v[136:139], v[40:43], v[100:103], 0
  ds_read_b64_tr_b16 v[110:111], v9 offset:256
  global_load_dwordx4 a[128:131], v252, s[32:33] offset:0
  global_load_dwordx4 a[132:135], v252, s[32:33] offset:1024
  s_waitcnt lgkmcnt(9)
  v_mfma_f32_16x16x32_bf16 a[228:231], a[224:227], v[104:107], a[228:231]
  s_mov_b32 m0, s69
  s_nop 0
  global_load_lds_dwordx4 v4, s[40:41]
  v_add_u32 v4, 2048, v4
  ds_read_b128 v[16:19], v6 offset:21504
  v_mfma_f32_16x16x32_bf16 a[236:239], v[104:107], v[104:107], a[236:239]
  ds_read_b128 v[20:23], v6 offset:22528
  v_mfma_f32_16x16x32_bf16 v[112:115], v[44:47], v[104:107], v[112:115]
  ds_read_b128 v[24:27], v6 offset:23552
  v_mfma_f32_16x16x32_bf16 v[116:119], v[48:51], v[104:107], v[116:119]
  ds_read_b128 v[28:31], v6 offset:24576
  v_mfma_f32_16x16x32_bf16 v[120:123], v[52:55], v[104:107], v[120:123]
  ds_read_b128 v[32:35], v6 offset:25600
  v_mfma_f32_16x16x32_bf16 v[124:127], v[56:59], v[104:107], v[124:127]
  ds_read_b128 v[36:39], v6 offset:26624
  v_mfma_f32_16x16x32_bf16 v[128:131], v[60:63], v[104:107], v[128:131]
  ds_read_b128 v[40:43], v6 offset:27648
  v_mfma_f32_16x16x32_bf16 v[132:135], v[64:67], v[104:107], v[132:135]
  s_waitcnt vmcnt(10)
  ds_read_b64_tr_b16 v[100:101], v9 offset:1024
  v_mfma_f32_16x16x32_bf16 v[136:139], v[68:71], v[104:107], v[136:139]
  ds_read_b64_tr_b16 v[102:103], v9 offset:1280
  global_load_dwordx4 a[136:139], v252, s[32:33] offset:2048
  global_load_dwordx4 a[140:143], v252, s[32:33] offset:3072
  v_add_u32 v252, 4096, v252
  s_waitcnt lgkmcnt(9)
  v_mfma_f32_16x16x32_bf16 a[228:231], a[224:227], v[108:111], a[228:231]
  s_mov_b32 m0, s64
  s_nop 0
  global_load_lds_dwordx4 v4, s[40:41]
  v_add_u32 v4, 2048, v4
  ds_read_b128 v[44:47], v6 offset:28672
  v_mfma_f32_16x16x32_bf16 a[236:239], v[108:111], v[108:111], a[236:239]
  ds_read_b128 v[48:51], v6 offset:29696
  v_mfma_f32_16x16x32_bf16 v[112:115], v[72:75], v[108:111], v[112:115]
  ds_read_b128 v[52:55], v6 offset:30720
  v_mfma_f32_16x16x32_bf16 v[116:119], v[76:79], v[108:111], v[116:119]
  ds_read_b128 v[56:59], v6 offset:31744
  v_mfma_f32_16x16x32_bf16 v[120:123], v[80:83], v[108:111], v[120:123]
  ds_read_b128 v[60:63], v6 offset:32768
  v_mfma_f32_16x16x32_bf16 v[124:127], v[84:87], v[108:111], v[124:127]
  ds_read_b128 v[64:67], v6 offset:33792
  v_mfma_f32_16x16x32_bf16 v[128:131], v[88:91], v[108:111], v[128:131]
  ds_read_b128 v[68:71], v6 offset:34816
  v_mfma_f32_16x16x32_bf16 v[132:135], v[92:95], v[108:111], v[132:135]
  s_waitcnt vmcnt(12)
  ds_read_b64_tr_b16 v[104:105], v9 offset:2048
  v_mfma_f32_16x16x32_bf16 v[136:139], v[96:99], v[108:111], v[136:139]
  ds_read_b64_tr_b16 v[106:107], v9 offset:2304
  global_load_dwordx4 a[144:147], v252, s[32:33] offset:0
  global_load_dwordx4 a[148:151], v252, s[32:33] offset:1024
  s_waitcnt lgkmcnt(9)
  s_waitcnt vmcnt(9)
  s_barrier
  s_cmp_lg_u32 s34, 0
  s_cbranch_scc1 w0_21
  s_add_u32 s93, s92, 0
  v_mov_b32 v251, s93
  v_mov_b32 v11, 1
  s_mov_b64 exec, 1
  global_atomic_add v251, v11, s[90:91] sc1
  s_mov_b64 exec, -1
  s_nop 3

w0_21:
  v_mfma_f32_16x16x32_bf16 a[228:231], a[224:227], v[100:103], a[228:231]
  s_mov_b32 m0, s65
  s_nop 0
  global_load_lds_dwordx4 v4, s[40:41]
  v_add_u32 v4, 2048, v4
  ds_read_b128 v[72:75], v6 offset:35840
  v_mfma_f32_16x16x32_bf16 a[236:239], v[100:103], v[100:103], a[236:239]
  ds_read_b128 v[76:79], v6 offset:36864
  v_mfma_f32_16x16x32_bf16 v[112:115], v[16:19], v[100:103], v[112:115]
  ds_read_b128 v[80:83], v6 offset:37888
  v_mfma_f32_16x16x32_bf16 v[116:119], v[20:23], v[100:103], v[116:119]
  ds_read_b128 v[84:87], v6 offset:38912
  v_mfma_f32_16x16x32_bf16 v[120:123], v[24:27], v[100:103], v[120:123]
  ds_read_b128 v[88:91], v6 offset:39936
  v_mfma_f32_16x16x32_bf16 v[124:127], v[28:31], v[100:103], v[124:127]
  ds_read_b128 v[92:95], v6 offset:40960
  v_mfma_f32_16x16x32_bf16 v[128:131], v[32:35], v[100:103], v[128:131]
  ds_read_b128 v[96:99], v6 offset:41984
  v_mfma_f32_16x16x32_bf16 v[132:135], v[36:39], v[100:103], v[132:135]
  s_waitcnt vmcnt(13)
  ds_read_b64_tr_b16 v[108:109], v9 offset:3072
  v_mfma_f32_16x16x32_bf16 v[136:139], v[40:43], v[100:103], v[136:139]
  ds_read_b64_tr_b16 v[110:111], v9 offset:3328
  global_load_dwordx4 a[152:155], v252, s[32:33] offset:2048
  global_load_dwordx4 a[156:159], v252, s[32:33] offset:3072
  v_add_u32 v252, 4096, v252
  s_waitcnt lgkmcnt(9)
  v_mfma_f32_16x16x32_bf16 a[228:231], a[224:227], v[104:107], a[228:231]
  s_mov_b32 m0, s66
  s_nop 0
  global_load_lds_dwordx4 v4, s[40:41]
  v_add_u32 v4, 2048, v4
  ds_read_b128 v[16:19], v6 offset:43008
  v_mfma_f32_16x16x32_bf16 a[236:239], v[104:107], v[104:107], a[236:239]
  ds_read_b128 v[20:23], v6 offset:44032
  v_mfma_f32_16x16x32_bf16 v[112:115], v[44:47], v[104:107], v[112:115]
  ds_read_b128 v[24:27], v6 offset:45056
  v_mfma_f32_16x16x32_bf16 v[116:119], v[48:51], v[104:107], v[116:119]
  ds_read_b128 v[28:31], v6 offset:46080
  v_mfma_f32_16x16x32_bf16 v[120:123], v[52:55], v[104:107], v[120:123]
  ds_read_b128 v[32:35], v6 offset:47104
  v_mfma_f32_16x16x32_bf16 v[124:127], v[56:59], v[104:107], v[124:127]
  ds_read_b128 v[36:39], v6 offset:48128
  v_mfma_f32_16x16x32_bf16 v[128:131], v[60:63], v[104:107], v[128:131]
  ds_read_b128 v[40:43], v6 offset:49152
  v_mfma_f32_16x16x32_bf16 v[132:135], v[64:67], v[104:107], v[132:135]
  s_waitcnt vmcnt(12)
  ds_read_b64_tr_b16 v[100:101], v9 offset:4096
  v_mfma_f32_16x16x32_bf16 v[136:139], v[68:71], v[104:107], v[136:139]
  ds_read_b64_tr_b16 v[102:103], v9 offset:4352
  global_load_dwordx4 a[160:163], v252, s[32:33] offset:0
  global_load_dwordx4 a[164:167], v252, s[32:33] offset:1024
  s_waitcnt lgkmcnt(9)
  v_mfma_f32_16x16x32_bf16 a[228:231], a[224:227], v[108:111], a[228:231]
  s_mov_b32 m0, s67
  s_nop 0
  global_load_lds_dwordx4 v4, s[40:41]
  v_add_u32 v4, 2048, v4
  ds_read_b128 v[44:47], v6 offset:50176
  v_mfma_f32_16x16x32_bf16 a[236:239], v[108:111], v[108:111], a[236:239]
  ds_read_b128 v[48:51], v6 offset:51200
  v_mfma_f32_16x16x32_bf16 v[112:115], v[72:75], v[108:111], v[112:115]
  ds_read_b128 v[52:55], v6 offset:52224
  v_mfma_f32_16x16x32_bf16 v[116:119], v[76:79], v[108:111], v[116:119]
  ds_read_b128 v[56:59], v6 offset:53248
  v_mfma_f32_16x16x32_bf16 v[120:123], v[80:83], v[108:111], v[120:123]
  ds_read_b128 v[60:63], v6 offset:54272
  v_mfma_f32_16x16x32_bf16 v[124:127], v[84:87], v[108:111], v[124:127]
  ds_read_b128 v[64:67], v6 offset:55296
  v_mfma_f32_16x16x32_bf16 v[128:131], v[88:91], v[108:111], v[128:131]
  ds_read_b128 v[68:71], v6 offset:56320
  v_mfma_f32_16x16x32_bf16 v[132:135], v[92:95], v[108:111], v[132:135]
  s_waitcnt vmcnt(12)
  ds_read_b64_tr_b16 v[104:105], v9 offset:5120
  v_mfma_f32_16x16x32_bf16 v[136:139], v[96:99], v[108:111], v[136:139]
  ds_read_b64_tr_b16 v[106:107], v9 offset:5376
  global_load_dwordx4 a[168:171], v252, s[32:33] offset:2048
  global_load_dwordx4 a[172:175], v252, s[32:33] offset:3072
  v_add_u32 v252, 4096, v252
  s_waitcnt lgkmcnt(9)
  v_mfma_f32_16x16x32_bf16 a[228:231], a[224:227], v[100:103], a[228:231]
  s_mov_b32 m0, s68
  s_nop 0
  global_load_lds_dwordx4 v4, s[40:41]
  v_add_u32 v4, 2048, v4
  ds_read_b128 v[72:75], v7 offset:0
  v_mfma_f32_16x16x32_bf16 a[236:239], v[100:103], v[100:103], a[236:239]
  ds_read_b128 v[76:79], v7 offset:1024
  v_mfma_f32_16x16x32_bf16 v[112:115], v[16:19], v[100:103], v[112:115]
  ds_read_b128 v[80:83], v7 offset:2048
  v_mfma_f32_16x16x32_bf16 v[116:119], v[20:23], v[100:103], v[116:119]
  ds_read_b128 v[84:87], v7 offset:3072
  v_mfma_f32_16x16x32_bf16 v[120:123], v[24:27], v[100:103], v[120:123]
  ds_read_b128 v[88:91], v7 offset:4096
  v_mfma_f32_16x16x32_bf16 v[124:127], v[28:31], v[100:103], v[124:127]
  ds_read_b128 v[92:95], v7 offset:5120
  v_mfma_f32_16x16x32_bf16 v[128:131], v[32:35], v[100:103], v[128:131]
  ds_read_b128 v[96:99], v7 offset:6144
  v_mfma_f32_16x16x32_bf16 v[132:135], v[36:39], v[100:103], v[132:135]
  s_waitcnt vmcnt(12)
  ds_read_b64_tr_b16 v[108:109], v9 offset:0
  v_mfma_f32_16x16x32_bf16 v[136:139], v[40:43], v[100:103], v[136:139]
  ds_read_b64_tr_b16 v[110:111], v9 offset:256
  global_load_dwordx4 a[176:179], v252, s[32:33] offset:0
  global_load_dwordx4 a[180:183], v252, s[32:33] offset:1024
  s_waitcnt lgkmcnt(9)
  v_mfma_f32_16x16x32_bf16 a[228:231], a[224:227], v[104:107], a[228:231]
  s_mov_b32 m0, s69
  s_nop 0
  global_load_lds_dwordx4 v4, s[40:41]
  v_add_u32 v4, 2048, v4
  ds_read_b128 v[16:19], v7 offset:7168
  v_mfma_f32_16x16x32_bf16 a[236:239], v[104:107], v[104:107], a[236:239]
  ds_read_b128 v[20:23], v7 offset:8192
  v_mfma_f32_16x16x32_bf16 v[112:115], v[44:47], v[104:107], v[112:115]
  ds_read_b128 v[24:27], v7 offset:9216
  v_mfma_f32_16x16x32_bf16 v[116:119], v[48:51], v[104:107], v[116:119]
  ds_read_b128 v[28:31], v7 offset:10240
  v_mfma_f32_16x16x32_bf16 v[120:123], v[52:55], v[104:107], v[120:123]
  ds_read_b128 v[32:35], v7 offset:11264
  v_mfma_f32_16x16x32_bf16 v[124:127], v[56:59], v[104:107], v[124:127]
  ds_read_b128 v[36:39], v7 offset:12288
  v_mfma_f32_16x16x32_bf16 v[128:131], v[60:63], v[104:107], v[128:131]
  ds_read_b128 v[40:43], v7 offset:13312
  v_mfma_f32_16x16x32_bf16 v[132:135], v[64:67], v[104:107], v[132:135]
  s_waitcnt vmcnt(12)
  ds_read_b64_tr_b16 v[100:101], v9 offset:1024
  v_mfma_f32_16x16x32_bf16 v[136:139], v[68:71], v[104:107], v[136:139]
  ds_read_b64_tr_b16 v[102:103], v9 offset:1280
  global_load_dwordx4 a[184:187], v252, s[32:33] offset:2048
  global_load_dwordx4 a[188:191], v252, s[32:33] offset:3072
  v_add_u32 v252, 4096, v252
  s_waitcnt lgkmcnt(9)
  v_mfma_f32_16x16x32_bf16 a[228:231], a[224:227], v[108:111], a[228:231]
  s_mov_b32 m0, s64
  s_nop 0
  global_load_lds_dwordx4 v4, s[40:41]
  v_add_u32 v4, 2048, v4
  ds_read_b128 v[44:47], v7 offset:14336
  v_mfma_f32_16x16x32_bf16 a[236:239], v[108:111], v[108:111], a[236:239]
  ds_read_b128 v[48:51], v7 offset:15360
  v_mfma_f32_16x16x32_bf16 v[112:115], v[72:75], v[108:111], v[112:115]
  ds_read_b128 v[52:55], v7 offset:16384
  v_mfma_f32_16x16x32_bf16 v[116:119], v[76:79], v[108:111], v[116:119]
  ds_read_b128 v[56:59], v7 offset:17408
  v_mfma_f32_16x16x32_bf16 v[120:123], v[80:83], v[108:111], v[120:123]
  ds_read_b128 v[60:63], v7 offset:18432
  v_mfma_f32_16x16x32_bf16 v[124:127], v[84:87], v[108:111], v[124:127]
  ds_read_b128 v[64:67], v7 offset:19456
  v_mfma_f32_16x16x32_bf16 v[128:131], v[88:91], v[108:111], v[128:131]
  ds_read_b128 v[68:71], v7 offset:20480
  v_mfma_f32_16x16x32_bf16 v[132:135], v[92:95], v[108:111], v[132:135]
  s_waitcnt vmcnt(12)
  ds_read_b64_tr_b16 v[104:105], v9 offset:2048
  v_mfma_f32_16x16x32_bf16 v[136:139], v[96:99], v[108:111], v[136:139]
  ds_read_b64_tr_b16 v[106:107], v9 offset:2304
  global_load_dwordx4 a[192:195], v252, s[32:33] offset:0
  global_load_dwordx4 a[196:199], v252, s[32:33] offset:1024
  s_waitcnt lgkmcnt(9)
  v_mfma_f32_16x16x32_bf16 a[228:231], a[224:227], v[100:103], a[228:231]
  s_mov_b32 m0, s65
  s_nop 0
  global_load_lds_dwordx4 v4, s[40:41]
  v_add_u32 v4, 1017856, v4
  ds_read_b128 v[72:75], v7 offset:21504
  v_mfma_f32_16x16x32_bf16 a[236:239], v[100:103], v[100:103], a[236:239]
  ds_read_b128 v[76:79], v7 offset:22528
  v_mfma_f32_16x16x32_bf16 v[112:115], v[16:19], v[100:103], v[112:115]
  ds_read_b128 v[80:83], v7 offset:23552
  v_mfma_f32_16x16x32_bf16 v[116:119], v[20:23], v[100:103], v[116:119]
  ds_read_b128 v[84:87], v7 offset:24576
  v_mfma_f32_16x16x32_bf16 v[120:123], v[24:27], v[100:103], v[120:123]
  ds_read_b128 v[88:91], v7 offset:25600
  v_mfma_f32_16x16x32_bf16 v[124:127], v[28:31], v[100:103], v[124:127]
  ds_read_b128 v[92:95], v7 offset:26624
  v_mfma_f32_16x16x32_bf16 v[128:131], v[32:35], v[100:103], v[128:131]
  ds_read_b128 v[96:99], v7 offset:27648
  v_mfma_f32_16x16x32_bf16 v[132:135], v[36:39], v[100:103], v[132:135]
  s_waitcnt vmcnt(12)
  ds_read_b64_tr_b16 v[108:109], v9 offset:3072
  v_mfma_f32_16x16x32_bf16 v[136:139], v[40:43], v[100:103], v[136:139]
  ds_read_b64_tr_b16 v[110:111], v9 offset:3328
  global_load_dwordx4 a[200:203], v252, s[32:33] offset:2048
  global_load_dwordx4 a[204:207], v252, s[32:33] offset:3072
  v_add_u32 v252, 4096, v252
  s_waitcnt lgkmcnt(9)
  v_mfma_f32_16x16x32_bf16 a[228:231], a[224:227], v[104:107], a[228:231]
  ds_read_b128 v[16:19], v7 offset:28672
  ds_read_b128 v[20:23], v7 offset:29696
  v_mfma_f32_16x16x32_bf16 a[236:239], v[104:107], v[104:107], a[236:239]
  ds_read_b128 v[24:27], v7 offset:30720
  v_mfma_f32_16x16x32_bf16 v[112:115], v[44:47], v[104:107], v[112:115]
  ds_read_b128 v[28:31], v7 offset:31744
  v_mfma_f32_16x16x32_bf16 v[116:119], v[48:51], v[104:107], v[116:119]
  ds_read_b128 v[32:35], v7 offset:32768
  v_mfma_f32_16x16x32_bf16 v[120:123], v[52:55], v[104:107], v[120:123]
  ds_read_b128 v[36:39], v7 offset:33792
  v_mfma_f32_16x16x32_bf16 v[124:127], v[56:59], v[104:107], v[124:127]
  ds_read_b128 v[40:43], v7 offset:34816
  v_mfma_f32_16x16x32_bf16 v[128:131], v[60:63], v[104:107], v[128:131]
  s_waitcnt vmcnt(11)
  ds_read_b64_tr_b16 v[100:101], v9 offset:4096
  v_mfma_f32_16x16x32_bf16 v[132:135], v[64:67], v[104:107], v[132:135]
  ds_read_b64_tr_b16 v[102:103], v9 offset:4352
  v_mfma_f32_16x16x32_bf16 v[136:139], v[68:71], v[104:107], v[136:139]
  global_load_dwordx4 a[208:211], v252, s[32:33] offset:0
  global_load_dwordx4 a[212:215], v252, s[32:33] offset:1024
  s_waitcnt lgkmcnt(9)
  v_mfma_f32_16x16x32_bf16 a[228:231], a[224:227], v[108:111], a[228:231]
  ds_read_b128 v[44:47], v7 offset:35840
  ds_read_b128 v[48:51], v7 offset:36864
  v_mfma_f32_16x16x32_bf16 a[236:239], v[108:111], v[108:111], a[236:239]
  ds_read_b128 v[52:55], v7 offset:37888
  v_mfma_f32_16x16x32_bf16 v[112:115], v[72:75], v[108:111], v[112:115]
  ds_read_b128 v[56:59], v7 offset:38912
  v_mfma_f32_16x16x32_bf16 v[116:119], v[76:79], v[108:111], v[116:119]
  ds_read_b128 v[60:63], v7 offset:39936
  v_mfma_f32_16x16x32_bf16 v[120:123], v[80:83], v[108:111], v[120:123]
  ds_read_b128 v[64:67], v7 offset:40960
  v_mfma_f32_16x16x32_bf16 v[124:127], v[84:87], v[108:111], v[124:127]
  ds_read_b128 v[68:71], v7 offset:41984
  v_mfma_f32_16x16x32_bf16 v[128:131], v[88:91], v[108:111], v[128:131]
  s_waitcnt vmcnt(10)
  ds_read_b64_tr_b16 v[104:105], v9 offset:5120
  v_mfma_f32_16x16x32_bf16 v[132:135], v[92:95], v[108:111], v[132:135]
  ds_read_b64_tr_b16 v[106:107], v9 offset:5376
  v_mfma_f32_16x16x32_bf16 v[136:139], v[96:99], v[108:111], v[136:139]
  global_load_dwordx4 a[216:219], v252, s[32:33] offset:2048
  global_load_dwordx4 a[220:223], v252, s[32:33] offset:3072
  s_waitcnt lgkmcnt(9)
  s_cmp_lg_u32 s34, 0
  s_cbranch_scc1 w0_22
  s_add_u32 s93, s92, 0
  v_mov_b32 v251, s93
  global_load_dword v11, v251, s[90:91] sc1

w0_22:
  v_mfma_f32_16x16x32_bf16 a[228:231], a[224:227], v[100:103], a[228:231]
  ds_read_b128 v[72:75], v7 offset:43008
  ds_read_b128 v[76:79], v7 offset:44032
  v_mfma_f32_16x16x32_bf16 a[236:239], v[100:103], v[100:103], a[236:239]
  ds_read_b128 v[80:83], v7 offset:45056
  v_mfma_f32_16x16x32_bf16 v[112:115], v[16:19], v[100:103], v[112:115]
  ds_read_b128 v[84:87], v7 offset:46080
  v_mfma_f32_16x16x32_bf16 v[116:119], v[20:23], v[100:103], v[116:119]
  ds_read_b128 v[88:91], v7 offset:47104
  v_mfma_f32_16x16x32_bf16 v[120:123], v[24:27], v[100:103], v[120:123]
  ds_read_b128 v[92:95], v7 offset:48128
  v_mfma_f32_16x16x32_bf16 v[124:127], v[28:31], v[100:103], v[124:127]
  ds_read_b128 v[96:99], v7 offset:49152
  v_mfma_f32_16x16x32_bf16 v[128:131], v[32:35], v[100:103], v[128:131]
  s_waitcnt vmcnt(9)
  ds_read_b64_tr_b16 v[108:109], v9 offset:0
  v_mfma_f32_16x16x32_bf16 v[132:135], v[36:39], v[100:103], v[132:135]
  ds_read_b64_tr_b16 v[110:111], v9 offset:256
  v_mfma_f32_16x16x32_bf16 v[136:139], v[40:43], v[100:103], v[136:139]
  s_waitcnt lgkmcnt(9)
  v_mfma_f32_16x16x32_bf16 a[228:231], a[224:227], v[104:107], a[228:231]
  ds_read_b128 v[16:19], v7 offset:50176
  ds_read_b128 v[20:23], v7 offset:51200
  v_mfma_f32_16x16x32_bf16 a[236:239], v[104:107], v[104:107], a[236:239]
  ds_read_b128 v[24:27], v7 offset:52224
  v_mfma_f32_16x16x32_bf16 v[112:115], v[44:47], v[104:107], v[112:115]
  ds_read_b128 v[28:31], v7 offset:53248
  v_mfma_f32_16x16x32_bf16 v[116:119], v[48:51], v[104:107], v[116:119]
  ds_read_b128 v[32:35], v7 offset:54272
  v_mfma_f32_16x16x32_bf16 v[120:123], v[52:55], v[104:107], v[120:123]
  ds_read_b128 v[36:39], v7 offset:55296
  v_mfma_f32_16x16x32_bf16 v[124:127], v[56:59], v[104:107], v[124:127]
  ds_read_b128 v[40:43], v7 offset:56320
  v_mfma_f32_16x16x32_bf16 v[128:131], v[60:63], v[104:107], v[128:131]
  s_waitcnt vmcnt(6)
  ds_read_b64_tr_b16 v[100:101], v9 offset:1024
  v_mfma_f32_16x16x32_bf16 v[132:135], v[64:67], v[104:107], v[132:135]
  ds_read_b64_tr_b16 v[102:103], v9 offset:1280
  v_mfma_f32_16x16x32_bf16 v[136:139], v[68:71], v[104:107], v[136:139]
  s_waitcnt lgkmcnt(9)
  v_mfma_f32_16x16x32_bf16 a[228:231], a[224:227], v[108:111], a[228:231]
  ds_read_b128 v[160:163], v13 offset:0
  ds_read_b128 v[164:167], v13 offset:448
  v_mfma_f32_16x16x32_bf16 a[236:239], v[108:111], v[108:111], a[236:239]
  ds_read_b128 v[168:171], v13 offset:64
  v_mfma_f32_16x16x32_bf16 v[112:115], v[72:75], v[108:111], v[112:115]
  ds_read_b128 v[172:175], v13 offset:512
  v_mfma_f32_16x16x32_bf16 v[116:119], v[76:79], v[108:111], v[116:119]
  v_mfma_f32_16x16x32_bf16 v[120:123], v[80:83], v[108:111], v[120:123]
  v_mfma_f32_16x16x32_bf16 v[124:127], v[84:87], v[108:111], v[124:127]
  v_mfma_f32_16x16x32_bf16 v[128:131], v[88:91], v[108:111], v[128:131]
  v_mfma_f32_16x16x32_bf16 v[132:135], v[92:95], v[108:111], v[132:135]
  v_mfma_f32_16x16x32_bf16 v[136:139], v[96:99], v[108:111], v[136:139]
  s_waitcnt lgkmcnt(4)
  v_mfma_f32_16x16x32_bf16 a[228:231], a[224:227], v[100:103], a[228:231]
  v_mfma_f32_16x16x32_bf16 a[236:239], v[100:103], v[100:103], a[236:239]
  v_mfma_f32_16x16x32_bf16 v[112:115], v[16:19], v[100:103], v[112:115]
  v_mfma_f32_16x16x32_bf16 v[116:119], v[20:23], v[100:103], v[116:119]
  v_mfma_f32_16x16x32_bf16 v[120:123], v[24:27], v[100:103], v[120:123]
  v_mfma_f32_16x16x32_bf16 v[124:127], v[28:31], v[100:103], v[124:127]
  v_mfma_f32_16x16x32_bf16 v[128:131], v[32:35], v[100:103], v[128:131]
  v_mfma_f32_16x16x32_bf16 v[132:135], v[36:39], v[100:103], v[132:135]
  v_mfma_f32_16x16x32_bf16 v[136:139], v[40:43], v[100:103], v[136:139]
  s_cmp_lg_u32 s34, 0
  s_cbranch_scc1 w0_25
  s_waitcnt vmcnt(0)
  s_mov_b32 s93, 200000
  v_cmp_ne_u32 vcc, 16, v11
  s_cbranch_vccz pd_24
  pl_23:
  s_sleep 4
  global_load_dword v11, v251, s[90:91] sc1
  s_waitcnt vmcnt(0)
  v_cmp_ne_u32 vcc, 16, v11
  s_cbranch_vccz pd_24
  s_sub_u32 s93, s93, 1
  s_cbranch_scc0 pl_23
  pd_24:

w0_25:
  s_barrier
  v_accvgpr_read_b32 v8, a228
  v_accvgpr_read_b32 v140, a236
  v_accvgpr_read_b32 v141, a237
  v_accvgpr_read_b32 v142, a238
  v_accvgpr_read_b32 v143, a239
  v_and_b32 v144, 3, v2
  v_cmp_eq_u32 vcc, 1, v144
  v_cndmask_b32 v10, v140, v141, vcc
  v_cmp_eq_u32 vcc, 2, v144
  global_load_dwordx4 v[240:243], v249, s[40:41]
  v_add_u32 v249, 0x100000, v249
  v_cndmask_b32 v10, v10, v142, vcc
  v_cmp_eq_u32 vcc, 3, v144
  v_cndmask_b32 v10, v10, v143, vcc
  v_lshrrev_b32 v144, 2, v2
  v_cmp_eq_u32 vcc, v144, v3
  v_cndmask_b32 v10, 0, v10, vcc

  v_mov_b32 v140, v10
  s_nop 1
  global_load_dwordx4 v[16:19], v248, s[42:43] offset:0
  v_permlane16_swap_b32 v10, v140
  s_nop 1
  v_add_f32 v10, v10, v140
  v_mov_b32 v140, v10
  s_nop 1
  v_permlane32_swap_b32 v10, v140
  s_nop 1
  v_add_f32 v10, v10, v140
  v_mul_f32 v8, s56, v8
  global_load_dwordx4 v[20:23], v248, s[42:43] offset:256
  v_add_u32 v248, 0x20000, v248
  v_mul_f32 v10, s56, v10
  v_fma_f32 v10, -v8, v8, v10
  v_max_f32 v10, 0, v10
  v_cvt_pk_bf16_f32 v140, v10, v10
  v_and_b32 v140, s58, v140
  v_add_f32 v140, s57, v140
  v_cvt_pk_bf16_f32 v140, v140, v140
  v_and_b32 v140, s58, v140
  v_sqrt_f32 v140, v140
  global_load_dwordx4 v[24:27], v248, s[42:43] offset:0
  s_nop 0
  v_cvt_pk_bf16_f32 v140, v140, v140
  v_and_b32 v140, s58, v140
  v_rcp_f32 v140, v140
  s_nop 0
  v_mul_f32 v10, v10, v140
  v_mul_f32 v10, v10, v140
  v_cvt_pk_bf16_f32 v10, v10, v10
  v_and_b32 v10, s58, v10
  global_load_dwordx4 v[28:31], v248, s[42:43] offset:256
  v_add_u32 v248, 0x20000, v248
  v_add_f32 v10, s57, v10
  v_cvt_pk_bf16_f32 v10, v10, v10
  v_and_b32 v10, s58, v10
  v_sqrt_f32 v10, v10
  s_nop 0
  v_cvt_pk_bf16_f32 v10, v10, v10
  v_and_b32 v10, s58, v10
  v_rcp_f32 v10, v10
  s_nop 0
  global_load_dwordx4 v[32:35], v248, s[42:43] offset:0
  v_mul_f32 v10, v10, v140
  v_mul_f32 v8, v8, v10

  s_waitcnt lgkmcnt(0)
  v_pk_fma_f32 v[140:141], v[8:9], v[164:165], v[160:161] op_sel:[0,0,0] op_sel_hi:[0,1,1] neg_lo:[1,0,0] neg_hi:[1,0,0]
  v_pk_fma_f32 v[142:143], v[8:9], v[166:167], v[162:163] op_sel:[0,0,0] op_sel_hi:[0,1,1] neg_lo:[1,0,0] neg_hi:[1,0,0]
  v_pk_fma_f32 v[144:145], v[8:9], v[172:173], v[168:169] op_sel:[0,0,0] op_sel_hi:[0,1,1] neg_lo:[1,0,0] neg_hi:[1,0,0]
  v_pk_fma_f32 v[146:147], v[8:9], v[174:175], v[170:171] op_sel:[0,0,0] op_sel_hi:[0,1,1] neg_lo:[1,0,0] neg_hi:[1,0,0]
  ds_read_b128 v[160:163], v13 offset:128
  global_load_dwordx4 v[36:39], v248, s[42:43] offset:256
  v_add_u32 v248, 0x20000, v248
  ds_read_b128 v[164:167], v13 offset:576
  ds_read_b128 v[168:171], v13 offset:192
  ds_read_b128 v[172:175], v13 offset:640
  v_pk_fma_f32 v[112:113], v[10:11], v[112:113], v[140:141] op_sel:[0,0,0] op_sel_hi:[0,1,1]
  v_pk_fma_f32 v[114:115], v[10:11], v[114:115], v[142:143] op_sel:[0,0,0] op_sel_hi:[0,1,1]
  v_pk_fma_f32 v[116:117], v[10:11], v[116:117], v[144:145] op_sel:[0,0,0] op_sel_hi:[0,1,1]
  v_pk_fma_f32 v[118:119], v[10:11], v[118:119], v[146:147] op_sel:[0,0,0] op_sel_hi:[0,1,1]
  v_pk_mul_f32 v[140:141], v[112:113], v[112:113]
  v_pk_mul_f32 v[142:143], v[114:115], v[114:115]
  global_load_dwordx4 v[40:43], v248, s[42:43] offset:0
  v_pk_mul_f32 v[144:145], v[116:117], v[116:117]
  v_pk_mul_f32 v[146:147], v[118:119], v[118:119]
  v_pk_fma_f32 v[140:141], v[140:141], v[14:15], s[70:71]
  v_pk_fma_f32 v[142:143], v[142:143], v[14:15], s[70:71]
  v_pk_fma_f32 v[144:145], v[144:145], v[14:15], s[70:71]
  v_pk_fma_f32 v[146:147], v[146:147], v[14:15], s[70:71]
  v_pk_mul_f32 v[140:141], v[140:141], v[112:113]
  v_pk_mul_f32 v[142:143], v[142:143], v[114:115]
  v_pk_mul_f32 v[144:145], v[144:145], v[116:117]
  global_load_dwordx4 v[44:47], v248, s[42:43] offset:256
  v_add_u32 v248, 0x20000, v248
  v_pk_mul_f32 v[146:147], v[146:147], v[118:119]
  v_exp_f32 v140, v140
  v_exp_f32 v141, v141
  v_exp_f32 v142, v142
  v_exp_f32 v143, v143
  v_exp_f32 v144, v144
  v_exp_f32 v145, v145
  v_exp_f32 v146, v146
  v_exp_f32 v147, v147
  global_load_dwordx4 v[48:51], v248, s[42:43] offset:0
  s_nop 0
  v_pk_add_f32 v[140:141], v[140:141], 1.0 op_sel_hi:[1,0]
  v_pk_add_f32 v[142:143], v[142:143], 1.0 op_sel_hi:[1,0]
  v_pk_add_f32 v[144:145], v[144:145], 1.0 op_sel_hi:[1,0]
  v_pk_add_f32 v[146:147], v[146:147], 1.0 op_sel_hi:[1,0]
  v_rcp_f32 v140, v140
  v_rcp_f32 v141, v141
  v_rcp_f32 v142, v142
  v_rcp_f32 v143, v143
  global_load_dwordx4 v[52:55], v248, s[42:43] offset:256
  v_add_u32 v248, 0x20000, v248
  v_rcp_f32 v144, v144
  v_rcp_f32 v145, v145
  v_rcp_f32 v146, v146
  v_rcp_f32 v147, v147
  s_nop 0
  v_pk_mul_f32 v[112:113], v[112:113], v[140:141]
  v_pk_mul_f32 v[114:115], v[114:115], v[142:143]
  v_pk_mul_f32 v[116:117], v[116:117], v[144:145]
  v_pk_mul_f32 v[118:119], v[118:119], v[146:147]
  global_load_dwordx4 v[56:59], v248, s[42:43] offset:0
  v_cvt_pk_bf16_f32 v148, v112, v113
  v_cvt_pk_bf16_f32 v149, v114, v115
  v_cvt_pk_bf16_f32 v150, v116, v117
  v_cvt_pk_bf16_f32 v151, v118, v119
  s_nop 1
  v_permlane16_swap_b32 v148, v150
  v_permlane16_swap_b32 v149, v151
  s_nop 1
  global_store_dwordx4 v5, v[148:151], s[42:43] sc1
  global_load_dwordx4 v[60:63], v248, s[42:43] offset:256
  v_add_u32 v248, 0x20000, v248
  v_add_u32 v5, 0x20000, v5

  s_waitcnt lgkmcnt(0)
  v_pk_fma_f32 v[140:141], v[8:9], v[164:165], v[160:161] op_sel:[0,0,0] op_sel_hi:[0,1,1] neg_lo:[1,0,0] neg_hi:[1,0,0]
  v_pk_fma_f32 v[142:143], v[8:9], v[166:167], v[162:163] op_sel:[0,0,0] op_sel_hi:[0,1,1] neg_lo:[1,0,0] neg_hi:[1,0,0]
  v_pk_fma_f32 v[144:145], v[8:9], v[172:173], v[168:169] op_sel:[0,0,0] op_sel_hi:[0,1,1] neg_lo:[1,0,0] neg_hi:[1,0,0]
  v_pk_fma_f32 v[146:147], v[8:9], v[174:175], v[170:171] op_sel:[0,0,0] op_sel_hi:[0,1,1] neg_lo:[1,0,0] neg_hi:[1,0,0]
  ds_read_b128 v[160:163], v13 offset:256
  ds_read_b128 v[164:167], v13 offset:704
  global_load_dwordx4 v[64:67], v248, s[42:43] offset:0
  ds_read_b128 v[168:171], v13 offset:320
  ds_read_b128 v[172:175], v13 offset:768
  v_pk_fma_f32 v[120:121], v[10:11], v[120:121], v[140:141] op_sel:[0,0,0] op_sel_hi:[0,1,1]
  v_pk_fma_f32 v[122:123], v[10:11], v[122:123], v[142:143] op_sel:[0,0,0] op_sel_hi:[0,1,1]
  v_pk_fma_f32 v[124:125], v[10:11], v[124:125], v[144:145] op_sel:[0,0,0] op_sel_hi:[0,1,1]
  v_pk_fma_f32 v[126:127], v[10:11], v[126:127], v[146:147] op_sel:[0,0,0] op_sel_hi:[0,1,1]
  v_pk_mul_f32 v[140:141], v[120:121], v[120:121]
  v_pk_mul_f32 v[142:143], v[122:123], v[122:123]
  v_pk_mul_f32 v[144:145], v[124:125], v[124:125]
  global_load_dwordx4 v[68:71], v248, s[42:43] offset:256
  v_add_u32 v248, 0x20000, v248
  v_pk_mul_f32 v[146:147], v[126:127], v[126:127]
  v_pk_fma_f32 v[140:141], v[140:141], v[14:15], s[70:71]
  v_pk_fma_f32 v[142:143], v[142:143], v[14:15], s[70:71]
  v_pk_fma_f32 v[144:145], v[144:145], v[14:15], s[70:71]
  v_pk_fma_f32 v[146:147], v[146:147], v[14:15], s[70:71]
  v_pk_mul_f32 v[140:141], v[140:141], v[120:121]
  v_pk_mul_f32 v[142:143], v[142:143], v[122:123]
  v_pk_mul_f32 v[144:145], v[144:145], v[124:125]
  v_pk_mul_f32 v[146:147], v[146:147], v[126:127]
  v_exp_f32 v140, v140
  v_exp_f32 v141, v141
  v_exp_f32 v142, v142
  v_exp_f32 v143, v143
  v_exp_f32 v144, v144
  v_exp_f32 v145, v145
  v_exp_f32 v146, v146
  v_exp_f32 v147, v147
  s_nop 0
  v_pk_add_f32 v[140:141], v[140:141], 1.0 op_sel_hi:[1,0]
  v_pk_add_f32 v[142:143], v[142:143], 1.0 op_sel_hi:[1,0]
  v_pk_add_f32 v[144:145], v[144:145], 1.0 op_sel_hi:[1,0]
  v_pk_add_f32 v[146:147], v[146:147], 1.0 op_sel_hi:[1,0]
  v_rcp_f32 v140, v140
  v_rcp_f32 v141, v141
  v_rcp_f32 v142, v142
  v_rcp_f32 v143, v143
  v_rcp_f32 v144, v144
  v_rcp_f32 v145, v145
  v_rcp_f32 v146, v146
  v_rcp_f32 v147, v147
  s_nop 0
  v_pk_mul_f32 v[120:121], v[120:121], v[140:141]
  v_pk_mul_f32 v[122:123], v[122:123], v[142:143]
  v_pk_mul_f32 v[124:125], v[124:125], v[144:145]
  v_pk_mul_f32 v[126:127], v[126:127], v[146:147]
  v_cvt_pk_bf16_f32 v152, v120, v121
  v_cvt_pk_bf16_f32 v153, v122, v123
  v_cvt_pk_bf16_f32 v154, v124, v125
  v_cvt_pk_bf16_f32 v155, v126, v127
  s_nop 1
  v_permlane16_swap_b32 v152, v154
  v_permlane16_swap_b32 v153, v155
  s_nop 1
  global_store_dwordx4 v5, v[152:155], s[42:43] sc1
  v_add_u32 v5, 0x20000, v5

  s_waitcnt lgkmcnt(0)
  v_pk_fma_f32 v[140:141], v[8:9], v[164:165], v[160:161] op_sel:[0,0,0] op_sel_hi:[0,1,1] neg_lo:[1,0,0] neg_hi:[1,0,0]
  v_pk_fma_f32 v[142:143], v[8:9], v[166:167], v[162:163] op_sel:[0,0,0] op_sel_hi:[0,1,1] neg_lo:[1,0,0] neg_hi:[1,0,0]
  v_pk_fma_f32 v[144:145], v[8:9], v[172:173], v[168:169] op_sel:[0,0,0] op_sel_hi:[0,1,1] neg_lo:[1,0,0] neg_hi:[1,0,0]
  v_pk_fma_f32 v[146:147], v[8:9], v[174:175], v[170:171] op_sel:[0,0,0] op_sel_hi:[0,1,1] neg_lo:[1,0,0] neg_hi:[1,0,0]
  ds_read_b128 v[160:163], v13 offset:384
  ds_read_b128 v[164:167], v13 offset:832
  v_pk_fma_f32 v[128:129], v[10:11], v[128:129], v[140:141] op_sel:[0,0,0] op_sel_hi:[0,1,1]
  v_pk_fma_f32 v[130:131], v[10:11], v[130:131], v[142:143] op_sel:[0,0,0] op_sel_hi:[0,1,1]
  v_pk_fma_f32 v[132:133], v[10:11], v[132:133], v[144:145] op_sel:[0,0,0] op_sel_hi:[0,1,1]
  v_pk_fma_f32 v[134:135], v[10:11], v[134:135], v[146:147] op_sel:[0,0,0] op_sel_hi:[0,1,1]
  v_pk_mul_f32 v[140:141], v[128:129], v[128:129]
  v_pk_mul_f32 v[142:143], v[130:131], v[130:131]
  v_pk_mul_f32 v[144:145], v[132:133], v[132:133]
  v_pk_mul_f32 v[146:147], v[134:135], v[134:135]
  v_pk_fma_f32 v[140:141], v[140:141], v[14:15], s[70:71]
  v_pk_fma_f32 v[142:143], v[142:143], v[14:15], s[70:71]
  v_pk_fma_f32 v[144:145], v[144:145], v[14:15], s[70:71]
  v_pk_fma_f32 v[146:147], v[146:147], v[14:15], s[70:71]
  v_pk_mul_f32 v[140:141], v[140:141], v[128:129]
  v_pk_mul_f32 v[142:143], v[142:143], v[130:131]
  v_pk_mul_f32 v[144:145], v[144:145], v[132:133]
  v_pk_mul_f32 v[146:147], v[146:147], v[134:135]
  v_exp_f32 v140, v140
  v_exp_f32 v141, v141
  v_exp_f32 v142, v142
  v_exp_f32 v143, v143
  v_exp_f32 v144, v144
  v_exp_f32 v145, v145
  v_exp_f32 v146, v146
  v_exp_f32 v147, v147
  s_nop 0
  v_pk_add_f32 v[140:141], v[140:141], 1.0 op_sel_hi:[1,0]
  v_pk_add_f32 v[142:143], v[142:143], 1.0 op_sel_hi:[1,0]
  v_pk_add_f32 v[144:145], v[144:145], 1.0 op_sel_hi:[1,0]
  v_pk_add_f32 v[146:147], v[146:147], 1.0 op_sel_hi:[1,0]
  v_rcp_f32 v140, v140
  v_rcp_f32 v141, v141
  v_rcp_f32 v142, v142
  v_rcp_f32 v143, v143
  v_rcp_f32 v144, v144
  v_rcp_f32 v145, v145
  v_rcp_f32 v146, v146
  v_rcp_f32 v147, v147
  s_nop 0
  v_pk_mul_f32 v[128:129], v[128:129], v[140:141]
  v_pk_mul_f32 v[130:131], v[130:131], v[142:143]
  v_pk_mul_f32 v[132:133], v[132:133], v[144:145]
  v_pk_mul_f32 v[134:135], v[134:135], v[146:147]
  v_cvt_pk_bf16_f32 v148, v128, v129
  v_cvt_pk_bf16_f32 v149, v130, v131
  v_cvt_pk_bf16_f32 v150, v132, v133
  v_cvt_pk_bf16_f32 v151, v134, v135
  s_nop 1
  v_permlane16_swap_b32 v148, v150
  v_permlane16_swap_b32 v149, v151
  s_nop 1
  global_store_dwordx4 v5, v[148:151], s[42:43] sc1
  v_add_u32 v5, 0xfffc4000, v5

  s_waitcnt lgkmcnt(0)
  v_pk_fma_f32 v[140:141], v[8:9], v[164:165], v[160:161] op_sel:[0,0,0] op_sel_hi:[0,1,1] neg_lo:[1,0,0] neg_hi:[1,0,0]
  v_pk_fma_f32 v[142:143], v[8:9], v[166:167], v[162:163] op_sel:[0,0,0] op_sel_hi:[0,1,1] neg_lo:[1,0,0] neg_hi:[1,0,0]
  v_pk_fma_f32 v[136:137], v[10:11], v[136:137], v[140:141] op_sel:[0,0,0] op_sel_hi:[0,1,1]
  v_pk_fma_f32 v[138:139], v[10:11], v[138:139], v[142:143] op_sel:[0,0,0] op_sel_hi:[0,1,1]
  v_pk_mul_f32 v[140:141], v[136:137], v[136:137]
  v_pk_mul_f32 v[142:143], v[138:139], v[138:139]
  v_pk_fma_f32 v[140:141], v[140:141], v[14:15], s[70:71]
  v_pk_fma_f32 v[142:143], v[142:143], v[14:15], s[70:71]
  v_pk_mul_f32 v[140:141], v[140:141], v[136:137]
  v_pk_mul_f32 v[142:143], v[142:143], v[138:139]
  v_exp_f32 v140, v140
  v_exp_f32 v141, v141
  v_exp_f32 v142, v142
  v_exp_f32 v143, v143
  s_nop 0
  v_pk_add_f32 v[140:141], v[140:141], 1.0 op_sel_hi:[1,0]
  v_pk_add_f32 v[142:143], v[142:143], 1.0 op_sel_hi:[1,0]
  v_rcp_f32 v140, v140
  v_rcp_f32 v141, v141
  v_rcp_f32 v142, v142
  v_rcp_f32 v143, v143
  s_nop 0
  v_pk_mul_f32 v[136:137], v[136:137], v[140:141]
  v_pk_mul_f32 v[138:139], v[138:139], v[142:143]
  v_cvt_pk_bf16_f32 v152, v136, v137
  v_cvt_pk_bf16_f32 v153, v138, v139
  global_store_dwordx2 v12, v[152:153], s[42:43] sc1
  v_add_u32 v12, 16384, v12
  v_lshlrev_b32 v112, 4, v0
  v_add_u32 v112, 151552, v112
  s_waitcnt vmcnt(18)
  ds_write_b128 v112, v[240:243]

  s_waitcnt vmcnt(16)
  v_mfma_f32_16x16x32_bf16 v[208:211], a[0:3], v[16:19], 0
  v_mfma_f32_16x16x32_bf16 v[212:215], a[0:3], v[20:23], 0
  global_load_dwordx4 v[72:75], v248, s[42:43] offset:0
  v_mfma_f32_16x16x32_bf16 v[216:219], a[4:7], v[16:19], 0
  global_load_dwordx4 v[76:79], v248, s[42:43] offset:256
  v_add_u32 v248, 0x20000, v248
  v_mfma_f32_16x16x32_bf16 v[220:223], a[4:7], v[20:23], 0
  v_mfma_f32_16x16x32_bf16 v[224:227], a[8:11], v[16:19], 0
  v_mfma_f32_16x16x32_bf16 v[228:231], a[8:11], v[20:23], 0
  v_mfma_f32_16x16x32_bf16 v[232:235], a[12:15], v[16:19], 0
  v_mfma_f32_16x16x32_bf16 v[236:239], a[12:15], v[20:23], 0
  s_waitcnt vmcnt(16)
  v_mfma_f32_16x16x32_bf16 v[208:211], a[16:19], v[24:27], v[208:211]
  v_mfma_f32_16x16x32_bf16 v[212:215], a[16:19], v[28:31], v[212:215]
  global_load_dwordx4 v[80:83], v248, s[42:43] offset:0
  v_mfma_f32_16x16x32_bf16 v[216:219], a[20:23], v[24:27], v[216:219]
  global_load_dwordx4 v[84:87], v248, s[42:43] offset:256
  v_add_u32 v248, 0x20000, v248
  v_mfma_f32_16x16x32_bf16 v[220:223], a[20:23], v[28:31], v[220:223]
  v_mfma_f32_16x16x32_bf16 v[224:227], a[24:27], v[24:27], v[224:227]
  v_mfma_f32_16x16x32_bf16 v[228:231], a[24:27], v[28:31], v[228:231]
  v_mfma_f32_16x16x32_bf16 v[232:235], a[28:31], v[24:27], v[232:235]
  v_mfma_f32_16x16x32_bf16 v[236:239], a[28:31], v[28:31], v[236:239]
  s_waitcnt vmcnt(16)
  v_mfma_f32_16x16x32_bf16 v[208:211], a[32:35], v[32:35], v[208:211]
  v_mfma_f32_16x16x32_bf16 v[212:215], a[32:35], v[36:39], v[212:215]
  global_load_dwordx4 v[88:91], v248, s[42:43] offset:0
  v_mfma_f32_16x16x32_bf16 v[216:219], a[36:39], v[32:35], v[216:219]
  global_load_dwordx4 v[92:95], v248, s[42:43] offset:256
  v_add_u32 v248, 0x20000, v248
  v_mfma_f32_16x16x32_bf16 v[220:223], a[36:39], v[36:39], v[220:223]
  v_mfma_f32_16x16x32_bf16 v[224:227], a[40:43], v[32:35], v[224:227]
  v_mfma_f32_16x16x32_bf16 v[228:231], a[40:43], v[36:39], v[228:231]
  v_mfma_f32_16x16x32_bf16 v[232:235], a[44:47], v[32:35], v[232:235]
  v_mfma_f32_16x16x32_bf16 v[236:239], a[44:47], v[36:39], v[236:239]
  s_waitcnt vmcnt(16)
  s_waitcnt vmcnt(6)
  s_barrier
  s_cmp_lg_u32 s34, 0
  s_cbranch_scc1 w0_26
  s_add_u32 s93, s92, 16384
  v_mov_b32 v251, s93
  v_mov_b32 v11, 1
  s_mov_b64 exec, 1
  global_atomic_add v251, v11, s[90:91] sc1
  s_mov_b64 exec, -1
  s_nop 3

w0_26:
  v_mfma_f32_16x16x32_bf16 v[208:211], a[48:51], v[40:43], v[208:211]
  v_mfma_f32_16x16x32_bf16 v[212:215], a[48:51], v[44:47], v[212:215]
  global_load_dwordx4 v[96:99], v248, s[42:43] offset:0
  v_mfma_f32_16x16x32_bf16 v[216:219], a[52:55], v[40:43], v[216:219]
  global_load_dwordx4 v[100:103], v248, s[42:43] offset:256
  v_add_u32 v248, 0x20000, v248
  v_mfma_f32_16x16x32_bf16 v[220:223], a[52:55], v[44:47], v[220:223]
  v_mfma_f32_16x16x32_bf16 v[224:227], a[56:59], v[40:43], v[224:227]
  v_mfma_f32_16x16x32_bf16 v[228:231], a[56:59], v[44:47], v[228:231]
  v_mfma_f32_16x16x32_bf16 v[232:235], a[60:63], v[40:43], v[232:235]
  v_mfma_f32_16x16x32_bf16 v[236:239], a[60:63], v[44:47], v[236:239]
  s_waitcnt vmcnt(16)
  v_mfma_f32_16x16x32_bf16 v[208:211], a[64:67], v[48:51], v[208:211]
  v_mfma_f32_16x16x32_bf16 v[212:215], a[64:67], v[52:55], v[212:215]
  global_load_dwordx4 v[104:107], v248, s[42:43] offset:0
  v_mfma_f32_16x16x32_bf16 v[216:219], a[68:71], v[48:51], v[216:219]
  global_load_dwordx4 v[108:111], v248, s[42:43] offset:256
  v_add_u32 v248, 0x20000, v248
  v_mfma_f32_16x16x32_bf16 v[220:223], a[68:71], v[52:55], v[220:223]
  v_mfma_f32_16x16x32_bf16 v[224:227], a[72:75], v[48:51], v[224:227]
  v_mfma_f32_16x16x32_bf16 v[228:231], a[72:75], v[52:55], v[228:231]
  v_mfma_f32_16x16x32_bf16 v[232:235], a[76:79], v[48:51], v[232:235]
  v_mfma_f32_16x16x32_bf16 v[236:239], a[76:79], v[52:55], v[236:239]
  s_waitcnt vmcnt(15)
  v_mfma_f32_16x16x32_bf16 v[208:211], a[80:83], v[56:59], v[208:211]
  v_mfma_f32_16x16x32_bf16 v[212:215], a[80:83], v[60:63], v[212:215]
  global_load_dwordx4 v[16:19], v248, s[42:43] offset:0
  v_mfma_f32_16x16x32_bf16 v[216:219], a[84:87], v[56:59], v[216:219]
  global_load_dwordx4 v[20:23], v248, s[42:43] offset:256
  v_add_u32 v248, 0x20000, v248
  v_mfma_f32_16x16x32_bf16 v[220:223], a[84:87], v[60:63], v[220:223]
  v_mfma_f32_16x16x32_bf16 v[224:227], a[88:91], v[56:59], v[224:227]
  v_mfma_f32_16x16x32_bf16 v[228:231], a[88:91], v[60:63], v[228:231]
  v_mfma_f32_16x16x32_bf16 v[232:235], a[92:95], v[56:59], v[232:235]
  v_mfma_f32_16x16x32_bf16 v[236:239], a[92:95], v[60:63], v[236:239]
  s_waitcnt vmcnt(15)
  v_mfma_f32_16x16x32_bf16 v[208:211], a[96:99], v[64:67], v[208:211]
  v_mfma_f32_16x16x32_bf16 v[212:215], a[96:99], v[68:71], v[212:215]
  global_load_dwordx4 v[24:27], v248, s[42:43] offset:0
  v_mfma_f32_16x16x32_bf16 v[216:219], a[100:103], v[64:67], v[216:219]
  global_load_dwordx4 v[28:31], v248, s[42:43] offset:256
  v_add_u32 v248, 0xffe64000, v248
  v_mfma_f32_16x16x32_bf16 v[220:223], a[100:103], v[68:71], v[220:223]
  v_mfma_f32_16x16x32_bf16 v[224:227], a[104:107], v[64:67], v[224:227]
  v_mfma_f32_16x16x32_bf16 v[228:231], a[104:107], v[68:71], v[228:231]
  v_mfma_f32_16x16x32_bf16 v[232:235], a[108:111], v[64:67], v[232:235]
  v_mfma_f32_16x16x32_bf16 v[236:239], a[108:111], v[68:71], v[236:239]
  s_waitcnt vmcnt(12)
  v_mfma_f32_16x16x32_bf16 v[208:211], a[112:115], v[72:75], v[208:211]
  v_mfma_f32_16x16x32_bf16 v[212:215], a[112:115], v[76:79], v[212:215]
  v_mfma_f32_16x16x32_bf16 v[216:219], a[116:119], v[72:75], v[216:219]
  v_mfma_f32_16x16x32_bf16 v[220:223], a[116:119], v[76:79], v[220:223]
  v_mfma_f32_16x16x32_bf16 v[224:227], a[120:123], v[72:75], v[224:227]
  v_mfma_f32_16x16x32_bf16 v[228:231], a[120:123], v[76:79], v[228:231]
  v_mfma_f32_16x16x32_bf16 v[232:235], a[124:127], v[72:75], v[232:235]
  v_mfma_f32_16x16x32_bf16 v[236:239], a[124:127], v[76:79], v[236:239]
  s_waitcnt vmcnt(10)
  v_mfma_f32_16x16x32_bf16 v[208:211], a[128:131], v[80:83], v[208:211]
  v_mfma_f32_16x16x32_bf16 v[212:215], a[128:131], v[84:87], v[212:215]
  v_mfma_f32_16x16x32_bf16 v[216:219], a[132:135], v[80:83], v[216:219]
  v_mfma_f32_16x16x32_bf16 v[220:223], a[132:135], v[84:87], v[220:223]
  v_mfma_f32_16x16x32_bf16 v[224:227], a[136:139], v[80:83], v[224:227]
  v_mfma_f32_16x16x32_bf16 v[228:231], a[136:139], v[84:87], v[228:231]
  v_mfma_f32_16x16x32_bf16 v[232:235], a[140:143], v[80:83], v[232:235]
  v_mfma_f32_16x16x32_bf16 v[236:239], a[140:143], v[84:87], v[236:239]
  s_waitcnt vmcnt(8)
  v_mfma_f32_16x16x32_bf16 v[208:211], a[144:147], v[88:91], v[208:211]
  v_mfma_f32_16x16x32_bf16 v[212:215], a[144:147], v[92:95], v[212:215]
  v_mfma_f32_16x16x32_bf16 v[216:219], a[148:151], v[88:91], v[216:219]
  v_mfma_f32_16x16x32_bf16 v[220:223], a[148:151], v[92:95], v[220:223]
  v_mfma_f32_16x16x32_bf16 v[224:227], a[152:155], v[88:91], v[224:227]
  v_mfma_f32_16x16x32_bf16 v[228:231], a[152:155], v[92:95], v[228:231]
  v_mfma_f32_16x16x32_bf16 v[232:235], a[156:159], v[88:91], v[232:235]
  v_mfma_f32_16x16x32_bf16 v[236:239], a[156:159], v[92:95], v[236:239]
  s_waitcnt vmcnt(6)
  s_cmp_lg_u32 s34, 0
  s_cbranch_scc1 w0_27
  s_add_u32 s93, s92, 16384
  v_mov_b32 v251, s93
  global_load_dword v11, v251, s[90:91] sc1

w0_27:
  v_mfma_f32_16x16x32_bf16 v[208:211], a[160:163], v[96:99], v[208:211]
  v_mfma_f32_16x16x32_bf16 v[212:215], a[160:163], v[100:103], v[212:215]
  v_mfma_f32_16x16x32_bf16 v[216:219], a[164:167], v[96:99], v[216:219]
  v_mfma_f32_16x16x32_bf16 v[220:223], a[164:167], v[100:103], v[220:223]
  v_mfma_f32_16x16x32_bf16 v[224:227], a[168:171], v[96:99], v[224:227]
  v_mfma_f32_16x16x32_bf16 v[228:231], a[168:171], v[100:103], v[228:231]
  v_mfma_f32_16x16x32_bf16 v[232:235], a[172:175], v[96:99], v[232:235]
  v_mfma_f32_16x16x32_bf16 v[236:239], a[172:175], v[100:103], v[236:239]
  s_waitcnt vmcnt(4)
  v_mfma_f32_16x16x32_bf16 v[208:211], a[176:179], v[104:107], v[208:211]
  v_mfma_f32_16x16x32_bf16 v[212:215], a[176:179], v[108:111], v[212:215]
  v_mfma_f32_16x16x32_bf16 v[216:219], a[180:183], v[104:107], v[216:219]
  v_mfma_f32_16x16x32_bf16 v[220:223], a[180:183], v[108:111], v[220:223]
  v_mfma_f32_16x16x32_bf16 v[224:227], a[184:187], v[104:107], v[224:227]
  v_mfma_f32_16x16x32_bf16 v[228:231], a[184:187], v[108:111], v[228:231]
  v_mfma_f32_16x16x32_bf16 v[232:235], a[188:191], v[104:107], v[232:235]
  v_mfma_f32_16x16x32_bf16 v[236:239], a[188:191], v[108:111], v[236:239]
  s_waitcnt vmcnt(2)
  v_mfma_f32_16x16x32_bf16 v[208:211], a[192:195], v[16:19], v[208:211]
  v_mfma_f32_16x16x32_bf16 v[212:215], a[192:195], v[20:23], v[212:215]
  v_mfma_f32_16x16x32_bf16 v[216:219], a[196:199], v[16:19], v[216:219]
  v_mfma_f32_16x16x32_bf16 v[220:223], a[196:199], v[20:23], v[220:223]
  v_mfma_f32_16x16x32_bf16 v[224:227], a[200:203], v[16:19], v[224:227]
  v_mfma_f32_16x16x32_bf16 v[228:231], a[200:203], v[20:23], v[228:231]
  v_mfma_f32_16x16x32_bf16 v[232:235], a[204:207], v[16:19], v[232:235]
  v_mfma_f32_16x16x32_bf16 v[236:239], a[204:207], v[20:23], v[236:239]
  s_waitcnt vmcnt(0)
  v_mfma_f32_16x16x32_bf16 v[208:211], a[208:211], v[24:27], v[208:211]
  v_mfma_f32_16x16x32_bf16 v[212:215], a[208:211], v[28:31], v[212:215]
  v_mfma_f32_16x16x32_bf16 v[216:219], a[212:215], v[24:27], v[216:219]
  v_mfma_f32_16x16x32_bf16 v[220:223], a[212:215], v[28:31], v[220:223]
  v_mfma_f32_16x16x32_bf16 v[224:227], a[216:219], v[24:27], v[224:227]
  v_mfma_f32_16x16x32_bf16 v[228:231], a[216:219], v[28:31], v[228:231]
  v_mfma_f32_16x16x32_bf16 v[232:235], a[220:223], v[24:27], v[232:235]
  v_mfma_f32_16x16x32_bf16 v[236:239], a[220:223], v[28:31], v[236:239]
  v_mul_u32_u24 v113, 272, v2
  v_lshl_add_u32 v113, v3, 4, v113
  s_mul_i32 s50, s34, 8704
  s_add_u32 s50, s50, 114688
  v_add_u32 v113, s50, v113
  v_and_b32 v114, 31, v1
  v_mul_u32_u24 v115, 272, v114
  v_lshrrev_b32 v116, 5, v1
  v_lshl_add_u32 v115, v116, 5, v115
  s_lshl_b32 s50, s34, 6
  s_add_u32 s50, s50, 114688
  v_add_u32 v115, s50, v115

  ds_write_b128 v113, v[208:211] offset:0
  ds_write_b128 v113, v[212:215] offset:4352
  ds_write_b128 v113, v[216:219] offset:64
  ds_write_b128 v113, v[220:223] offset:4416
  ds_write_b128 v113, v[224:227] offset:128
  ds_write_b128 v113, v[228:231] offset:4480
  ds_write_b128 v113, v[232:235] offset:192
  ds_write_b128 v113, v[236:239] offset:4544
  v_lshrrev_b32 v117, 2, v2
  v_lshl_add_u32 v117, v116, 3, v117
  v_lshlrev_b32 v117, 6, v117
  v_and_b32 v118, 1, v3
  v_lshl_add_u32 v117, v118, 5, v117
  v_and_b32 v118, 3, v2
  v_lshl_add_u32 v117, v118, 3, v117
  s_lshl_b32 s50, s34, 10
  s_add_u32 s50, s50, 151552
  v_add_u32 v117, s50, v117

  v_lshlrev_b32 v120, 16, v244
  v_and_b32 v121, s58, v244
  v_lshlrev_b32 v122, 16, v245
  v_and_b32 v123, s58, v245
  v_lshlrev_b32 v124, 16, v246
  v_and_b32 v125, s58, v246
  v_lshlrev_b32 v126, 16, v247
  v_and_b32 v127, s58, v247
  s_cmp_lg_u32 s34, 0
  s_cbranch_scc1 w0_30
  s_waitcnt vmcnt(0)
  s_mov_b32 s93, 200000
  v_cmp_ne_u32 vcc, 16, v11
  s_cbranch_vccz pd_29
  pl_28:
  s_sleep 4
  global_load_dword v11, v251, s[90:91] sc1
  s_waitcnt vmcnt(0)
  v_cmp_ne_u32 vcc, 16, v11
  s_cbranch_vccz pd_29
  s_sub_u32 s93, s93, 1
  s_cbranch_scc0 pl_28
  pd_29:

w0_30:
  s_waitcnt lgkmcnt(0)
  s_barrier
  ds_read_b128 v[128:131], v115 offset:0
  ds_read_b128 v[132:135], v115 offset:16
  ds_read_b128 v[136:139], v115 offset:8704
  ds_read_b128 v[140:143], v115 offset:8720
  ds_read_b128 v[144:147], v115 offset:17408
  ds_read_b128 v[148:151], v115 offset:17424
  ds_read_b128 v[152:155], v115 offset:26112
  ds_read_b128 v[156:159], v115 offset:26128
  ds_read_b64_tr_b16 v[160:161], v117
  ds_read_b64_tr_b16 v[162:163], v117 offset:256
  global_load_dwordx4 v[240:243], v249, s[40:41]
  v_add_u32 v249, 0x100000, v249
  global_load_dwordx4 v[16:19], v248, s[42:43] offset:0
  global_load_dwordx4 v[20:23], v248, s[42:43] offset:256
  v_add_u32 v248, 0x20000, v248
  global_load_dwordx4 v[24:27], v248, s[42:43] offset:0
  s_waitcnt lgkmcnt(0)
  s_barrier
  v_pk_add_f32 v[128:129], v[128:129], v[136:137]
  global_load_dwordx4 v[28:31], v248, s[42:43] offset:256
  v_add_u32 v248, 0x20000, v248
  v_pk_add_f32 v[144:145], v[144:145], v[152:153]
  v_pk_add_f32 v[130:131], v[130:131], v[138:139]
  v_pk_add_f32 v[146:147], v[146:147], v[154:155]
  global_load_dwordx4 v[32:35], v248, s[42:43] offset:0
  v_pk_add_f32 v[132:133], v[132:133], v[140:141]
  v_pk_add_f32 v[148:149], v[148:149], v[156:157]
  v_pk_add_f32 v[134:135], v[134:135], v[142:143]
  global_load_dwordx4 v[36:39], v248, s[42:43] offset:256
  v_add_u32 v248, 0x20000, v248
  v_pk_add_f32 v[150:151], v[150:151], v[158:159]
  v_pk_add_f32 v[128:129], v[128:129], v[144:145]
  v_pk_add_f32 v[130:131], v[130:131], v[146:147]
  global_load_dwordx4 v[40:43], v248, s[42:43] offset:0
  v_pk_add_f32 v[132:133], v[132:133], v[148:149]
  v_pk_add_f32 v[134:135], v[134:135], v[150:151]
  v_cvt_pk_bf16_f32 v164, v128, v129
  global_load_dwordx4 v[44:47], v248, s[42:43] offset:256
  v_add_u32 v248, 0x20000, v248
  v_lshlrev_b32 v128, 16, v164
  v_and_b32 v129, s58, v164
  v_pk_add_f32 v[128:129], v[128:129], v[120:121]
  global_load_dwordx4 v[48:51], v248, s[42:43] offset:0
  v_cvt_pk_bf16_f32 v164, v128, v129
  v_lshlrev_b32 v128, 16, v164
  v_and_b32 v129, s58, v164
  global_load_dwordx4 v[52:55], v248, s[42:43] offset:256
  v_add_u32 v248, 0x20000, v248
  v_lshlrev_b32 v164, 16, v160
  v_and_b32 v165, s58, v160
  v_pk_add_f32 v[128:129], v[128:129], v[164:165]
  global_load_dwordx4 v[56:59], v248, s[42:43] offset:0
  v_cvt_pk_bf16_f32 v172, v128, v129

  v_cvt_pk_bf16_f32 v166, v130, v131
  global_load_dwordx4 v[60:63], v248, s[42:43] offset:256
  v_add_u32 v248, 0x20000, v248
  v_lshlrev_b32 v130, 16, v166
  v_and_b32 v131, s58, v166
  v_pk_add_f32 v[130:131], v[130:131], v[122:123]
  global_load_dwordx4 v[64:67], v248, s[42:43] offset:0
  v_cvt_pk_bf16_f32 v166, v130, v131
  v_lshlrev_b32 v130, 16, v166
  v_and_b32 v131, s58, v166
  global_load_dwordx4 v[68:71], v248, s[42:43] offset:256
  v_add_u32 v248, 0x20000, v248
  v_lshlrev_b32 v166, 16, v161
  v_and_b32 v167, s58, v161
  v_pk_add_f32 v[130:131], v[130:131], v[166:167]
  v_cvt_pk_bf16_f32 v173, v130, v131

  v_cvt_pk_bf16_f32 v168, v132, v133
  v_lshlrev_b32 v132, 16, v168
  v_and_b32 v133, s58, v168
  v_pk_add_f32 v[132:133], v[132:133], v[124:125]
  v_cvt_pk_bf16_f32 v168, v132, v133
  v_lshlrev_b32 v132, 16, v168
  v_and_b32 v133, s58, v168
  v_lshlrev_b32 v168, 16, v162
  v_and_b32 v169, s58, v162
  v_pk_add_f32 v[132:133], v[132:133], v[168:169]
  v_cvt_pk_bf16_f32 v174, v132, v133

  v_cvt_pk_bf16_f32 v170, v134, v135
  v_lshlrev_b32 v134, 16, v170
  v_and_b32 v135, s58, v170
  v_pk_add_f32 v[134:135], v[134:135], v[126:127]
  v_cvt_pk_bf16_f32 v170, v134, v135
  v_lshlrev_b32 v134, 16, v170
  v_and_b32 v135, s58, v170
  v_lshlrev_b32 v170, 16, v163
  v_and_b32 v171, s58, v163
  v_pk_add_f32 v[134:135], v[134:135], v[170:171]
  v_cvt_pk_bf16_f32 v175, v134, v135

  s_add_u32 s52, s32, 4194304
  s_addc_u32 s53, s33, 0
  s_add_u32 s54, s32, 29425664
  s_addc_u32 s55, s33, 0
  v_bfe_u32 v118, v1, 1, 1
  v_bfe_u32 v119, v1, 3, 1
  v_lshl_or_b32 v118, v119, 1, v118
  v_xor_b32 v118, s34, v118
  v_lshlrev_b32 v118, 5, v118
  v_lshl_add_u32 v118, v114, 7, v118
  v_lshl_add_u32 v118, v116, 4, v118
  v_add_u32 v118, 114688, v118
  ds_write_b128 v118, v[172:175]
  s_mov_b32 s51, 0x3f803f80

  v_dot2_f32_bf16 v176, v172, s51, 0
  v_dot2_f32_bf16 v177, v172, v172, 0
  v_dot2_f32_bf16 v176, v173, s51, v176
  v_dot2_f32_bf16 v177, v173, v173, v177
  v_dot2_f32_bf16 v176, v174, s51, v176
  v_dot2_f32_bf16 v177, v174, v174, v177
  v_dot2_f32_bf16 v176, v175, s51, v176
  v_dot2_f32_bf16 v177, v175, v175, v177
  s_lshl_b32 s50, s34, 9
  s_add_u32 s50, s50, 159744
  v_lshlrev_b32 v118, 8, v116
  v_lshl_add_u32 v118, v114, 3, v118
  v_add_u32 v118, s50, v118
  s_nop 0
  ds_write_b64 v118, v[176:177]

  v_and_b32 v179, 15, v1
  v_lshrrev_b32 v180, 4, v1
  v_lshrrev_b32 v178, 2, v179
  v_lshl_add_u32 v178, v180, 3, v178
  v_lshlrev_b32 v178, 7, v178
  v_and_b32 v180, 1, v180
  v_lshlrev_b32 v180, 1, v180
  v_bfe_u32 v179, v1, 3, 1
  v_or_b32 v180, v180, v179
  v_xor_b32 v180, s34, v180
  v_lshl_add_u32 v178, v180, 5, v178
  v_and_b32 v179, 3, v1
  v_lshl_add_u32 v178, v179, 3, v178
  v_add_u32 v178, 114688, v178

  v_and_b32 v179, 15, v1
  s_lshl_b32 s50, s34, 4
  s_lshl_b32 s51, s49, 6
  s_add_u32 s50, s50, s51
  v_add_u32 v179, s50, v179
  v_lshlrev_b32 v181, 12, v179
  v_lshl_add_u32 v181, v3, 4, v181
  s_add_u32 s50, s48, 0
  s_lshl_b32 s51, s50, 1
  v_add_u32 v181, s51, v181
  s_waitcnt lgkmcnt(0)
  s_barrier
  ds_read_b64_tr_b16 v[184:185], v178
  ds_read_b64_tr_b16 v[186:187], v178 offset:512
  v_lshlrev_b32 v118, 3, v114
  v_add_u32 v118, 159744, v118

  ds_read_b64 v[188:189], v118 offset:0
  ds_read_b64 v[190:191], v118 offset:256
  ds_read_b64 v[192:193], v118 offset:512
  ds_read_b64 v[194:195], v118 offset:768
  ds_read_b64 v[196:197], v118 offset:1024
  ds_read_b64 v[198:199], v118 offset:1280
  ds_read_b64 v[200:201], v118 offset:1536
  ds_read_b64 v[202:203], v118 offset:1792
  v_add_u32 v118, s50, v114
  v_lshlrev_b32 v118, 2, v118
  v_add_u32 v119, 8192, v118
  s_waitcnt lgkmcnt(8)
  global_store_dwordx4 v181, v[184:187], s[52:53] sc1
  s_waitcnt lgkmcnt(0)
  v_pk_add_f32 v[188:189], v[188:189], v[190:191]
  v_pk_add_f32 v[192:193], v[192:193], v[194:195]
  v_pk_add_f32 v[196:197], v[196:197], v[198:199]
  v_pk_add_f32 v[200:201], v[200:201], v[202:203]
  v_pk_add_f32 v[188:189], v[188:189], v[192:193]
  v_pk_add_f32 v[196:197], v[196:197], v[200:201]
  v_pk_add_f32 v[188:189], v[188:189], v[196:197]

  s_cmp_lg_u32 s34, 1
  s_cbranch_scc1 g2st_31
  s_mov_b32 exec_hi, 0
  global_atomic_add_f32 v118, v188, s[54:55] sc1
  global_atomic_add_f32 v119, v189, s[54:55] sc1
  s_mov_b64 exec, -1

g2st_31:
  s_barrier
  v_lshlrev_b32 v112, 4, v0
  v_add_u32 v112, 155648, v112
  s_waitcnt vmcnt(15)
  ds_write_b128 v112, v[240:243]

  s_waitcnt vmcnt(13)
  v_mfma_f32_16x16x32_bf16 v[208:211], a[0:3], v[16:19], 0
  v_mfma_f32_16x16x32_bf16 v[212:215], a[0:3], v[20:23], 0
  global_load_dwordx4 v[72:75], v248, s[42:43] offset:0
  v_mfma_f32_16x16x32_bf16 v[216:219], a[4:7], v[16:19], 0
  global_load_dwordx4 v[76:79], v248, s[42:43] offset:256
  v_add_u32 v248, 0x20000, v248
  v_mfma_f32_16x16x32_bf16 v[220:223], a[4:7], v[20:23], 0
  v_mfma_f32_16x16x32_bf16 v[224:227], a[8:11], v[16:19], 0
  v_mfma_f32_16x16x32_bf16 v[228:231], a[8:11], v[20:23], 0
  v_mfma_f32_16x16x32_bf16 v[232:235], a[12:15], v[16:19], 0
  v_mfma_f32_16x16x32_bf16 v[236:239], a[12:15], v[20:23], 0
  s_waitcnt vmcnt(13)
  v_mfma_f32_16x16x32_bf16 v[208:211], a[16:19], v[24:27], v[208:211]
  v_mfma_f32_16x16x32_bf16 v[212:215], a[16:19], v[28:31], v[212:215]
  global_load_dwordx4 v[80:83], v248, s[42:43] offset:0
  v_mfma_f32_16x16x32_bf16 v[216:219], a[20:23], v[24:27], v[216:219]
  global_load_dwordx4 v[84:87], v248, s[42:43] offset:256
  v_add_u32 v248, 0x20000, v248
  v_mfma_f32_16x16x32_bf16 v[220:223], a[20:23], v[28:31], v[220:223]
  v_mfma_f32_16x16x32_bf16 v[224:227], a[24:27], v[24:27], v[224:227]
  v_mfma_f32_16x16x32_bf16 v[228:231], a[24:27], v[28:31], v[228:231]
  v_mfma_f32_16x16x32_bf16 v[232:235], a[28:31], v[24:27], v[232:235]
  v_mfma_f32_16x16x32_bf16 v[236:239], a[28:31], v[28:31], v[236:239]
  s_waitcnt vmcnt(13)
  v_mfma_f32_16x16x32_bf16 v[208:211], a[32:35], v[32:35], v[208:211]
  v_mfma_f32_16x16x32_bf16 v[212:215], a[32:35], v[36:39], v[212:215]
  global_load_dwordx4 v[88:91], v248, s[42:43] offset:0
  v_mfma_f32_16x16x32_bf16 v[216:219], a[36:39], v[32:35], v[216:219]
  global_load_dwordx4 v[92:95], v248, s[42:43] offset:256
  v_add_u32 v248, 0x20000, v248
  v_mfma_f32_16x16x32_bf16 v[220:223], a[36:39], v[36:39], v[220:223]
  v_mfma_f32_16x16x32_bf16 v[224:227], a[40:43], v[32:35], v[224:227]
  v_mfma_f32_16x16x32_bf16 v[228:231], a[40:43], v[36:39], v[228:231]
  v_mfma_f32_16x16x32_bf16 v[232:235], a[44:47], v[32:35], v[232:235]
  v_mfma_f32_16x16x32_bf16 v[236:239], a[44:47], v[36:39], v[236:239]
  s_waitcnt vmcnt(13)
  s_waitcnt vmcnt(6)
  s_barrier
  s_cmp_lg_u32 s34, 0
  s_cbranch_scc1 w0_32
  s_and_b32 s93, s2, 15
  s_lshl_b32 s93, s93, 8
  s_add_u32 s93, s93, 31469568
  v_mov_b32 v251, s93
  v_mov_b32 v11, 1
  s_mov_b64 exec, 1
  global_atomic_add v251, v11, s[32:33] sc1
  s_mov_b64 exec, -1
  s_nop 3

w0_32:
  v_mfma_f32_16x16x32_bf16 v[208:211], a[48:51], v[40:43], v[208:211]
  v_mfma_f32_16x16x32_bf16 v[212:215], a[48:51], v[44:47], v[212:215]
  global_load_dwordx4 v[96:99], v248, s[42:43] offset:0
  v_mfma_f32_16x16x32_bf16 v[216:219], a[52:55], v[40:43], v[216:219]
  global_load_dwordx4 v[100:103], v248, s[42:43] offset:256
  v_add_u32 v248, 0x20000, v248
  v_mfma_f32_16x16x32_bf16 v[220:223], a[52:55], v[44:47], v[220:223]
  v_mfma_f32_16x16x32_bf16 v[224:227], a[56:59], v[40:43], v[224:227]
  v_mfma_f32_16x16x32_bf16 v[228:231], a[56:59], v[44:47], v[228:231]
  v_mfma_f32_16x16x32_bf16 v[232:235], a[60:63], v[40:43], v[232:235]
  v_mfma_f32_16x16x32_bf16 v[236:239], a[60:63], v[44:47], v[236:239]
  s_waitcnt vmcnt(13)
  v_mfma_f32_16x16x32_bf16 v[208:211], a[64:67], v[48:51], v[208:211]
  v_mfma_f32_16x16x32_bf16 v[212:215], a[64:67], v[52:55], v[212:215]
  global_load_dwordx4 v[104:107], v248, s[42:43] offset:0
  v_mfma_f32_16x16x32_bf16 v[216:219], a[68:71], v[48:51], v[216:219]
  global_load_dwordx4 v[108:111], v248, s[42:43] offset:256
  v_add_u32 v248, 0x20000, v248
  v_mfma_f32_16x16x32_bf16 v[220:223], a[68:71], v[52:55], v[220:223]
  v_mfma_f32_16x16x32_bf16 v[224:227], a[72:75], v[48:51], v[224:227]
  v_mfma_f32_16x16x32_bf16 v[228:231], a[72:75], v[52:55], v[228:231]
  v_mfma_f32_16x16x32_bf16 v[232:235], a[76:79], v[48:51], v[232:235]
  v_mfma_f32_16x16x32_bf16 v[236:239], a[76:79], v[52:55], v[236:239]
  s_waitcnt vmcnt(13)
  v_mfma_f32_16x16x32_bf16 v[208:211], a[80:83], v[56:59], v[208:211]
  v_mfma_f32_16x16x32_bf16 v[212:215], a[80:83], v[60:63], v[212:215]
  global_load_dwordx4 v[16:19], v248, s[42:43] offset:0
  v_mfma_f32_16x16x32_bf16 v[216:219], a[84:87], v[56:59], v[216:219]
  global_load_dwordx4 v[20:23], v248, s[42:43] offset:256
  v_add_u32 v248, 0x20000, v248
  v_mfma_f32_16x16x32_bf16 v[220:223], a[84:87], v[60:63], v[220:223]
  v_mfma_f32_16x16x32_bf16 v[224:227], a[88:91], v[56:59], v[224:227]
  v_mfma_f32_16x16x32_bf16 v[228:231], a[88:91], v[60:63], v[228:231]
  v_mfma_f32_16x16x32_bf16 v[232:235], a[92:95], v[56:59], v[232:235]
  v_mfma_f32_16x16x32_bf16 v[236:239], a[92:95], v[60:63], v[236:239]
  s_waitcnt vmcnt(13)
  v_mfma_f32_16x16x32_bf16 v[208:211], a[96:99], v[64:67], v[208:211]
  v_mfma_f32_16x16x32_bf16 v[212:215], a[96:99], v[68:71], v[212:215]
  global_load_dwordx4 v[24:27], v248, s[42:43] offset:0
  v_mfma_f32_16x16x32_bf16 v[216:219], a[100:103], v[64:67], v[216:219]
  global_load_dwordx4 v[28:31], v248, s[42:43] offset:256
  v_add_u32 v248, 0xffe64000, v248
  v_mfma_f32_16x16x32_bf16 v[220:223], a[100:103], v[68:71], v[220:223]
  v_mfma_f32_16x16x32_bf16 v[224:227], a[104:107], v[64:67], v[224:227]
  v_mfma_f32_16x16x32_bf16 v[228:231], a[104:107], v[68:71], v[228:231]
  v_mfma_f32_16x16x32_bf16 v[232:235], a[108:111], v[64:67], v[232:235]
  v_mfma_f32_16x16x32_bf16 v[236:239], a[108:111], v[68:71], v[236:239]
  s_waitcnt vmcnt(12)
  v_mfma_f32_16x16x32_bf16 v[208:211], a[112:115], v[72:75], v[208:211]
  v_mfma_f32_16x16x32_bf16 v[212:215], a[112:115], v[76:79], v[212:215]
  v_mfma_f32_16x16x32_bf16 v[216:219], a[116:119], v[72:75], v[216:219]
  v_mfma_f32_16x16x32_bf16 v[220:223], a[116:119], v[76:79], v[220:223]
  v_mfma_f32_16x16x32_bf16 v[224:227], a[120:123], v[72:75], v[224:227]
  v_mfma_f32_16x16x32_bf16 v[228:231], a[120:123], v[76:79], v[228:231]
  v_mfma_f32_16x16x32_bf16 v[232:235], a[124:127], v[72:75], v[232:235]
  v_mfma_f32_16x16x32_bf16 v[236:239], a[124:127], v[76:79], v[236:239]
  s_waitcnt vmcnt(10)
  v_mfma_f32_16x16x32_bf16 v[208:211], a[128:131], v[80:83], v[208:211]
  v_mfma_f32_16x16x32_bf16 v[212:215], a[128:131], v[84:87], v[212:215]
  v_mfma_f32_16x16x32_bf16 v[216:219], a[132:135], v[80:83], v[216:219]
  v_mfma_f32_16x16x32_bf16 v[220:223], a[132:135], v[84:87], v[220:223]
  v_mfma_f32_16x16x32_bf16 v[224:227], a[136:139], v[80:83], v[224:227]
  v_mfma_f32_16x16x32_bf16 v[228:231], a[136:139], v[84:87], v[228:231]
  v_mfma_f32_16x16x32_bf16 v[232:235], a[140:143], v[80:83], v[232:235]
  v_mfma_f32_16x16x32_bf16 v[236:239], a[140:143], v[84:87], v[236:239]
  s_waitcnt vmcnt(8)
  v_mfma_f32_16x16x32_bf16 v[208:211], a[144:147], v[88:91], v[208:211]
  v_mfma_f32_16x16x32_bf16 v[212:215], a[144:147], v[92:95], v[212:215]
  v_mfma_f32_16x16x32_bf16 v[216:219], a[148:151], v[88:91], v[216:219]
  v_mfma_f32_16x16x32_bf16 v[220:223], a[148:151], v[92:95], v[220:223]
  v_mfma_f32_16x16x32_bf16 v[224:227], a[152:155], v[88:91], v[224:227]
  v_mfma_f32_16x16x32_bf16 v[228:231], a[152:155], v[92:95], v[228:231]
  v_mfma_f32_16x16x32_bf16 v[232:235], a[156:159], v[88:91], v[232:235]
  v_mfma_f32_16x16x32_bf16 v[236:239], a[156:159], v[92:95], v[236:239]
  s_waitcnt vmcnt(6)
  v_mfma_f32_16x16x32_bf16 v[208:211], a[160:163], v[96:99], v[208:211]
  v_mfma_f32_16x16x32_bf16 v[212:215], a[160:163], v[100:103], v[212:215]
  v_mfma_f32_16x16x32_bf16 v[216:219], a[164:167], v[96:99], v[216:219]
  v_mfma_f32_16x16x32_bf16 v[220:223], a[164:167], v[100:103], v[220:223]
  v_mfma_f32_16x16x32_bf16 v[224:227], a[168:171], v[96:99], v[224:227]
  v_mfma_f32_16x16x32_bf16 v[228:231], a[168:171], v[100:103], v[228:231]
  v_mfma_f32_16x16x32_bf16 v[232:235], a[172:175], v[96:99], v[232:235]
  v_mfma_f32_16x16x32_bf16 v[236:239], a[172:175], v[100:103], v[236:239]
  s_waitcnt vmcnt(4)
  s_cmp_lg_u32 s34, 0
  s_cbranch_scc1 w0_33
  v_lshlrev_b32 v251, 8, v1
  v_add_u32 v251, 31469568, v251
  s_mov_b64 exec, 0xffff
  global_load_dword v11, v251, s[32:33] sc1
  s_mov_b64 exec, -1
  s_nop 3

w0_33:
  v_mfma_f32_16x16x32_bf16 v[208:211], a[176:179], v[104:107], v[208:211]
  v_mfma_f32_16x16x32_bf16 v[212:215], a[176:179], v[108:111], v[212:215]
  v_mfma_f32_16x16x32_bf16 v[216:219], a[180:183], v[104:107], v[216:219]
  v_mfma_f32_16x16x32_bf16 v[220:223], a[180:183], v[108:111], v[220:223]
  v_mfma_f32_16x16x32_bf16 v[224:227], a[184:187], v[104:107], v[224:227]
  v_mfma_f32_16x16x32_bf16 v[228:231], a[184:187], v[108:111], v[228:231]
  v_mfma_f32_16x16x32_bf16 v[232:235], a[188:191], v[104:107], v[232:235]
  v_mfma_f32_16x16x32_bf16 v[236:239], a[188:191], v[108:111], v[236:239]
  s_waitcnt vmcnt(2)
  v_mfma_f32_16x16x32_bf16 v[208:211], a[192:195], v[16:19], v[208:211]
  v_mfma_f32_16x16x32_bf16 v[212:215], a[192:195], v[20:23], v[212:215]
  v_mfma_f32_16x16x32_bf16 v[216:219], a[196:199], v[16:19], v[216:219]
  v_mfma_f32_16x16x32_bf16 v[220:223], a[196:199], v[20:23], v[220:223]
  v_mfma_f32_16x16x32_bf16 v[224:227], a[200:203], v[16:19], v[224:227]
  v_mfma_f32_16x16x32_bf16 v[228:231], a[200:203], v[20:23], v[228:231]
  v_mfma_f32_16x16x32_bf16 v[232:235], a[204:207], v[16:19], v[232:235]
  v_mfma_f32_16x16x32_bf16 v[236:239], a[204:207], v[20:23], v[236:239]
  s_waitcnt vmcnt(0)
  v_mfma_f32_16x16x32_bf16 v[208:211], a[208:211], v[24:27], v[208:211]
  v_mfma_f32_16x16x32_bf16 v[212:215], a[208:211], v[28:31], v[212:215]
  v_mfma_f32_16x16x32_bf16 v[216:219], a[212:215], v[24:27], v[216:219]
  v_mfma_f32_16x16x32_bf16 v[220:223], a[212:215], v[28:31], v[220:223]
  v_mfma_f32_16x16x32_bf16 v[224:227], a[216:219], v[24:27], v[224:227]
  v_mfma_f32_16x16x32_bf16 v[228:231], a[216:219], v[28:31], v[228:231]
  v_mfma_f32_16x16x32_bf16 v[232:235], a[220:223], v[24:27], v[232:235]
  v_mfma_f32_16x16x32_bf16 v[236:239], a[220:223], v[28:31], v[236:239]
  v_mul_u32_u24 v113, 272, v2
  v_lshl_add_u32 v113, v3, 4, v113
  s_mul_i32 s50, s34, 8704
  s_add_u32 s50, s50, 114688
  v_add_u32 v113, s50, v113
  v_and_b32 v114, 31, v1
  v_mul_u32_u24 v115, 272, v114
  v_lshrrev_b32 v116, 5, v1
  v_lshl_add_u32 v115, v116, 5, v115
  s_lshl_b32 s50, s34, 6
  s_add_u32 s50, s50, 114688
  v_add_u32 v115, s50, v115

  ds_write_b128 v113, v[208:211] offset:0
  ds_write_b128 v113, v[212:215] offset:4352
  ds_write_b128 v113, v[216:219] offset:64
  ds_write_b128 v113, v[220:223] offset:4416
  ds_write_b128 v113, v[224:227] offset:128
  ds_write_b128 v113, v[228:231] offset:4480
  ds_write_b128 v113, v[232:235] offset:192
  ds_write_b128 v113, v[236:239] offset:4544
  v_lshrrev_b32 v117, 2, v2
  v_lshl_add_u32 v117, v116, 3, v117
  v_lshlrev_b32 v117, 6, v117
  v_and_b32 v118, 1, v3
  v_lshl_add_u32 v117, v118, 5, v117
  v_and_b32 v118, 3, v2
  v_lshl_add_u32 v117, v118, 3, v117
  s_lshl_b32 s50, s34, 10
  s_add_u32 s50, s50, 155648
  v_add_u32 v117, s50, v117

  v_lshlrev_b32 v120, 16, v244
  v_and_b32 v121, s58, v244
  v_lshlrev_b32 v122, 16, v245
  v_and_b32 v123, s58, v245
  v_lshlrev_b32 v124, 16, v246
  v_and_b32 v125, s58, v246
  v_lshlrev_b32 v126, 16, v247
  v_and_b32 v127, s58, v247
  s_cmp_lg_u32 s34, 0
  s_cbranch_scc1 w0_36
  s_mov_b64 exec, 0xffff
  s_waitcnt vmcnt(0)
  s_mov_b32 s93, 200000
  v_cmp_ne_u32 vcc, 16, v11
  s_cbranch_vccz gd_35
  gp_34:
  s_sleep 12
  global_load_dword v11, v251, s[32:33] sc1
  s_waitcnt vmcnt(0)
  v_cmp_ne_u32 vcc, 16, v11
  s_cbranch_vccz gd_35
  s_sub_u32 s93, s93, 1
  s_cbranch_scc0 gp_34
  gd_35:
  s_mov_b64 exec, -1

w0_36:
  s_waitcnt lgkmcnt(0)
  s_barrier
  ds_read_b128 v[128:131], v115 offset:0
  ds_read_b128 v[132:135], v115 offset:16
  ds_read_b128 v[136:139], v115 offset:8704
  ds_read_b128 v[140:143], v115 offset:8720
  ds_read_b128 v[144:147], v115 offset:17408
  ds_read_b128 v[148:151], v115 offset:17424
  ds_read_b128 v[152:155], v115 offset:26112
  ds_read_b128 v[156:159], v115 offset:26128
  ds_read_b64_tr_b16 v[160:161], v117
  ds_read_b64_tr_b16 v[162:163], v117 offset:256
  s_lshl_b32 s59, s37, 12
  s_add_u32 s59, s59, 4194304
  v_lshlrev_b32 v238, 3, v0
  v_add_u32 v238, s59, v238
  v_lshlrev_b32 v239, 4, v0
  v_add_u32 v239, 29425664, v239
  v_add_u32 v237, 8192, v239

  s_mul_i32 s59, s37, 4224
  s_add_u32 s59, s59, 25165824
  v_lshlrev_b32 v235, 4, v0
  v_add_u32 v235, s59, v235
  v_add_u32 v234, 4224, v235

  global_load_dwordx4 v[216:219], v235, s[32:33]
  global_load_dwordx2 v[220:221], v235, s[32:33] offset:16
  global_load_dwordx4 v[224:227], v234, s[32:33]
  global_load_dwordx2 v[222:223], v234, s[32:33] offset:16
  s_waitcnt lgkmcnt(0)
  s_barrier
  v_pk_add_f32 v[128:129], v[128:129], v[136:137]
  global_load_dwordx4 v[208:211], v239, s[32:33]
  v_add_u32 v239, 4096, v239
  v_pk_add_f32 v[144:145], v[144:145], v[152:153]
  v_pk_add_f32 v[130:131], v[130:131], v[138:139]
  v_pk_add_f32 v[146:147], v[146:147], v[154:155]
  global_load_dwordx4 v[212:215], v237, s[32:33]
  v_add_u32 v237, 4096, v237
  v_pk_add_f32 v[132:133], v[132:133], v[140:141]
  v_pk_add_f32 v[148:149], v[148:149], v[156:157]
  v_pk_add_f32 v[134:135], v[134:135], v[142:143]
  global_load_dwordx2 v[204:205], v238, s[32:33]
  v_add_u32 v236, 4096, v238
  v_pk_add_f32 v[150:151], v[150:151], v[158:159]
  v_pk_add_f32 v[128:129], v[128:129], v[144:145]
  v_pk_add_f32 v[130:131], v[130:131], v[146:147]
  global_load_dwordx2 v[206:207], v236, s[32:33]
  v_add_u32 v238, 2048, v238
  v_pk_add_f32 v[132:133], v[132:133], v[148:149]
  v_pk_add_f32 v[134:135], v[134:135], v[150:151]
  v_cvt_pk_bf16_f32 v164, v128, v129
  v_lshlrev_b32 v128, 16, v164
  v_and_b32 v129, s58, v164
  v_pk_add_f32 v[128:129], v[128:129], v[120:121]
  v_cvt_pk_bf16_f32 v164, v128, v129
  v_lshlrev_b32 v128, 16, v164
  v_and_b32 v129, s58, v164
  v_lshlrev_b32 v164, 16, v160
  v_and_b32 v165, s58, v160
  v_pk_add_f32 v[128:129], v[128:129], v[164:165]
  v_cvt_pk_bf16_f32 v172, v128, v129

  v_cvt_pk_bf16_f32 v166, v130, v131
  v_lshlrev_b32 v130, 16, v166
  v_and_b32 v131, s58, v166
  v_pk_add_f32 v[130:131], v[130:131], v[122:123]
  v_cvt_pk_bf16_f32 v166, v130, v131
  v_lshlrev_b32 v130, 16, v166
  v_and_b32 v131, s58, v166
  v_lshlrev_b32 v166, 16, v161
  v_and_b32 v167, s58, v161
  v_pk_add_f32 v[130:131], v[130:131], v[166:167]
  v_cvt_pk_bf16_f32 v173, v130, v131

  v_cvt_pk_bf16_f32 v168, v132, v133
  v_lshlrev_b32 v132, 16, v168
  v_and_b32 v133, s58, v168
  v_pk_add_f32 v[132:133], v[132:133], v[124:125]
  v_cvt_pk_bf16_f32 v168, v132, v133
  v_lshlrev_b32 v132, 16, v168
  v_and_b32 v133, s58, v168
  v_lshlrev_b32 v168, 16, v162
  v_and_b32 v169, s58, v162
  v_pk_add_f32 v[132:133], v[132:133], v[168:169]
  v_cvt_pk_bf16_f32 v174, v132, v133

  v_cvt_pk_bf16_f32 v170, v134, v135
  v_lshlrev_b32 v134, 16, v170
  v_and_b32 v135, s58, v170
  v_pk_add_f32 v[134:135], v[134:135], v[126:127]
  v_cvt_pk_bf16_f32 v170, v134, v135
  v_lshlrev_b32 v134, 16, v170
  v_and_b32 v135, s58, v170
  v_lshlrev_b32 v170, 16, v163
  v_and_b32 v171, s58, v163
  v_pk_add_f32 v[134:135], v[134:135], v[170:171]
  v_cvt_pk_bf16_f32 v175, v134, v135

  s_add_u32 s52, s32, 4194304
  s_addc_u32 s53, s33, 0
  s_add_u32 s54, s32, 29425664
  s_addc_u32 s55, s33, 0
  v_bfe_u32 v118, v1, 1, 1
  v_bfe_u32 v119, v1, 3, 1
  v_lshl_or_b32 v118, v119, 1, v118
  v_xor_b32 v118, s34, v118
  v_lshlrev_b32 v118, 5, v118
  v_lshl_add_u32 v118, v114, 7, v118
  v_lshl_add_u32 v118, v116, 4, v118
  v_add_u32 v118, 114688, v118
  ds_write_b128 v118, v[172:175]
  s_mov_b32 s51, 0x3f803f80

  v_dot2_f32_bf16 v176, v172, s51, 0
  v_dot2_f32_bf16 v177, v172, v172, 0
  v_dot2_f32_bf16 v176, v173, s51, v176
  v_dot2_f32_bf16 v177, v173, v173, v177
  v_dot2_f32_bf16 v176, v174, s51, v176
  v_dot2_f32_bf16 v177, v174, v174, v177
  v_dot2_f32_bf16 v176, v175, s51, v176
  v_dot2_f32_bf16 v177, v175, v175, v177
  s_lshl_b32 s50, s34, 9
  s_add_u32 s50, s50, 159744
  v_lshlrev_b32 v118, 8, v116
  v_lshl_add_u32 v118, v114, 3, v118
  v_add_u32 v118, s50, v118
  s_nop 0
  ds_write_b64 v118, v[176:177]

  v_and_b32 v179, 15, v1
  v_lshrrev_b32 v180, 4, v1
  v_lshrrev_b32 v178, 2, v179
  v_lshl_add_u32 v178, v180, 3, v178
  v_lshlrev_b32 v178, 7, v178
  v_and_b32 v180, 1, v180
  v_lshlrev_b32 v180, 1, v180
  v_bfe_u32 v179, v1, 3, 1
  v_or_b32 v180, v180, v179
  v_xor_b32 v180, s34, v180
  v_lshl_add_u32 v178, v180, 5, v178
  v_and_b32 v179, 3, v1
  v_lshl_add_u32 v178, v179, 3, v178
  v_add_u32 v178, 114688, v178

  v_and_b32 v179, 15, v1
  s_lshl_b32 s50, s34, 4
  s_lshl_b32 s51, s49, 6
  s_add_u32 s50, s50, s51
  v_add_u32 v179, s50, v179
  v_lshlrev_b32 v181, 12, v179
  v_lshl_add_u32 v181, v3, 4, v181
  s_add_u32 s50, s48, 1024
  s_lshl_b32 s51, s50, 1
  v_add_u32 v181, s51, v181
  s_waitcnt lgkmcnt(0)
  s_barrier
  ds_read_b64_tr_b16 v[184:185], v178
  ds_read_b64_tr_b16 v[186:187], v178 offset:512
  v_lshlrev_b32 v118, 3, v114
  v_add_u32 v118, 159744, v118

  ds_read_b64 v[188:189], v118 offset:0
  ds_read_b64 v[190:191], v118 offset:256
  ds_read_b64 v[192:193], v118 offset:512
  ds_read_b64 v[194:195], v118 offset:768
  ds_read_b64 v[196:197], v118 offset:1024
  ds_read_b64 v[198:199], v118 offset:1280
  ds_read_b64 v[200:201], v118 offset:1536
  ds_read_b64 v[202:203], v118 offset:1792
  v_add_u32 v118, s50, v114
  v_lshlrev_b32 v118, 2, v118
  v_add_u32 v119, 8192, v118
  s_waitcnt lgkmcnt(8)
  global_store_dwordx4 v181, v[184:187], s[52:53] sc1
  s_waitcnt lgkmcnt(0)
  v_pk_add_f32 v[188:189], v[188:189], v[190:191]
  v_pk_add_f32 v[192:193], v[192:193], v[194:195]
  v_pk_add_f32 v[196:197], v[196:197], v[198:199]
  v_pk_add_f32 v[200:201], v[200:201], v[202:203]
  v_pk_add_f32 v[188:189], v[188:189], v[192:193]
  v_pk_add_f32 v[196:197], v[196:197], v[200:201]
  v_pk_add_f32 v[188:189], v[188:189], v[196:197]

  s_cmp_lg_u32 s34, 1
  s_cbranch_scc1 g2st_37
  s_mov_b32 exec_hi, 0
  global_atomic_add_f32 v118, v188, s[54:55] sc1
  global_atomic_add_f32 v119, v189, s[54:55] sc1
  s_mov_b64 exec, -1

g2st_37:
  s_barrier
  v_lshlrev_b32 v9, 4, v0
  v_add_u32 v9, 114688, v9
  v_mov_b32 v4, 0
  v_mov_b32 v5, 0
  v_mov_b32 v6, 0
  v_mov_b32 v7, 0
  v_subrev_u32 v3, 64, v0
  v_mul_u32_u24 v2, 4160, v3
  v_add_u32 v2, 118784, v2
  v_cmp_gt_u32 vcc, 8, v3
  s_and_saveexec_b64 s[46:47], vcc
  s_cbranch_execz kb_38
  ds_write_b128 v2, v[4:7]
  ds_write_b128 v2, v[4:7] offset:16

kb_38:
  s_mov_b64 exec, s[46:47]
  s_waitcnt vmcnt(5)
  ds_write_b128 v9, v[216:219] offset:12480
  v_alignbit_b32 v40, v217, v216, 16
  v_mov_b32 v44, v217
  v_alignbit_b32 v48, v218, v217, 16
  v_alignbit_b32 v41, v218, v217, 16
  v_mov_b32 v45, v218
  v_alignbit_b32 v49, v219, v218, 16
  v_alignbit_b32 v42, v219, v218, 16
  v_mov_b32 v46, v219
  v_alignbit_b32 v50, v220, v219, 16
  v_alignbit_b32 v43, v220, v219, 16
  v_mov_b32 v47, v220
  v_alignbit_b32 v51, v221, v220, 16
  ds_write_b128 v9, v[40:43] offset:8320
  ds_write_b128 v9, v[44:47] offset:4160
  ds_write_b128 v9, v[48:51] offset:0
  ds_write_b128 v9, v[224:227] offset:29120
  v_alignbit_b32 v52, v225, v224, 16
  v_mov_b32 v56, v225
  v_alignbit_b32 v60, v226, v225, 16
  v_alignbit_b32 v53, v226, v225, 16
  v_mov_b32 v57, v226
  v_alignbit_b32 v61, v227, v226, 16
  v_alignbit_b32 v54, v227, v226, 16
  v_mov_b32 v58, v227
  v_alignbit_b32 v62, v222, v227, 16
  v_alignbit_b32 v55, v222, v227, 16
  v_mov_b32 v59, v222
  v_alignbit_b32 v63, v223, v222, 16
  ds_write_b128 v9, v[52:55] offset:24960
  ds_write_b128 v9, v[56:59] offset:20800
  ds_write_b128 v9, v[60:63] offset:16640
  v_lshlrev_b32 v2, 3, v0
  v_lshlrev_b32 v3, 4, v0
  s_lshr_b32 s41, s34, 1
  s_and_b32 s42, s34, 1
  s_lshl_b32 s43, s37, 2
  s_add_u32 s43, s43, 29491200
  v_mov_b32 v5, s43
  global_load_dwordx2 v[240:241], v5, s[32:33]
  s_lshl_b32 s43, s37, 1
  s_load_dword s52, s[16:17], s43
  v_mov_b32 v8, 0
  v_mov_b32 v9, 0
  v_mov_b32 v10, 0
  v_mov_b32 v11, 0
  v_add_u32 v5, 147968, v3
  v_cmp_gt_u32 vcc, 30, v0
  s_and_saveexec_b64 s[54:55], vcc
  s_cbranch_execz cv_z_1
  ds_write_b128 v5, v[8:11]
  ds_write_b128 v5, v[8:11] offset:4608

cv_z_1:
  s_mov_b64 exec, s[54:55]
  s_mov_b32 s58, 0xffff0000
  v_mov_b32 v12, 0x3b000000
  v_mov_b32 v13, 0x3b000000
  v_mov_b32 v14, 0x3727c5ac
  v_mov_b32 v15, 0x3727c5ac
  v_add_u32 v7, 148448, v2
  v_add_u32 v235, 157184, v2
  v_and_b32 v2, 15, v1
  v_lshrrev_b32 v3, 4, v1
  v_and_b32 v4, 3, v2
  s_lshl_b32 s43, s41, 2
  v_add_u32 v4, s43, v4
  v_mul_u32_u24 v4, 4160, v4
  v_lshrrev_b32 v5, 2, v2
  v_lshlrev_b32 v6, 1, v3
  v_sub_u32 v5, v6, v5
  v_lshl_add_u32 v4, v5, 3, v4
  v_add_u32 v230, 116760, v4
  s_lshl_b32 s43, s42, 8
  s_sub_u32 s43, 115160, s43
  v_add_u32 v4, s43, v4
  v_lshlrev_b32 v5, 5, v2
  v_lshl_add_u32 v5, v3, 4, v5
  s_mul_i32 s43, s41, 4608
  s_add_u32 s43, s43, 147968
  v_add_u32 v231, s43, v5
  s_add_u32 s43, s43, 448
  s_lshl_b32 s53, s42, 8
  s_sub_u32 s43, s43, s53
  v_add_u32 v5, s43, v5
  v_lshlrev_b32 v6, 6, v2
  v_lshl_add_u32 v6, v3, 4, v6
  s_lshl_b32 s43, s34, 12
  s_add_u32 s43, s43, 114688
  v_add_u32 v6, s43, v6
  v_lshlrev_b32 v232, 5, v2
  v_lshl_add_u32 v232, v3, 3, v232
  s_lshl_b32 s43, s41, 11
  s_add_u32 s43, s43, 157184
  v_add_u32 v233, s43, v232
  s_mul_i32 s43, s41, 4608
  s_add_u32 s43, s43, 148448
  v_add_u32 v232, s43, v232
  v_lshrrev_b32 v234, 1, v2
  v_lshlrev_b32 v234, 15, v234
  v_and_b32 v8, 1, v2
  v_lshl_add_u32 v234, v8, 5, v234
  v_lshl_add_u32 v234, v3, 3, v234
  s_add_u32 s43, s37, s41
  s_lshl_b32 s43, s43, 6
  s_add_u32 s43, s43, 6291456
  v_add_u32 v234, s43, v234

  s_waitcnt vmcnt(4)
  v_pk_mul_f32 v[208:209], v[208:209], v[12:13]
  v_pk_mul_f32 v[212:213], v[212:213], v[12:13]
  v_pk_fma_f32 v[212:213], v[208:209], v[208:209], v[212:213] neg_lo:[1,0,0] neg_hi:[1,0,0]
  v_cvt_pk_bf16_f32 v16, v208, v209
  v_max_f32 v212, 0, v212
  v_max_f32 v213, 0, v213
  v_cvt_pk_bf16_f32 v20, v212, v213
  v_lshlrev_b32 v208, 16, v16
  v_and_b32 v209, s58, v16
  v_lshlrev_b32 v212, 16, v20
  v_and_b32 v213, s58, v20
  v_pk_add_f32 v[212:213], v[212:213], v[14:15]

  v_pk_mul_f32 v[210:211], v[210:211], v[12:13]
  v_pk_mul_f32 v[214:215], v[214:215], v[12:13]
  v_pk_fma_f32 v[214:215], v[210:211], v[210:211], v[214:215] neg_lo:[1,0,0] neg_hi:[1,0,0]
  v_cvt_pk_bf16_f32 v17, v210, v211
  v_max_f32 v214, 0, v214
  v_max_f32 v215, 0, v215
  v_cvt_pk_bf16_f32 v21, v214, v215
  v_lshlrev_b32 v210, 16, v17
  v_and_b32 v211, s58, v17
  v_lshlrev_b32 v214, 16, v21
  v_and_b32 v215, s58, v21
  v_pk_add_f32 v[214:215], v[214:215], v[14:15]

  v_cvt_pk_bf16_f32 v20, v212, v213
  v_lshlrev_b32 v212, 16, v20
  v_and_b32 v213, s58, v20
  v_sqrt_f32 v212, v212
  v_sqrt_f32 v213, v213

  v_cvt_pk_bf16_f32 v21, v214, v215
  v_lshlrev_b32 v214, 16, v21
  v_and_b32 v215, s58, v21
  v_sqrt_f32 v214, v214
  v_sqrt_f32 v215, v215

  s_nop 0
  v_cvt_pk_bf16_f32 v20, v212, v213
  v_lshlrev_b32 v212, 16, v20
  v_and_b32 v213, s58, v20
  v_rcp_f32 v212, v212
  v_rcp_f32 v213, v213

  v_cvt_pk_bf16_f32 v21, v214, v215
  v_lshlrev_b32 v214, 16, v21
  v_and_b32 v215, s58, v21
  v_rcp_f32 v214, v214
  v_rcp_f32 v215, v215

  s_nop 0
  s_waitcnt vmcnt(2)
  v_lshlrev_b32 v32, 16, v204
  v_and_b32 v33, s58, v204
  v_pk_add_f32 v[32:33], v[32:33], v[208:209] neg_lo:[0,1] neg_hi:[0,1]
  v_cvt_pk_bf16_f32 v184, v32, v33
  v_lshlrev_b32 v32, 16, v184
  v_and_b32 v33, s58, v184
  v_pk_mul_f32 v[32:33], v[32:33], v[212:213]
  v_cvt_pk_bf16_f32 v184, v32, v33
  v_lshlrev_b32 v32, 16, v184
  v_and_b32 v33, s58, v184
  v_cvt_pk_f16_f32 v24, v32, v33

  v_lshlrev_b32 v34, 16, v205
  v_and_b32 v35, s58, v205
  v_pk_add_f32 v[34:35], v[34:35], v[210:211] neg_lo:[0,1] neg_hi:[0,1]
  v_cvt_pk_bf16_f32 v185, v34, v35
  v_lshlrev_b32 v34, 16, v185
  v_and_b32 v35, s58, v185
  v_pk_mul_f32 v[34:35], v[34:35], v[214:215]
  v_cvt_pk_bf16_f32 v185, v34, v35
  v_lshlrev_b32 v34, 16, v185
  v_and_b32 v35, s58, v185
  v_cvt_pk_f16_f32 v25, v34, v35

  ds_write_b64 v7, v[24:25] offset:0
  ds_write_b64 v235, v[204:205] offset:0
  v_lshlrev_b32 v36, 16, v206
  v_and_b32 v37, s58, v206
  v_pk_add_f32 v[36:37], v[36:37], v[208:209] neg_lo:[0,1] neg_hi:[0,1]
  v_cvt_pk_bf16_f32 v186, v36, v37
  v_lshlrev_b32 v36, 16, v186
  v_and_b32 v37, s58, v186
  v_pk_mul_f32 v[36:37], v[36:37], v[212:213]
  v_cvt_pk_bf16_f32 v186, v36, v37
  v_lshlrev_b32 v36, 16, v186
  v_and_b32 v37, s58, v186
  v_cvt_pk_f16_f32 v26, v36, v37

  v_lshlrev_b32 v38, 16, v207
  v_and_b32 v39, s58, v207
  v_pk_add_f32 v[38:39], v[38:39], v[210:211] neg_lo:[0,1] neg_hi:[0,1]
  v_cvt_pk_bf16_f32 v187, v38, v39
  v_lshlrev_b32 v38, 16, v187
  v_and_b32 v39, s58, v187
  v_pk_mul_f32 v[38:39], v[38:39], v[214:215]
  v_cvt_pk_bf16_f32 v187, v38, v39
  v_lshlrev_b32 v38, 16, v187
  v_and_b32 v39, s58, v187
  v_cvt_pk_f16_f32 v27, v38, v39

  ds_write_b64 v7, v[26:27] offset:4608
  ds_write_b64 v235, v[206:207] offset:2048
  s_waitcnt vmcnt(0) lgkmcnt(0)
  s_barrier
  s_cmp_lg_u32 s34, 0
  s_cbranch_scc1 w0_39
  s_and_b32 s93, s2, 15
  s_lshl_b32 s93, s93, 8
  s_add_u32 s93, s93, 31498240
  v_mov_b32 v246, s93
  v_mov_b32 v247, 1
  s_mov_b64 exec, 1
  global_atomic_add v246, v247, s[32:33] sc1
  s_mov_b64 exec, -1
  s_nop 3

w0_39:
  s_cmp_lg_u32 s42, 0
  s_cbranch_scc1 pa_40
  ds_read_b64 v[40:41], v230 offset:1984
  ds_read_b64 v[42:43], v230 offset:1992
  ds_read_b128 v[56:59], v231 offset:1984
  ds_read_b128 v[72:75], v231 offset:448
  ds_read_b64 v[44:45], v230 offset:1920
  ds_read_b64 v[46:47], v230 offset:1928
  ds_read_b128 v[60:63], v231 offset:1920
  ds_read_b128 v[76:79], v231 offset:384
  ds_read_b64 v[48:49], v230 offset:1856
  ds_read_b64 v[50:51], v230 offset:1864
  ds_read_b128 v[64:67], v231 offset:1856
  ds_read_b128 v[80:83], v231 offset:320
  ds_read_b64 v[52:53], v230 offset:1792
  ds_read_b64 v[54:55], v230 offset:1800
  ds_read_b128 v[68:71], v231 offset:1792
  ds_read_b128 v[84:87], v231 offset:256
  s_waitcnt lgkmcnt(0)
  v_mfma_f32_16x16x32_f16 v[140:143], v[40:43], v[56:59], 0
  ds_read_b64 v[88:89], v230 offset:1728
  ds_read_b64 v[90:91], v230 offset:1736
  v_mfma_f32_16x16x32_f16 v[136:139], v[40:43], v[72:75], 0
  ds_read_b128 v[104:107], v231 offset:1728
  ds_read_b128 v[120:123], v231 offset:192
  v_mfma_f32_16x16x32_f16 v[140:143], v[44:47], v[60:63], v[140:143]
  ds_read_b64 v[92:93], v230 offset:1664
  ds_read_b64 v[94:95], v230 offset:1672
  v_mfma_f32_16x16x32_f16 v[136:139], v[44:47], v[76:79], v[136:139]
  ds_read_b128 v[108:111], v231 offset:1664
  ds_read_b128 v[124:127], v231 offset:128
  v_mfma_f32_16x16x32_f16 v[140:143], v[48:51], v[64:67], v[140:143]
  ds_read_b64 v[96:97], v230 offset:1600
  ds_read_b64 v[98:99], v230 offset:1608
  v_mfma_f32_16x16x32_f16 v[136:139], v[48:51], v[80:83], v[136:139]
  ds_read_b128 v[112:115], v231 offset:1600
  ds_read_b128 v[128:131], v231 offset:64
  v_mfma_f32_16x16x32_f16 v[140:143], v[52:55], v[68:71], v[140:143]
  ds_read_b64 v[100:101], v230 offset:1536
  ds_read_b64 v[102:103], v230 offset:1544
  v_mfma_f32_16x16x32_f16 v[136:139], v[52:55], v[84:87], v[136:139]
  ds_read_b128 v[116:119], v231 offset:1536
  ds_read_b128 v[132:135], v231 offset:0
  s_waitcnt lgkmcnt(0)
  v_mfma_f32_16x16x32_f16 v[140:143], v[88:91], v[104:107], v[140:143]
  ds_read_b64 v[40:41], v230 offset:1472
  ds_read_b64 v[42:43], v230 offset:1480
  v_mfma_f32_16x16x32_f16 v[136:139], v[88:91], v[120:123], v[136:139]
  ds_read_b128 v[56:59], v231 offset:1472
  ds_read_b64 v[44:45], v230 offset:1408
  v_mfma_f32_16x16x32_f16 v[140:143], v[92:95], v[108:111], v[140:143]
  ds_read_b64 v[46:47], v230 offset:1416
  ds_read_b128 v[60:63], v231 offset:1408
  v_mfma_f32_16x16x32_f16 v[136:139], v[92:95], v[124:127], v[136:139]
  ds_read_b64 v[48:49], v230 offset:1344
  ds_read_b64 v[50:51], v230 offset:1352
  v_mfma_f32_16x16x32_f16 v[140:143], v[96:99], v[112:115], v[140:143]
  ds_read_b128 v[64:67], v231 offset:1344
  ds_read_b64 v[52:53], v230 offset:1280
  v_mfma_f32_16x16x32_f16 v[136:139], v[96:99], v[128:131], v[136:139]
  ds_read_b64 v[54:55], v230 offset:1288
  ds_read_b128 v[68:71], v231 offset:1280
  v_mfma_f32_16x16x32_f16 v[140:143], v[100:103], v[116:119], v[140:143]
  v_mfma_f32_16x16x32_f16 v[136:139], v[100:103], v[132:135], v[136:139]
  s_waitcnt lgkmcnt(0)
  v_mfma_f32_16x16x32_f16 v[140:143], v[40:43], v[56:59], v[140:143]
  ds_read_b64 v[88:89], v230 offset:1216
  ds_read_b64 v[90:91], v230 offset:1224
  ds_read_b128 v[104:107], v231 offset:1216
  v_mfma_f32_16x16x32_f16 v[140:143], v[44:47], v[60:63], v[140:143]
  ds_read_b64 v[92:93], v230 offset:1152
  ds_read_b64 v[94:95], v230 offset:1160
  ds_read_b128 v[108:111], v231 offset:1152
  v_mfma_f32_16x16x32_f16 v[140:143], v[48:51], v[64:67], v[140:143]
  ds_read_b64 v[96:97], v230 offset:1088
  ds_read_b64 v[98:99], v230 offset:1096
  ds_read_b128 v[112:115], v231 offset:1088
  v_mfma_f32_16x16x32_f16 v[140:143], v[52:55], v[68:71], v[140:143]
  ds_read_b64 v[100:101], v230 offset:1024
  ds_read_b64 v[102:103], v230 offset:1032
  ds_read_b128 v[116:119], v231 offset:1024
  s_waitcnt lgkmcnt(0)
  v_mfma_f32_16x16x32_f16 v[140:143], v[88:91], v[104:107], v[140:143]
  ds_read_b64 v[40:41], v230 offset:960
  ds_read_b64 v[42:43], v230 offset:968
  ds_read_b128 v[56:59], v231 offset:960
  v_mfma_f32_16x16x32_f16 v[140:143], v[92:95], v[108:111], v[140:143]
  ds_read_b64 v[44:45], v230 offset:896
  ds_read_b64 v[46:47], v230 offset:904
  ds_read_b128 v[60:63], v231 offset:896
  v_mfma_f32_16x16x32_f16 v[140:143], v[96:99], v[112:115], v[140:143]
  ds_read_b64 v[48:49], v230 offset:832
  ds_read_b64 v[50:51], v230 offset:840
  ds_read_b128 v[64:67], v231 offset:832
  v_mfma_f32_16x16x32_f16 v[140:143], v[100:103], v[116:119], v[140:143]
  ds_read_b64 v[52:53], v230 offset:768
  ds_read_b64 v[54:55], v230 offset:776
  ds_read_b128 v[68:71], v231 offset:768
  s_waitcnt lgkmcnt(0)
  v_mfma_f32_16x16x32_f16 v[140:143], v[40:43], v[56:59], v[140:143]
  ds_read_b64 v[88:89], v230 offset:704
  ds_read_b64 v[90:91], v230 offset:712
  ds_read_b128 v[104:107], v231 offset:704
  v_mfma_f32_16x16x32_f16 v[140:143], v[44:47], v[60:63], v[140:143]
  ds_read_b64 v[92:93], v230 offset:640
  ds_read_b64 v[94:95], v230 offset:648
  ds_read_b128 v[108:111], v231 offset:640
  v_mfma_f32_16x16x32_f16 v[140:143], v[48:51], v[64:67], v[140:143]
  ds_read_b64 v[96:97], v230 offset:576
  ds_read_b64 v[98:99], v230 offset:584
  ds_read_b128 v[112:115], v231 offset:576
  v_mfma_f32_16x16x32_f16 v[140:143], v[52:55], v[68:71], v[140:143]
  ds_read_b64 v[100:101], v230 offset:512
  ds_read_b64 v[102:103], v230 offset:520
  ds_read_b128 v[116:119], v231 offset:512
  s_waitcnt lgkmcnt(0)
  v_mfma_f32_16x16x32_f16 v[140:143], v[88:91], v[104:107], v[140:143]
  ds_read_b64 v[40:41], v230 offset:448
  ds_read_b64 v[42:43], v230 offset:456
  ds_read_b128 v[56:59], v231 offset:448
  v_mfma_f32_16x16x32_f16 v[140:143], v[92:95], v[108:111], v[140:143]
  ds_read_b64 v[44:45], v230 offset:384
  ds_read_b64 v[46:47], v230 offset:392
  ds_read_b128 v[60:63], v231 offset:384
  v_mfma_f32_16x16x32_f16 v[140:143], v[96:99], v[112:115], v[140:143]
  ds_read_b64 v[48:49], v230 offset:320
  ds_read_b64 v[50:51], v230 offset:328
  ds_read_b128 v[64:67], v231 offset:320
  v_mfma_f32_16x16x32_f16 v[140:143], v[100:103], v[116:119], v[140:143]
  ds_read_b64 v[52:53], v230 offset:256
  ds_read_b64 v[54:55], v230 offset:264
  ds_read_b128 v[68:71], v231 offset:256
  s_waitcnt lgkmcnt(0)
  v_mfma_f32_16x16x32_f16 v[140:143], v[40:43], v[56:59], v[140:143]
  ds_read_b64 v[88:89], v230 offset:192
  ds_read_b64 v[90:91], v230 offset:200
  ds_read_b128 v[104:107], v231 offset:192
  v_mfma_f32_16x16x32_f16 v[140:143], v[44:47], v[60:63], v[140:143]
  ds_read_b64 v[92:93], v230 offset:128
  ds_read_b64 v[94:95], v230 offset:136
  ds_read_b128 v[108:111], v231 offset:128
  v_mfma_f32_16x16x32_f16 v[140:143], v[48:51], v[64:67], v[140:143]
  ds_read_b64 v[96:97], v230 offset:64
  ds_read_b64 v[98:99], v230 offset:72
  ds_read_b128 v[112:115], v231 offset:64
  v_mfma_f32_16x16x32_f16 v[140:143], v[52:55], v[68:71], v[140:143]
  ds_read_b64 v[100:101], v230 offset:0
  ds_read_b64 v[102:103], v230 offset:8
  ds_read_b128 v[116:119], v231 offset:0
  s_waitcnt lgkmcnt(0)
  v_mfma_f32_16x16x32_f16 v[140:143], v[88:91], v[104:107], v[140:143]
  ds_read_b64 v[144:145], v232 offset:0
  ds_read_b64 v[146:147], v233 offset:0
  v_mfma_f32_16x16x32_f16 v[140:143], v[92:95], v[108:111], v[140:143]
  ds_read_b64 v[148:149], v232 offset:1536
  ds_read_b64 v[150:151], v233 offset:1536
  v_mfma_f32_16x16x32_f16 v[140:143], v[96:99], v[112:115], v[140:143]
  v_mfma_f32_16x16x32_f16 v[140:143], v[100:103], v[116:119], v[140:143]
  v_add_u32 v188, 0, v234
  v_add_u32 v189, 786432, v234
  s_branch pb_41
pa_40:
  ds_read_b64 v[40:41], v230 offset:1984
  ds_read_b64 v[42:43], v230 offset:1992
  ds_read_b128 v[56:59], v231 offset:1472
  ds_read_b128 v[72:75], v231 offset:960
  ds_read_b64 v[44:45], v230 offset:1920
  ds_read_b64 v[46:47], v230 offset:1928
  ds_read_b128 v[60:63], v231 offset:1408
  ds_read_b128 v[76:79], v231 offset:896
  ds_read_b64 v[48:49], v230 offset:1856
  ds_read_b64 v[50:51], v230 offset:1864
  ds_read_b128 v[64:67], v231 offset:1344
  ds_read_b128 v[80:83], v231 offset:832
  ds_read_b64 v[52:53], v230 offset:1792
  ds_read_b64 v[54:55], v230 offset:1800
  ds_read_b128 v[68:71], v231 offset:1280
  ds_read_b128 v[84:87], v231 offset:768
  s_waitcnt lgkmcnt(0)
  v_mfma_f32_16x16x32_f16 v[140:143], v[40:43], v[56:59], 0
  ds_read_b64 v[88:89], v230 offset:1728
  ds_read_b64 v[90:91], v230 offset:1736
  v_mfma_f32_16x16x32_f16 v[136:139], v[40:43], v[72:75], 0
  ds_read_b128 v[104:107], v231 offset:1216
  ds_read_b128 v[120:123], v231 offset:704
  v_mfma_f32_16x16x32_f16 v[140:143], v[44:47], v[60:63], v[140:143]
  ds_read_b64 v[92:93], v230 offset:1664
  ds_read_b64 v[94:95], v230 offset:1672
  v_mfma_f32_16x16x32_f16 v[136:139], v[44:47], v[76:79], v[136:139]
  ds_read_b128 v[108:111], v231 offset:1152
  ds_read_b128 v[124:127], v231 offset:640
  v_mfma_f32_16x16x32_f16 v[140:143], v[48:51], v[64:67], v[140:143]
  ds_read_b64 v[96:97], v230 offset:1600
  ds_read_b64 v[98:99], v230 offset:1608
  v_mfma_f32_16x16x32_f16 v[136:139], v[48:51], v[80:83], v[136:139]
  ds_read_b128 v[112:115], v231 offset:1088
  ds_read_b128 v[128:131], v231 offset:576
  v_mfma_f32_16x16x32_f16 v[140:143], v[52:55], v[68:71], v[140:143]
  ds_read_b64 v[100:101], v230 offset:1536
  ds_read_b64 v[102:103], v230 offset:1544
  v_mfma_f32_16x16x32_f16 v[136:139], v[52:55], v[84:87], v[136:139]
  ds_read_b128 v[116:119], v231 offset:1024
  ds_read_b128 v[132:135], v231 offset:512
  s_waitcnt lgkmcnt(0)
  v_mfma_f32_16x16x32_f16 v[140:143], v[88:91], v[104:107], v[140:143]
  ds_read_b64 v[40:41], v230 offset:1472
  ds_read_b64 v[42:43], v230 offset:1480
  v_mfma_f32_16x16x32_f16 v[136:139], v[88:91], v[120:123], v[136:139]
  ds_read_b128 v[56:59], v231 offset:960
  ds_read_b128 v[72:75], v231 offset:448
  v_mfma_f32_16x16x32_f16 v[140:143], v[92:95], v[108:111], v[140:143]
  ds_read_b64 v[44:45], v230 offset:1408
  ds_read_b64 v[46:47], v230 offset:1416
  v_mfma_f32_16x16x32_f16 v[136:139], v[92:95], v[124:127], v[136:139]
  ds_read_b128 v[60:63], v231 offset:896
  ds_read_b128 v[76:79], v231 offset:384
  v_mfma_f32_16x16x32_f16 v[140:143], v[96:99], v[112:115], v[140:143]
  ds_read_b64 v[48:49], v230 offset:1344
  ds_read_b64 v[50:51], v230 offset:1352
  v_mfma_f32_16x16x32_f16 v[136:139], v[96:99], v[128:131], v[136:139]
  ds_read_b128 v[64:67], v231 offset:832
  ds_read_b128 v[80:83], v231 offset:320
  v_mfma_f32_16x16x32_f16 v[140:143], v[100:103], v[116:119], v[140:143]
  ds_read_b64 v[52:53], v230 offset:1280
  ds_read_b64 v[54:55], v230 offset:1288
  v_mfma_f32_16x16x32_f16 v[136:139], v[100:103], v[132:135], v[136:139]
  ds_read_b128 v[68:71], v231 offset:768
  ds_read_b128 v[84:87], v231 offset:256
  s_waitcnt lgkmcnt(0)
  v_mfma_f32_16x16x32_f16 v[140:143], v[40:43], v[56:59], v[140:143]
  ds_read_b64 v[88:89], v230 offset:1216
  ds_read_b64 v[90:91], v230 offset:1224
  v_mfma_f32_16x16x32_f16 v[136:139], v[40:43], v[72:75], v[136:139]
  ds_read_b128 v[104:107], v231 offset:704
  ds_read_b128 v[120:123], v231 offset:192
  v_mfma_f32_16x16x32_f16 v[140:143], v[44:47], v[60:63], v[140:143]
  ds_read_b64 v[92:93], v230 offset:1152
  ds_read_b64 v[94:95], v230 offset:1160
  v_mfma_f32_16x16x32_f16 v[136:139], v[44:47], v[76:79], v[136:139]
  ds_read_b128 v[108:111], v231 offset:640
  ds_read_b128 v[124:127], v231 offset:128
  v_mfma_f32_16x16x32_f16 v[140:143], v[48:51], v[64:67], v[140:143]
  ds_read_b64 v[96:97], v230 offset:1088
  ds_read_b64 v[98:99], v230 offset:1096
  v_mfma_f32_16x16x32_f16 v[136:139], v[48:51], v[80:83], v[136:139]
  ds_read_b128 v[112:115], v231 offset:576
  ds_read_b128 v[128:131], v231 offset:64
  v_mfma_f32_16x16x32_f16 v[140:143], v[52:55], v[68:71], v[140:143]
  ds_read_b64 v[100:101], v230 offset:1024
  ds_read_b64 v[102:103], v230 offset:1032
  v_mfma_f32_16x16x32_f16 v[136:139], v[52:55], v[84:87], v[136:139]
  ds_read_b128 v[116:119], v231 offset:512
  ds_read_b128 v[132:135], v231 offset:0
  s_waitcnt lgkmcnt(0)
  v_mfma_f32_16x16x32_f16 v[140:143], v[88:91], v[104:107], v[140:143]
  ds_read_b64 v[40:41], v230 offset:960
  ds_read_b64 v[42:43], v230 offset:968
  v_mfma_f32_16x16x32_f16 v[136:139], v[88:91], v[120:123], v[136:139]
  ds_read_b128 v[56:59], v231 offset:448
  ds_read_b64 v[44:45], v230 offset:896
  v_mfma_f32_16x16x32_f16 v[140:143], v[92:95], v[108:111], v[140:143]
  ds_read_b64 v[46:47], v230 offset:904
  ds_read_b128 v[60:63], v231 offset:384
  v_mfma_f32_16x16x32_f16 v[136:139], v[92:95], v[124:127], v[136:139]
  ds_read_b64 v[48:49], v230 offset:832
  ds_read_b64 v[50:51], v230 offset:840
  v_mfma_f32_16x16x32_f16 v[140:143], v[96:99], v[112:115], v[140:143]
  ds_read_b128 v[64:67], v231 offset:320
  ds_read_b64 v[52:53], v230 offset:768
  v_mfma_f32_16x16x32_f16 v[136:139], v[96:99], v[128:131], v[136:139]
  ds_read_b64 v[54:55], v230 offset:776
  ds_read_b128 v[68:71], v231 offset:256
  v_mfma_f32_16x16x32_f16 v[140:143], v[100:103], v[116:119], v[140:143]
  v_mfma_f32_16x16x32_f16 v[136:139], v[100:103], v[132:135], v[136:139]
  s_waitcnt lgkmcnt(0)
  v_mfma_f32_16x16x32_f16 v[140:143], v[40:43], v[56:59], v[140:143]
  ds_read_b64 v[88:89], v230 offset:704
  ds_read_b64 v[90:91], v230 offset:712
  ds_read_b128 v[104:107], v231 offset:192
  v_mfma_f32_16x16x32_f16 v[140:143], v[44:47], v[60:63], v[140:143]
  ds_read_b64 v[92:93], v230 offset:640
  ds_read_b64 v[94:95], v230 offset:648
  ds_read_b128 v[108:111], v231 offset:128
  v_mfma_f32_16x16x32_f16 v[140:143], v[48:51], v[64:67], v[140:143]
  ds_read_b64 v[96:97], v230 offset:576
  ds_read_b64 v[98:99], v230 offset:584
  ds_read_b128 v[112:115], v231 offset:64
  v_mfma_f32_16x16x32_f16 v[140:143], v[52:55], v[68:71], v[140:143]
  ds_read_b64 v[100:101], v230 offset:512
  ds_read_b64 v[102:103], v230 offset:520
  ds_read_b128 v[116:119], v231 offset:0
  s_waitcnt lgkmcnt(0)
  v_mfma_f32_16x16x32_f16 v[140:143], v[88:91], v[104:107], v[140:143]
  ds_read_b64 v[144:145], v232 offset:512
  ds_read_b64 v[146:147], v233 offset:512
  v_mfma_f32_16x16x32_f16 v[140:143], v[92:95], v[108:111], v[140:143]
  ds_read_b64 v[148:149], v232 offset:1024
  ds_read_b64 v[150:151], v233 offset:1024
  v_mfma_f32_16x16x32_f16 v[140:143], v[96:99], v[112:115], v[140:143]
  v_mfma_f32_16x16x32_f16 v[140:143], v[100:103], v[116:119], v[140:143]
  v_add_u32 v188, 262144, v234
  v_add_u32 v189, 524288, v234
pb_41:
  s_cmp_lg_u32 s34, 0
  s_cbranch_scc1 w0_42
  v_lshlrev_b32 v246, 8, v1
  v_add_u32 v246, 31498240, v246
  s_mov_b64 exec, 0xffff
  global_load_dword v247, v246, s[32:33] sc1
  s_mov_b64 exec, -1
  s_nop 3

w0_42:
  s_waitcnt lgkmcnt(0)
  s_lshl_b32 s54, s52, 16
  s_and_b32 s55, s52, 0xffff0000
  s_cmp_eq_u32 s41, 0
  s_cselect_b32 s56, s54, s55
  s_mov_b32 s57, s56
  s_cselect_b64 vcc, 0, -1
  s_nop 1
  v_cndmask_b32 v8, v240, v241, vcc
  v_mov_b32 v9, v8

  v_cvt_f32_f16 v152, v144
  v_cvt_f32_f16_sdwa v153, v144 dst_sel:DWORD dst_unused:UNUSED_PAD src0_sel:WORD_1
  v_cvt_f32_f16 v154, v145
  v_cvt_f32_f16_sdwa v155, v145 dst_sel:DWORD dst_unused:UNUSED_PAD src0_sel:WORD_1
  v_cvt_f32_f16 v156, v148
  v_cvt_f32_f16_sdwa v157, v148 dst_sel:DWORD dst_unused:UNUSED_PAD src0_sel:WORD_1
  v_cvt_f32_f16 v158, v149
  v_cvt_f32_f16_sdwa v159, v149 dst_sel:DWORD dst_unused:UNUSED_PAD src0_sel:WORD_1
  v_pk_mul_f32 v[136:137], v[136:137], v[8:9]
  v_pk_mul_f32 v[152:153], v[152:153], s[56:57]
  v_cvt_pk_bf16_f32 v160, v136, v137
  v_cvt_pk_bf16_f32 v161, v152, v153
  v_lshlrev_b32 v136, 16, v160
  v_and_b32 v137, s58, v160
  v_lshlrev_b32 v152, 16, v161
  v_and_b32 v153, s58, v161
  v_pk_add_f32 v[136:137], v[136:137], v[152:153]
  v_lshlrev_b32 v152, 16, v146
  v_and_b32 v153, s58, v146
  v_cvt_pk_bf16_f32 v160, v136, v137
  v_lshlrev_b32 v136, 16, v160
  v_and_b32 v137, s58, v160
  v_pk_add_f32 v[136:137], v[136:137], v[152:153]
  v_cvt_pk_bf16_f32 v164, v136, v137

  v_pk_mul_f32 v[138:139], v[138:139], v[8:9]
  v_pk_mul_f32 v[154:155], v[154:155], s[56:57]
  v_cvt_pk_bf16_f32 v162, v138, v139
  v_cvt_pk_bf16_f32 v163, v154, v155
  v_lshlrev_b32 v138, 16, v162
  v_and_b32 v139, s58, v162
  v_lshlrev_b32 v154, 16, v163
  v_and_b32 v155, s58, v163
  v_pk_add_f32 v[138:139], v[138:139], v[154:155]
  v_lshlrev_b32 v154, 16, v147
  v_and_b32 v155, s58, v147
  v_cvt_pk_bf16_f32 v162, v138, v139
  v_lshlrev_b32 v138, 16, v162
  v_and_b32 v139, s58, v162
  v_pk_add_f32 v[138:139], v[138:139], v[154:155]
  v_cvt_pk_bf16_f32 v165, v138, v139

  global_store_dwordx2 v188, v[164:165], s[32:33] sc1
  v_pk_mul_f32 v[140:141], v[140:141], v[8:9]
  v_pk_mul_f32 v[156:157], v[156:157], s[56:57]
  v_cvt_pk_bf16_f32 v160, v140, v141
  v_cvt_pk_bf16_f32 v161, v156, v157
  v_lshlrev_b32 v140, 16, v160
  v_and_b32 v141, s58, v160
  v_lshlrev_b32 v156, 16, v161
  v_and_b32 v157, s58, v161
  v_pk_add_f32 v[140:141], v[140:141], v[156:157]
  v_lshlrev_b32 v156, 16, v150
  v_and_b32 v157, s58, v150
  v_cvt_pk_bf16_f32 v160, v140, v141
  v_lshlrev_b32 v140, 16, v160
  v_and_b32 v141, s58, v160
  v_pk_add_f32 v[140:141], v[140:141], v[156:157]
  v_cvt_pk_bf16_f32 v166, v140, v141

  v_pk_mul_f32 v[142:143], v[142:143], v[8:9]
  v_pk_mul_f32 v[158:159], v[158:159], s[56:57]
  v_cvt_pk_bf16_f32 v162, v142, v143
  v_cvt_pk_bf16_f32 v163, v158, v159
  v_lshlrev_b32 v142, 16, v162
  v_and_b32 v143, s58, v162
  v_lshlrev_b32 v158, 16, v163
  v_and_b32 v159, s58, v163
  v_pk_add_f32 v[142:143], v[142:143], v[158:159]
  v_lshlrev_b32 v158, 16, v151
  v_and_b32 v159, s58, v151
  v_cvt_pk_bf16_f32 v162, v142, v143
  v_lshlrev_b32 v142, 16, v162
  v_and_b32 v143, s58, v162
  v_pk_add_f32 v[142:143], v[142:143], v[158:159]
  v_cvt_pk_bf16_f32 v167, v142, v143

  global_store_dwordx2 v189, v[166:167], s[32:33] sc1
  s_cmp_lg_u32 s34, 0
  s_cbranch_scc1 w0_45
  s_mov_b64 exec, 0xffff
  s_waitcnt vmcnt(0)
  s_mov_b32 s93, 200000
  v_cmp_ne_u32 vcc, 16, v247
  s_cbranch_vccz gd_44
  gp_43:
  s_sleep 12
  global_load_dword v247, v246, s[32:33] sc1
  s_waitcnt vmcnt(0)
  v_cmp_ne_u32 vcc, 16, v247
  s_cbranch_vccz gd_44
  s_sub_u32 s93, s93, 1
  s_cbranch_scc0 gp_43
  gd_44:
  s_mov_b64 exec, -1

w0_45:
  s_barrier
  global_load_dwordx4 v[220:223], v239, s[32:33]
  v_add_u32 v239, 4096, v239
  global_load_dwordx4 v[224:227], v237, s[32:33]
  v_add_u32 v237, 4096, v237
  global_load_dwordx2 v[216:217], v238, s[32:33]
  v_add_u32 v236, 4096, v238
  global_load_dwordx2 v[218:219], v236, s[32:33]
  v_add_u32 v238, 2048, v238
  s_waitcnt vmcnt(2)
  v_pk_mul_f32 v[220:221], v[220:221], v[12:13]
  v_pk_mul_f32 v[224:225], v[224:225], v[12:13]
  v_pk_fma_f32 v[224:225], v[220:221], v[220:221], v[224:225] neg_lo:[1,0,0] neg_hi:[1,0,0]
  v_cvt_pk_bf16_f32 v16, v220, v221
  v_max_f32 v224, 0, v224
  v_max_f32 v225, 0, v225
  v_cvt_pk_bf16_f32 v20, v224, v225
  v_lshlrev_b32 v220, 16, v16
  v_and_b32 v221, s58, v16
  v_lshlrev_b32 v224, 16, v20
  v_and_b32 v225, s58, v20
  v_pk_add_f32 v[224:225], v[224:225], v[14:15]

  v_pk_mul_f32 v[222:223], v[222:223], v[12:13]
  v_pk_mul_f32 v[226:227], v[226:227], v[12:13]
  v_pk_fma_f32 v[226:227], v[222:223], v[222:223], v[226:227] neg_lo:[1,0,0] neg_hi:[1,0,0]
  v_cvt_pk_bf16_f32 v17, v222, v223
  v_max_f32 v226, 0, v226
  v_max_f32 v227, 0, v227
  v_cvt_pk_bf16_f32 v21, v226, v227
  v_lshlrev_b32 v222, 16, v17
  v_and_b32 v223, s58, v17
  v_lshlrev_b32 v226, 16, v21
  v_and_b32 v227, s58, v21
  v_pk_add_f32 v[226:227], v[226:227], v[14:15]

  v_cvt_pk_bf16_f32 v20, v224, v225
  v_lshlrev_b32 v224, 16, v20
  v_and_b32 v225, s58, v20
  v_sqrt_f32 v224, v224
  v_sqrt_f32 v225, v225

  v_cvt_pk_bf16_f32 v21, v226, v227
  v_lshlrev_b32 v226, 16, v21
  v_and_b32 v227, s58, v21
  v_sqrt_f32 v226, v226
  v_sqrt_f32 v227, v227

  s_nop 0
  v_cvt_pk_bf16_f32 v20, v224, v225
  v_lshlrev_b32 v224, 16, v20
  v_and_b32 v225, s58, v20
  v_rcp_f32 v224, v224
  v_rcp_f32 v225, v225

  v_cvt_pk_bf16_f32 v21, v226, v227
  v_lshlrev_b32 v226, 16, v21
  v_and_b32 v227, s58, v21
  v_rcp_f32 v226, v226
  v_rcp_f32 v227, v227

  s_nop 0
  s_waitcnt vmcnt(0)
  v_lshlrev_b32 v32, 16, v216
  v_and_b32 v33, s58, v216
  v_pk_add_f32 v[32:33], v[32:33], v[220:221] neg_lo:[0,1] neg_hi:[0,1]
  v_cvt_pk_bf16_f32 v184, v32, v33
  v_lshlrev_b32 v32, 16, v184
  v_and_b32 v33, s58, v184
  v_pk_mul_f32 v[32:33], v[32:33], v[224:225]
  v_cvt_pk_bf16_f32 v184, v32, v33
  v_lshlrev_b32 v32, 16, v184
  v_and_b32 v33, s58, v184
  v_cvt_pk_f16_f32 v24, v32, v33

  v_lshlrev_b32 v34, 16, v217
  v_and_b32 v35, s58, v217
  v_pk_add_f32 v[34:35], v[34:35], v[222:223] neg_lo:[0,1] neg_hi:[0,1]
  v_cvt_pk_bf16_f32 v185, v34, v35
  v_lshlrev_b32 v34, 16, v185
  v_and_b32 v35, s58, v185
  v_pk_mul_f32 v[34:35], v[34:35], v[226:227]
  v_cvt_pk_bf16_f32 v185, v34, v35
  v_lshlrev_b32 v34, 16, v185
  v_and_b32 v35, s58, v185
  v_cvt_pk_f16_f32 v25, v34, v35

  ds_write_b64 v7, v[24:25] offset:2048
  v_lshlrev_b32 v36, 16, v218
  v_and_b32 v37, s58, v218
  v_pk_add_f32 v[36:37], v[36:37], v[220:221] neg_lo:[0,1] neg_hi:[0,1]
  v_cvt_pk_bf16_f32 v186, v36, v37
  v_lshlrev_b32 v36, 16, v186
  v_and_b32 v37, s58, v186
  v_pk_mul_f32 v[36:37], v[36:37], v[224:225]
  v_cvt_pk_bf16_f32 v186, v36, v37
  v_lshlrev_b32 v36, 16, v186
  v_and_b32 v37, s58, v186
  v_cvt_pk_f16_f32 v26, v36, v37

  v_lshlrev_b32 v38, 16, v219
  v_and_b32 v39, s58, v219
  v_pk_add_f32 v[38:39], v[38:39], v[222:223] neg_lo:[0,1] neg_hi:[0,1]
  v_cvt_pk_bf16_f32 v187, v38, v39
  v_lshlrev_b32 v38, 16, v187
  v_and_b32 v39, s58, v187
  v_pk_mul_f32 v[38:39], v[38:39], v[226:227]
  v_cvt_pk_bf16_f32 v187, v38, v39
  v_lshlrev_b32 v38, 16, v187
  v_and_b32 v39, s58, v187
  v_cvt_pk_f16_f32 v27, v38, v39

  ds_write_b64 v7, v[26:27] offset:6656
  s_waitcnt vmcnt(4) lgkmcnt(0)
  s_barrier
  s_cmp_lg_u32 s34, 0
  s_cbranch_scc1 w0_46
  s_and_b32 s93, s2, 15
  s_lshl_b32 s93, s93, 8
  s_add_u32 s93, s93, 31473664
  v_mov_b32 v246, s93
  v_mov_b32 v247, 1
  s_mov_b64 exec, 1
  global_atomic_add v246, v247, s[32:33] sc1
  s_mov_b64 exec, -1
  s_nop 3

w0_46:
  ds_read_b64 v[40:41], v4 offset:3584
  ds_read_b64 v[42:43], v4 offset:3592
  ds_read_b128 v[88:91], v5 offset:2048
  ds_read_b128 v[92:95], v5 offset:2560
  ds_read_b128 v[96:99], v5 offset:3072
  ds_read_b128 v[100:103], v5 offset:3584
  ds_read_b128 v[84:87], v5 offset:1536
  ds_read_b128 v[80:83], v5 offset:1024
  ds_read_b128 v[76:79], v5 offset:512
  ds_read_b128 v[72:75], v5 offset:0
  ds_read_b64 v[44:45], v4 offset:3072
  ds_read_b64 v[46:47], v4 offset:3080
  ds_read_b64 v[48:49], v4 offset:2560
  ds_read_b64 v[50:51], v4 offset:2568
  ds_read_b64 v[52:53], v4 offset:2048
  ds_read_b64 v[54:55], v4 offset:2056
  ds_read_b64 v[56:57], v4 offset:1536
  ds_read_b64 v[58:59], v4 offset:1544
  ds_read_b64 v[60:61], v4 offset:1024
  ds_read_b64 v[62:63], v4 offset:1032
  ds_read_b64 v[64:65], v4 offset:512
  ds_read_b64 v[66:67], v4 offset:520
  ds_read_b64 v[68:69], v4 offset:0
  ds_read_b64 v[70:71], v4 offset:8
  v_subrev_u32 v4, 64, v4
  v_subrev_u32 v5, 64, v5
  s_waitcnt lgkmcnt(0)
  v_mfma_f32_16x16x32_f16 v[168:171], v[40:43], v[88:91], 0
  ds_read_b64 v[104:105], v4 offset:3584
  v_mfma_f32_16x16x32_f16 v[172:175], v[40:43], v[92:95], 0
  ds_read_b64 v[106:107], v4 offset:3592
  v_mfma_f32_16x16x32_f16 v[176:179], v[40:43], v[96:99], 0
  ds_read_b128 v[152:155], v5 offset:2048
  v_mfma_f32_16x16x32_f16 v[180:183], v[40:43], v[100:103], 0
  ds_read_b128 v[156:159], v5 offset:2560
  v_mfma_f32_16x16x32_f16 v[168:171], v[44:47], v[84:87], v[168:171]
  ds_read_b128 v[160:163], v5 offset:3072
  v_mfma_f32_16x16x32_f16 v[172:175], v[44:47], v[88:91], v[172:175]
  ds_read_b128 v[164:167], v5 offset:3584
  v_mfma_f32_16x16x32_f16 v[176:179], v[44:47], v[92:95], v[176:179]
  ds_read_b128 v[148:151], v5 offset:1536
  v_mfma_f32_16x16x32_f16 v[180:183], v[44:47], v[96:99], v[180:183]
  ds_read_b128 v[144:147], v5 offset:1024
  v_mfma_f32_16x16x32_f16 v[168:171], v[48:51], v[80:83], v[168:171]
  ds_read_b128 v[140:143], v5 offset:512
  v_mfma_f32_16x16x32_f16 v[172:175], v[48:51], v[84:87], v[172:175]
  ds_read_b128 v[136:139], v5 offset:0
  v_mfma_f32_16x16x32_f16 v[176:179], v[48:51], v[88:91], v[176:179]
  ds_read_b64 v[108:109], v4 offset:3072
  v_mfma_f32_16x16x32_f16 v[180:183], v[48:51], v[92:95], v[180:183]
  ds_read_b64 v[110:111], v4 offset:3080
  v_mfma_f32_16x16x32_f16 v[168:171], v[52:55], v[76:79], v[168:171]
  ds_read_b64 v[112:113], v4 offset:2560
  v_mfma_f32_16x16x32_f16 v[172:175], v[52:55], v[80:83], v[172:175]
  ds_read_b64 v[114:115], v4 offset:2568
  v_mfma_f32_16x16x32_f16 v[176:179], v[52:55], v[84:87], v[176:179]
  ds_read_b64 v[116:117], v4 offset:2048
  v_mfma_f32_16x16x32_f16 v[180:183], v[52:55], v[88:91], v[180:183]
  ds_read_b64 v[118:119], v4 offset:2056
  v_mfma_f32_16x16x32_f16 v[168:171], v[56:59], v[72:75], v[168:171]
  ds_read_b64 v[120:121], v4 offset:1536
  v_mfma_f32_16x16x32_f16 v[172:175], v[56:59], v[76:79], v[172:175]
  ds_read_b64 v[122:123], v4 offset:1544
  v_mfma_f32_16x16x32_f16 v[176:179], v[56:59], v[80:83], v[176:179]
  ds_read_b64 v[124:125], v4 offset:1024
  v_mfma_f32_16x16x32_f16 v[180:183], v[56:59], v[84:87], v[180:183]
  ds_read_b64 v[126:127], v4 offset:1032
  v_mfma_f32_16x16x32_f16 v[172:175], v[60:63], v[72:75], v[172:175]
  ds_read_b64 v[128:129], v4 offset:512
  v_mfma_f32_16x16x32_f16 v[176:179], v[60:63], v[76:79], v[176:179]
  ds_read_b64 v[130:131], v4 offset:520
  v_mfma_f32_16x16x32_f16 v[180:183], v[60:63], v[80:83], v[180:183]
  ds_read_b64 v[132:133], v4 offset:0
  v_mfma_f32_16x16x32_f16 v[176:179], v[64:67], v[72:75], v[176:179]
  ds_read_b64 v[134:135], v4 offset:8
  v_mfma_f32_16x16x32_f16 v[180:183], v[64:67], v[76:79], v[180:183]
  v_subrev_u32 v4, 64, v4
  v_subrev_u32 v5, 64, v5
  v_mfma_f32_16x16x32_f16 v[180:183], v[68:71], v[72:75], v[180:183]
  s_waitcnt lgkmcnt(0)
  v_mfma_f32_16x16x32_f16 v[168:171], v[104:107], v[152:155], v[168:171]
  ds_read_b64 v[40:41], v4 offset:3584
  v_mfma_f32_16x16x32_f16 v[172:175], v[104:107], v[156:159], v[172:175]
  ds_read_b64 v[42:43], v4 offset:3592
  v_mfma_f32_16x16x32_f16 v[176:179], v[104:107], v[160:163], v[176:179]
  ds_read_b128 v[88:91], v5 offset:2048
  v_mfma_f32_16x16x32_f16 v[180:183], v[104:107], v[164:167], v[180:183]
  ds_read_b128 v[92:95], v5 offset:2560
  v_mfma_f32_16x16x32_f16 v[168:171], v[108:111], v[148:151], v[168:171]
  ds_read_b128 v[96:99], v5 offset:3072
  v_mfma_f32_16x16x32_f16 v[172:175], v[108:111], v[152:155], v[172:175]
  ds_read_b128 v[100:103], v5 offset:3584
  v_mfma_f32_16x16x32_f16 v[176:179], v[108:111], v[156:159], v[176:179]
  ds_read_b128 v[84:87], v5 offset:1536
  v_mfma_f32_16x16x32_f16 v[180:183], v[108:111], v[160:163], v[180:183]
  ds_read_b128 v[80:83], v5 offset:1024
  v_mfma_f32_16x16x32_f16 v[168:171], v[112:115], v[144:147], v[168:171]
  ds_read_b128 v[76:79], v5 offset:512
  v_mfma_f32_16x16x32_f16 v[172:175], v[112:115], v[148:151], v[172:175]
  ds_read_b128 v[72:75], v5 offset:0
  v_mfma_f32_16x16x32_f16 v[176:179], v[112:115], v[152:155], v[176:179]
  ds_read_b64 v[44:45], v4 offset:3072
  v_mfma_f32_16x16x32_f16 v[180:183], v[112:115], v[156:159], v[180:183]
  ds_read_b64 v[46:47], v4 offset:3080
  v_mfma_f32_16x16x32_f16 v[168:171], v[116:119], v[140:143], v[168:171]
  ds_read_b64 v[48:49], v4 offset:2560
  v_mfma_f32_16x16x32_f16 v[172:175], v[116:119], v[144:147], v[172:175]
  ds_read_b64 v[50:51], v4 offset:2568
  v_mfma_f32_16x16x32_f16 v[176:179], v[116:119], v[148:151], v[176:179]
  ds_read_b64 v[52:53], v4 offset:2048
  v_mfma_f32_16x16x32_f16 v[180:183], v[116:119], v[152:155], v[180:183]
  ds_read_b64 v[54:55], v4 offset:2056
  v_mfma_f32_16x16x32_f16 v[168:171], v[120:123], v[136:139], v[168:171]
  ds_read_b64 v[56:57], v4 offset:1536
  v_mfma_f32_16x16x32_f16 v[172:175], v[120:123], v[140:143], v[172:175]
  ds_read_b64 v[58:59], v4 offset:1544
  v_mfma_f32_16x16x32_f16 v[176:179], v[120:123], v[144:147], v[176:179]
  ds_read_b64 v[60:61], v4 offset:1024
  v_mfma_f32_16x16x32_f16 v[180:183], v[120:123], v[148:151], v[180:183]
  ds_read_b64 v[62:63], v4 offset:1032
  v_mfma_f32_16x16x32_f16 v[172:175], v[124:127], v[136:139], v[172:175]
  ds_read_b64 v[64:65], v4 offset:512
  v_mfma_f32_16x16x32_f16 v[176:179], v[124:127], v[140:143], v[176:179]
  ds_read_b64 v[66:67], v4 offset:520
  v_mfma_f32_16x16x32_f16 v[180:183], v[124:127], v[144:147], v[180:183]
  ds_read_b64 v[68:69], v4 offset:0
  v_mfma_f32_16x16x32_f16 v[176:179], v[128:131], v[136:139], v[176:179]
  ds_read_b64 v[70:71], v4 offset:8
  v_mfma_f32_16x16x32_f16 v[180:183], v[128:131], v[140:143], v[180:183]
  v_subrev_u32 v4, 64, v4
  v_subrev_u32 v5, 64, v5
  v_mfma_f32_16x16x32_f16 v[180:183], v[132:135], v[136:139], v[180:183]
  s_waitcnt lgkmcnt(0)
  v_mfma_f32_16x16x32_f16 v[168:171], v[40:43], v[88:91], v[168:171]
  ds_read_b64 v[104:105], v4 offset:3584
  v_mfma_f32_16x16x32_f16 v[172:175], v[40:43], v[92:95], v[172:175]
  ds_read_b64 v[106:107], v4 offset:3592
  v_mfma_f32_16x16x32_f16 v[176:179], v[40:43], v[96:99], v[176:179]
  ds_read_b128 v[152:155], v5 offset:2048
  v_mfma_f32_16x16x32_f16 v[180:183], v[40:43], v[100:103], v[180:183]
  ds_read_b128 v[156:159], v5 offset:2560
  v_mfma_f32_16x16x32_f16 v[168:171], v[44:47], v[84:87], v[168:171]
  ds_read_b128 v[160:163], v5 offset:3072
  v_mfma_f32_16x16x32_f16 v[172:175], v[44:47], v[88:91], v[172:175]
  ds_read_b128 v[164:167], v5 offset:3584
  v_mfma_f32_16x16x32_f16 v[176:179], v[44:47], v[92:95], v[176:179]
  ds_read_b128 v[148:151], v5 offset:1536
  v_mfma_f32_16x16x32_f16 v[180:183], v[44:47], v[96:99], v[180:183]
  ds_read_b128 v[144:147], v5 offset:1024
  v_mfma_f32_16x16x32_f16 v[168:171], v[48:51], v[80:83], v[168:171]
  ds_read_b128 v[140:143], v5 offset:512
  v_mfma_f32_16x16x32_f16 v[172:175], v[48:51], v[84:87], v[172:175]
  ds_read_b128 v[136:139], v5 offset:0
  v_mfma_f32_16x16x32_f16 v[176:179], v[48:51], v[88:91], v[176:179]
  ds_read_b64 v[108:109], v4 offset:3072
  v_mfma_f32_16x16x32_f16 v[180:183], v[48:51], v[92:95], v[180:183]
  ds_read_b64 v[110:111], v4 offset:3080
  v_mfma_f32_16x16x32_f16 v[168:171], v[52:55], v[76:79], v[168:171]
  ds_read_b64 v[112:113], v4 offset:2560
  v_mfma_f32_16x16x32_f16 v[172:175], v[52:55], v[80:83], v[172:175]
  ds_read_b64 v[114:115], v4 offset:2568
  v_mfma_f32_16x16x32_f16 v[176:179], v[52:55], v[84:87], v[176:179]
  ds_read_b64 v[116:117], v4 offset:2048
  v_mfma_f32_16x16x32_f16 v[180:183], v[52:55], v[88:91], v[180:183]
  ds_read_b64 v[118:119], v4 offset:2056
  v_mfma_f32_16x16x32_f16 v[168:171], v[56:59], v[72:75], v[168:171]
  ds_read_b64 v[120:121], v4 offset:1536
  v_mfma_f32_16x16x32_f16 v[172:175], v[56:59], v[76:79], v[172:175]
  ds_read_b64 v[122:123], v4 offset:1544
  v_mfma_f32_16x16x32_f16 v[176:179], v[56:59], v[80:83], v[176:179]
  ds_read_b64 v[124:125], v4 offset:1024
  v_mfma_f32_16x16x32_f16 v[180:183], v[56:59], v[84:87], v[180:183]
  ds_read_b64 v[126:127], v4 offset:1032
  v_mfma_f32_16x16x32_f16 v[172:175], v[60:63], v[72:75], v[172:175]
  ds_read_b64 v[128:129], v4 offset:512
  v_mfma_f32_16x16x32_f16 v[176:179], v[60:63], v[76:79], v[176:179]
  ds_read_b64 v[130:131], v4 offset:520
  v_mfma_f32_16x16x32_f16 v[180:183], v[60:63], v[80:83], v[180:183]
  ds_read_b64 v[132:133], v4 offset:0
  v_mfma_f32_16x16x32_f16 v[176:179], v[64:67], v[72:75], v[176:179]
  ds_read_b64 v[134:135], v4 offset:8
  v_mfma_f32_16x16x32_f16 v[180:183], v[64:67], v[76:79], v[180:183]
  v_subrev_u32 v4, 64, v4
  v_subrev_u32 v5, 64, v5
  v_mfma_f32_16x16x32_f16 v[180:183], v[68:71], v[72:75], v[180:183]
  s_waitcnt lgkmcnt(0)
  s_cmp_lg_u32 s34, 0
  s_cbranch_scc1 w0_47
  v_lshlrev_b32 v246, 8, v1
  v_add_u32 v246, 31473664, v246
  s_mov_b64 exec, 0xffff
  global_load_dword v247, v246, s[32:33] sc1
  s_mov_b64 exec, -1
  s_nop 3

w0_47:
  v_mfma_f32_16x16x32_f16 v[168:171], v[104:107], v[152:155], v[168:171]
  v_mfma_f32_16x16x32_f16 v[172:175], v[104:107], v[156:159], v[172:175]
  v_mfma_f32_16x16x32_f16 v[176:179], v[104:107], v[160:163], v[176:179]
  v_mfma_f32_16x16x32_f16 v[180:183], v[104:107], v[164:167], v[180:183]
  v_mfma_f32_16x16x32_f16 v[168:171], v[108:111], v[148:151], v[168:171]
  v_mfma_f32_16x16x32_f16 v[172:175], v[108:111], v[152:155], v[172:175]
  v_mfma_f32_16x16x32_f16 v[176:179], v[108:111], v[156:159], v[176:179]
  v_mfma_f32_16x16x32_f16 v[180:183], v[108:111], v[160:163], v[180:183]
  v_mfma_f32_16x16x32_f16 v[168:171], v[112:115], v[144:147], v[168:171]
  v_mfma_f32_16x16x32_f16 v[172:175], v[112:115], v[148:151], v[172:175]
  v_mfma_f32_16x16x32_f16 v[176:179], v[112:115], v[152:155], v[176:179]
  v_mfma_f32_16x16x32_f16 v[180:183], v[112:115], v[156:159], v[180:183]
  v_mfma_f32_16x16x32_f16 v[168:171], v[116:119], v[140:143], v[168:171]
  v_mfma_f32_16x16x32_f16 v[172:175], v[116:119], v[144:147], v[172:175]
  v_mfma_f32_16x16x32_f16 v[176:179], v[116:119], v[148:151], v[176:179]
  v_mfma_f32_16x16x32_f16 v[180:183], v[116:119], v[152:155], v[180:183]
  v_mfma_f32_16x16x32_f16 v[168:171], v[120:123], v[136:139], v[168:171]
  v_mfma_f32_16x16x32_f16 v[172:175], v[120:123], v[140:143], v[172:175]
  v_mfma_f32_16x16x32_f16 v[176:179], v[120:123], v[144:147], v[176:179]
  v_mfma_f32_16x16x32_f16 v[180:183], v[120:123], v[148:151], v[180:183]
  v_mfma_f32_16x16x32_f16 v[172:175], v[124:127], v[136:139], v[172:175]
  v_mfma_f32_16x16x32_f16 v[176:179], v[124:127], v[140:143], v[176:179]
  v_mfma_f32_16x16x32_f16 v[180:183], v[124:127], v[144:147], v[180:183]
  v_mfma_f32_16x16x32_f16 v[176:179], v[128:131], v[136:139], v[176:179]
  v_mfma_f32_16x16x32_f16 v[180:183], v[128:131], v[140:143], v[180:183]
  v_mfma_f32_16x16x32_f16 v[180:183], v[132:135], v[136:139], v[180:183]
  s_cmp_lg_u32 s34, 0
  s_cbranch_scc1 w0_50
  s_mov_b64 exec, 0xffff
  s_waitcnt vmcnt(0)
  s_mov_b32 s93, 200000
  v_cmp_ne_u32 vcc, 16, v247
  s_cbranch_vccz gd_49
  gp_48:
  s_sleep 12
  global_load_dword v247, v246, s[32:33] sc1
  s_waitcnt vmcnt(0)
  v_cmp_ne_u32 vcc, 16, v247
  s_cbranch_vccz gd_49
  s_sub_u32 s93, s93, 1
  s_cbranch_scc0 gp_48
  gd_49:
  s_mov_b64 exec, -1

w0_50:
  s_barrier
  s_nop 7
  ds_write_b128 v6, v[168:171] offset:0
  ds_write_b128 v6, v[172:175] offset:1024
  ds_write_b128 v6, v[176:179] offset:2048
  ds_write_b128 v6, v[180:183] offset:3072
  s_add_u32 s40, s32, 6291456
  s_addc_u32 s41, s33, 0
  s_lshl_b32 s44, s38, 1
  s_lshr_b32 s45, s34, 1
  s_add_u32 s44, s44, s45
  s_lshl_b32 s44, s44, 15
  s_and_b32 s45, s34, 1
  s_lshl_b32 s45, s45, 5
  s_add_u32 s44, s44, s45
  v_lshrrev_b32 v2, 1, v1
  v_and_b32 v3, 0x13, v2
  v_and_b32 v4, 4, v2
  v_lshl_or_b32 v3, v4, 1, v3
  v_and_b32 v4, 8, v2
  v_lshrrev_b32 v4, 1, v4
  v_or_b32 v3, v3, v4
  v_lshlrev_b32 v4, 6, v3
  v_and_b32 v3, 1, v1
  v_lshl_add_u32 v4, v3, 4, v4
  v_add_u32 v4, s44, v4
  s_mul_i32 s64, s34, 6144
  s_add_u32 s64, s64, 131072

  s_add_u32 s65, s64, 1024
  s_add_u32 s66, s64, 2048
  s_add_u32 s67, s64, 3072
  s_add_u32 s68, s64, 4096
  s_add_u32 s69, s64, 5120
  s_mov_b32 m0, s64
  s_nop 0
  global_load_lds_dwordx4 v4, s[40:41]
  v_add_u32 v4, 2048, v4
  s_mov_b32 m0, s65
  s_nop 0
  global_load_lds_dwordx4 v4, s[40:41]
  v_add_u32 v4, 2048, v4
  s_mov_b32 m0, s66
  s_nop 0
  global_load_lds_dwordx4 v4, s[40:41]
  v_add_u32 v4, 2048, v4
  s_mov_b32 m0, s67
  s_nop 0
  global_load_lds_dwordx4 v4, s[40:41]
  v_add_u32 v4, 2048, v4
  s_mov_b32 m0, s68
  s_nop 0
  global_load_lds_dwordx4 v4, s[40:41]
  v_add_u32 v4, 2048, v4
  s_mov_b32 m0, s69
  s_nop 0
  global_load_lds_dwordx4 v4, s[40:41]
  v_add_u32 v4, 2048, v4
  v_lshrrev_b32 v242, 3, v0
  v_lshlrev_b32 v242, 15, v242
  v_and_b32 v243, 7, v0
  v_lshl_add_u32 v242, v243, 3, v242
  s_lshl_b32 s43, s37, 6
  s_add_u32 s43, s43, 7340032
  v_add_u32 v242, s43, v242
  v_lshlrev_b32 v3, 4, v0
  v_add_u32 v3, 114688, v3
  v_mov_b32 v8, v240
  v_mov_b32 v9, v240
  v_mov_b32 v10, v241
  v_mov_b32 v11, v241
  s_mov_b32 s56, s54
  s_mov_b32 s57, s54
  s_mov_b32 s60, s55
  s_mov_b32 s61, s55
  s_waitcnt lgkmcnt(0)
  s_barrier

  ds_read_b128 v[40:43], v3 offset:0
  ds_read_b128 v[44:47], v3 offset:4096
  ds_read_b128 v[48:51], v3 offset:8192
  ds_read_b128 v[52:55], v3 offset:12288
  v_lshlrev_b32 v60, 16, v184
  v_and_b32 v61, s58, v184
  v_lshlrev_b32 v62, 16, v185
  v_and_b32 v63, s58, v185
  v_lshlrev_b32 v64, 16, v186
  v_and_b32 v65, s58, v186
  v_lshlrev_b32 v66, 16, v187
  v_and_b32 v67, s58, v187
  s_waitcnt lgkmcnt(2)
  v_pk_add_f32 v[40:41], v[40:41], v[44:45]
  v_pk_mul_f32 v[40:41], v[40:41], v[8:9]
  v_pk_mul_f32 v[60:61], v[60:61], s[56:57]
  v_cvt_pk_bf16_f32 v70, v40, v41
  v_cvt_pk_bf16_f32 v71, v60, v61
  v_lshlrev_b32 v40, 16, v70
  v_and_b32 v41, s58, v70
  v_lshlrev_b32 v60, 16, v71
  v_and_b32 v61, s58, v71
  v_pk_add_f32 v[40:41], v[40:41], v[60:61]
  v_lshlrev_b32 v60, 16, v216
  v_and_b32 v61, s58, v216
  v_cvt_pk_bf16_f32 v70, v40, v41
  v_lshlrev_b32 v40, 16, v70
  v_and_b32 v41, s58, v70
  v_pk_add_f32 v[40:41], v[40:41], v[60:61]
  v_cvt_pk_bf16_f32 v76, v40, v41

  v_pk_add_f32 v[42:43], v[42:43], v[46:47]
  v_pk_mul_f32 v[42:43], v[42:43], v[8:9]
  v_pk_mul_f32 v[62:63], v[62:63], s[56:57]
  v_cvt_pk_bf16_f32 v72, v42, v43
  v_cvt_pk_bf16_f32 v73, v62, v63
  v_lshlrev_b32 v42, 16, v72
  v_and_b32 v43, s58, v72
  v_lshlrev_b32 v62, 16, v73
  v_and_b32 v63, s58, v73
  v_pk_add_f32 v[42:43], v[42:43], v[62:63]
  v_lshlrev_b32 v62, 16, v217
  v_and_b32 v63, s58, v217
  v_cvt_pk_bf16_f32 v72, v42, v43
  v_lshlrev_b32 v42, 16, v72
  v_and_b32 v43, s58, v72
  v_pk_add_f32 v[42:43], v[42:43], v[62:63]
  v_cvt_pk_bf16_f32 v77, v42, v43

  global_store_dwordx2 v242, v[76:77], s[32:33] offset:0 sc1
  s_waitcnt lgkmcnt(0)
  v_pk_add_f32 v[48:49], v[48:49], v[52:53]
  v_pk_mul_f32 v[48:49], v[48:49], v[10:11]
  v_pk_mul_f32 v[64:65], v[64:65], s[60:61]
  v_cvt_pk_bf16_f32 v70, v48, v49
  v_cvt_pk_bf16_f32 v71, v64, v65
  v_lshlrev_b32 v48, 16, v70
  v_and_b32 v49, s58, v70
  v_lshlrev_b32 v64, 16, v71
  v_and_b32 v65, s58, v71
  v_pk_add_f32 v[48:49], v[48:49], v[64:65]
  v_lshlrev_b32 v64, 16, v218
  v_and_b32 v65, s58, v218
  v_cvt_pk_bf16_f32 v70, v48, v49
  v_lshlrev_b32 v48, 16, v70
  v_and_b32 v49, s58, v70
  v_pk_add_f32 v[48:49], v[48:49], v[64:65]
  v_cvt_pk_bf16_f32 v78, v48, v49

  v_pk_add_f32 v[50:51], v[50:51], v[54:55]
  v_pk_mul_f32 v[50:51], v[50:51], v[10:11]
  v_pk_mul_f32 v[66:67], v[66:67], s[60:61]
  v_cvt_pk_bf16_f32 v72, v50, v51
  v_cvt_pk_bf16_f32 v73, v66, v67
  v_lshlrev_b32 v50, 16, v72
  v_and_b32 v51, s58, v72
  v_lshlrev_b32 v66, 16, v73
  v_and_b32 v67, s58, v73
  v_pk_add_f32 v[50:51], v[50:51], v[66:67]
  v_lshlrev_b32 v66, 16, v219
  v_and_b32 v67, s58, v219
  v_cvt_pk_bf16_f32 v72, v50, v51
  v_lshlrev_b32 v50, 16, v72
  v_and_b32 v51, s58, v72
  v_pk_add_f32 v[50:51], v[50:51], v[66:67]
  v_cvt_pk_bf16_f32 v79, v50, v51

  global_store_dwordx2 v242, v[78:79], s[32:33] offset:64 sc1
  s_add_u32 s42, s32, 16777216
  s_addc_u32 s43, s33, 0
  s_add_u32 s90, s32, 31477760
  s_addc_u32 s91, s33, 0
  v_and_b32 v2, 15, v1
  v_lshrrev_b32 v3, 4, v1
  v_lshlrev_b32 v6, 4, v1
  v_add_u32 v6, 0, v6
  v_add_u32 v7, 57344, v6
  v_and_b32 v9, 1, v3
  v_lshlrev_b32 v9, 2, v9
  v_lshrrev_b32 v10, 1, v3
  v_lshl_add_u32 v9, v10, 4, v9
  v_lshrrev_b32 v10, 2, v2
  v_add_u32 v9, v9, v10
  v_lshlrev_b32 v9, 5, v9
  v_and_b32 v10, 3, v2
  v_lshl_add_u32 v9, v10, 3, v9
  v_add_u32 v9, s64, v9
  v_mov_b32 v11, 0x3f803f80
  v_accvgpr_write_b32 a224, v11
  v_accvgpr_write_b32 a225, v11
  v_accvgpr_write_b32 a226, v11
  v_accvgpr_write_b32 a227, v11
  v_lshlrev_b32 v13, 4, v3
  v_add_u32 v13, 162880, v13
  v_and_b32 v5, 1, v3
  v_lshlrev_b32 v5, 1, v5
  v_lshrrev_b32 v10, 1, v3
  v_add_u32 v5, v5, v10
  v_lshlrev_b32 v5, 11, v5
  v_add_u32 v5, v5, v2
  s_lshl_b32 s45, s38, 6
  s_lshl_b32 s46, s34, 4
  s_add_u32 s45, s45, s46
  v_add_u32 v5, s45, v5
  v_lshlrev_b32 v5, 4, v5
  s_mul_i32 s46, s39, 458752
  v_add_u32 v5, s46, v5
  v_lshlrev_b32 v12, 11, v10
  v_add_u32 v12, v12, v2
  v_add_u32 v12, s45, v12
  v_lshlrev_b32 v12, 4, v12
  v_and_b32 v10, 1, v3
  v_lshl_add_u32 v12, v10, 3, v12
  s_add_u32 s46, s46, 393216
  v_add_u32 v12, s46, v12
  s_mov_b32 s56, 0x3b000000
  s_mov_b32 s57, 0x3727c5ac
  s_mov_b32 s58, 0xffff0000
  s_mov_b32 s70, 0xc0135761
  s_mov_b32 s71, 0xc0135761
  v_mov_b32 v14, 0xbdd2d3e8
  v_mov_b32 v15, 0xbdd2d3e8
  s_lshr_b32 s47, s36, 3
  s_lshl_b32 s48, s35, 2
  s_add_u32 s47, s47, s48
  s_lshl_b32 s48, s47, 5
  s_and_b32 s49, s36, 7
  v_lshlrev_b32 v248, 11, v3
  v_add_u32 v248, v248, v2
  v_add_u32 v248, s48, v248
  v_lshlrev_b32 v248, 4, v248
  s_mul_i32 s50, s34, 1835008
  v_add_u32 v248, s50, v248
  s_lshl_b32 s50, s47, 15
  s_lshl_b32 s51, s49, 12
  s_add_u32 s50, s50, s51
  v_lshlrev_b32 v249, 4, v0
  v_add_u32 v249, s50, v249
  s_lshl_b32 s50, s49, 3
  s_lshl_b32 s51, s34, 1
  s_add_u32 s50, s50, s51
  v_lshrrev_b32 v250, 5, v1
  v_add_u32 v250, s50, v250
  v_lshlrev_b32 v251, 4, v250
  global_load_dwordx4 v[244:247], v251, s[26:27]
  s_lshl_b32 s92, s38, 8
  s_waitcnt vmcnt(9) lgkmcnt(0)
  s_barrier

  ds_read_b128 v[16:19], v6 offset:0
  ds_read_b128 v[20:23], v6 offset:1024
  ds_read_b128 v[24:27], v6 offset:2048
  ds_read_b128 v[28:31], v6 offset:3072
  ds_read_b128 v[32:35], v6 offset:4096
  ds_read_b128 v[36:39], v6 offset:5120
  ds_read_b128 v[40:43], v6 offset:6144
  s_waitcnt vmcnt(8)
  ds_read_b64_tr_b16 v[100:101], v9 offset:0
  ds_read_b64_tr_b16 v[102:103], v9 offset:256
  ds_read_b128 v[44:47], v6 offset:7168
  ds_read_b128 v[48:51], v6 offset:8192
  ds_read_b128 v[52:55], v6 offset:9216
  ds_read_b128 v[56:59], v6 offset:10240
  ds_read_b128 v[60:63], v6 offset:11264
  ds_read_b128 v[64:67], v6 offset:12288
  ds_read_b128 v[68:71], v6 offset:13312
  s_waitcnt vmcnt(7)
  ds_read_b64_tr_b16 v[104:105], v9 offset:1024
  ds_read_b64_tr_b16 v[106:107], v9 offset:1280
  s_waitcnt lgkmcnt(9)
  v_mfma_f32_16x16x32_bf16 a[228:231], a[224:227], v[100:103], 0
  s_mov_b32 m0, s64
  s_nop 0
  global_load_lds_dwordx4 v4, s[40:41]
  v_add_u32 v4, 2048, v4
  ds_read_b128 v[72:75], v6 offset:14336
  v_mfma_f32_16x16x32_bf16 a[236:239], v[100:103], v[100:103], 0
  ds_read_b128 v[76:79], v6 offset:15360
  v_mfma_f32_16x16x32_bf16 v[112:115], v[16:19], v[100:103], 0
  ds_read_b128 v[80:83], v6 offset:16384
  v_mfma_f32_16x16x32_bf16 v[116:119], v[20:23], v[100:103], 0
  ds_read_b128 v[84:87], v6 offset:17408
  v_mfma_f32_16x16x32_bf16 v[120:123], v[24:27], v[100:103], 0
  ds_read_b128 v[88:91], v6 offset:18432
  v_mfma_f32_16x16x32_bf16 v[124:127], v[28:31], v[100:103], 0
  ds_read_b128 v[92:95], v6 offset:19456
  v_mfma_f32_16x16x32_bf16 v[128:131], v[32:35], v[100:103], 0
  ds_read_b128 v[96:99], v6 offset:20480
  v_mfma_f32_16x16x32_bf16 v[132:135], v[36:39], v[100:103], 0
  s_waitcnt vmcnt(7)
  ds_read_b64_tr_b16 v[108:109], v9 offset:2048
  v_mfma_f32_16x16x32_bf16 v[136:139], v[40:43], v[100:103], 0
  ds_read_b64_tr_b16 v[110:111], v9 offset:2304
  s_waitcnt lgkmcnt(9)
  v_mfma_f32_16x16x32_bf16 a[228:231], a[224:227], v[104:107], a[228:231]
  s_mov_b32 m0, s65
  s_nop 0
  global_load_lds_dwordx4 v4, s[40:41]
  v_add_u32 v4, 2048, v4
  ds_read_b128 v[16:19], v6 offset:21504
  v_mfma_f32_16x16x32_bf16 a[236:239], v[104:107], v[104:107], a[236:239]
  ds_read_b128 v[20:23], v6 offset:22528
  v_mfma_f32_16x16x32_bf16 v[112:115], v[44:47], v[104:107], v[112:115]
  ds_read_b128 v[24:27], v6 offset:23552
  v_mfma_f32_16x16x32_bf16 v[116:119], v[48:51], v[104:107], v[116:119]
  ds_read_b128 v[28:31], v6 offset:24576
  v_mfma_f32_16x16x32_bf16 v[120:123], v[52:55], v[104:107], v[120:123]
  ds_read_b128 v[32:35], v6 offset:25600
  v_mfma_f32_16x16x32_bf16 v[124:127], v[56:59], v[104:107], v[124:127]
  ds_read_b128 v[36:39], v6 offset:26624
  v_mfma_f32_16x16x32_bf16 v[128:131], v[60:63], v[104:107], v[128:131]
  ds_read_b128 v[40:43], v6 offset:27648
  v_mfma_f32_16x16x32_bf16 v[132:135], v[64:67], v[104:107], v[132:135]
  s_waitcnt vmcnt(7)
  ds_read_b64_tr_b16 v[100:101], v9 offset:3072
  v_mfma_f32_16x16x32_bf16 v[136:139], v[68:71], v[104:107], v[136:139]
  ds_read_b64_tr_b16 v[102:103], v9 offset:3328
  s_waitcnt lgkmcnt(9)
  v_mfma_f32_16x16x32_bf16 a[228:231], a[224:227], v[108:111], a[228:231]
  s_mov_b32 m0, s66
  s_nop 0
  global_load_lds_dwordx4 v4, s[40:41]
  v_add_u32 v4, 2048, v4
  ds_read_b128 v[44:47], v6 offset:28672
  v_mfma_f32_16x16x32_bf16 a[236:239], v[108:111], v[108:111], a[236:239]
  ds_read_b128 v[48:51], v6 offset:29696
  v_mfma_f32_16x16x32_bf16 v[112:115], v[72:75], v[108:111], v[112:115]
  ds_read_b128 v[52:55], v6 offset:30720
  v_mfma_f32_16x16x32_bf16 v[116:119], v[76:79], v[108:111], v[116:119]
  ds_read_b128 v[56:59], v6 offset:31744
  v_mfma_f32_16x16x32_bf16 v[120:123], v[80:83], v[108:111], v[120:123]
  ds_read_b128 v[60:63], v6 offset:32768
  v_mfma_f32_16x16x32_bf16 v[124:127], v[84:87], v[108:111], v[124:127]
  ds_read_b128 v[64:67], v6 offset:33792
  v_mfma_f32_16x16x32_bf16 v[128:131], v[88:91], v[108:111], v[128:131]
  ds_read_b128 v[68:71], v6 offset:34816
  v_mfma_f32_16x16x32_bf16 v[132:135], v[92:95], v[108:111], v[132:135]
  s_waitcnt vmcnt(7)
  ds_read_b64_tr_b16 v[104:105], v9 offset:4096
  v_mfma_f32_16x16x32_bf16 v[136:139], v[96:99], v[108:111], v[136:139]
  ds_read_b64_tr_b16 v[106:107], v9 offset:4352
  s_waitcnt lgkmcnt(9)
  s_waitcnt vmcnt(4)
  s_barrier
  s_cmp_lg_u32 s34, 0
  s_cbranch_scc1 w0_51
  s_and_b32 s93, s2, 15
  s_lshl_b32 s93, s93, 8
  s_add_u32 s93, s93, 31494144
  v_mov_b32 v251, s93
  v_mov_b32 v11, 1
  s_mov_b64 exec, 1
  global_atomic_add v251, v11, s[32:33] sc1
  s_mov_b64 exec, -1
  s_nop 3

w0_51:
  v_mfma_f32_16x16x32_bf16 a[228:231], a[224:227], v[100:103], a[228:231]
  s_mov_b32 m0, s67
  s_nop 0
  global_load_lds_dwordx4 v4, s[40:41]
  v_add_u32 v4, 2048, v4
  ds_read_b128 v[72:75], v6 offset:35840
  v_mfma_f32_16x16x32_bf16 a[236:239], v[100:103], v[100:103], a[236:239]
  ds_read_b128 v[76:79], v6 offset:36864
  v_mfma_f32_16x16x32_bf16 v[112:115], v[16:19], v[100:103], v[112:115]
  ds_read_b128 v[80:83], v6 offset:37888
  v_mfma_f32_16x16x32_bf16 v[116:119], v[20:23], v[100:103], v[116:119]
  ds_read_b128 v[84:87], v6 offset:38912
  v_mfma_f32_16x16x32_bf16 v[120:123], v[24:27], v[100:103], v[120:123]
  ds_read_b128 v[88:91], v6 offset:39936
  v_mfma_f32_16x16x32_bf16 v[124:127], v[28:31], v[100:103], v[124:127]
  ds_read_b128 v[92:95], v6 offset:40960
  v_mfma_f32_16x16x32_bf16 v[128:131], v[32:35], v[100:103], v[128:131]
  ds_read_b128 v[96:99], v6 offset:41984
  v_mfma_f32_16x16x32_bf16 v[132:135], v[36:39], v[100:103], v[132:135]
  s_waitcnt vmcnt(7)
  ds_read_b64_tr_b16 v[108:109], v9 offset:5120
  v_mfma_f32_16x16x32_bf16 v[136:139], v[40:43], v[100:103], v[136:139]
  ds_read_b64_tr_b16 v[110:111], v9 offset:5376
  s_waitcnt lgkmcnt(9)
  v_mfma_f32_16x16x32_bf16 a[228:231], a[224:227], v[104:107], a[228:231]
  s_mov_b32 m0, s68
  s_nop 0
  global_load_lds_dwordx4 v4, s[40:41]
  v_add_u32 v4, 2048, v4
  ds_read_b128 v[16:19], v6 offset:43008
  v_mfma_f32_16x16x32_bf16 a[236:239], v[104:107], v[104:107], a[236:239]
  ds_read_b128 v[20:23], v6 offset:44032
  v_mfma_f32_16x16x32_bf16 v[112:115], v[44:47], v[104:107], v[112:115]
  ds_read_b128 v[24:27], v6 offset:45056
  v_mfma_f32_16x16x32_bf16 v[116:119], v[48:51], v[104:107], v[116:119]
  ds_read_b128 v[28:31], v6 offset:46080
  v_mfma_f32_16x16x32_bf16 v[120:123], v[52:55], v[104:107], v[120:123]
  ds_read_b128 v[32:35], v6 offset:47104
  v_mfma_f32_16x16x32_bf16 v[124:127], v[56:59], v[104:107], v[124:127]
  ds_read_b128 v[36:39], v6 offset:48128
  v_mfma_f32_16x16x32_bf16 v[128:131], v[60:63], v[104:107], v[128:131]
  ds_read_b128 v[40:43], v6 offset:49152
  v_mfma_f32_16x16x32_bf16 v[132:135], v[64:67], v[104:107], v[132:135]
  s_waitcnt vmcnt(4)
  ds_read_b64_tr_b16 v[100:101], v9 offset:0
  v_mfma_f32_16x16x32_bf16 v[136:139], v[68:71], v[104:107], v[136:139]
  ds_read_b64_tr_b16 v[102:103], v9 offset:256
  s_waitcnt lgkmcnt(9)
  v_mfma_f32_16x16x32_bf16 a[228:231], a[224:227], v[108:111], a[228:231]
  s_mov_b32 m0, s69
  s_nop 0
  global_load_lds_dwordx4 v4, s[40:41]
  v_add_u32 v4, 2048, v4
  ds_read_b128 v[44:47], v6 offset:50176
  v_mfma_f32_16x16x32_bf16 a[236:239], v[108:111], v[108:111], a[236:239]
  ds_read_b128 v[48:51], v6 offset:51200
  v_mfma_f32_16x16x32_bf16 v[112:115], v[72:75], v[108:111], v[112:115]
  ds_read_b128 v[52:55], v6 offset:52224
  v_mfma_f32_16x16x32_bf16 v[116:119], v[76:79], v[108:111], v[116:119]
  ds_read_b128 v[56:59], v6 offset:53248
  v_mfma_f32_16x16x32_bf16 v[120:123], v[80:83], v[108:111], v[120:123]
  ds_read_b128 v[60:63], v6 offset:54272
  v_mfma_f32_16x16x32_bf16 v[124:127], v[84:87], v[108:111], v[124:127]
  ds_read_b128 v[64:67], v6 offset:55296
  v_mfma_f32_16x16x32_bf16 v[128:131], v[88:91], v[108:111], v[128:131]
  ds_read_b128 v[68:71], v6 offset:56320
  v_mfma_f32_16x16x32_bf16 v[132:135], v[92:95], v[108:111], v[132:135]
  s_waitcnt vmcnt(4)
  ds_read_b64_tr_b16 v[104:105], v9 offset:1024
  v_mfma_f32_16x16x32_bf16 v[136:139], v[96:99], v[108:111], v[136:139]
  ds_read_b64_tr_b16 v[106:107], v9 offset:1280
  s_waitcnt lgkmcnt(9)
  v_mfma_f32_16x16x32_bf16 a[228:231], a[224:227], v[100:103], a[228:231]
  s_mov_b32 m0, s64
  s_nop 0
  global_load_lds_dwordx4 v4, s[40:41]
  v_add_u32 v4, 2048, v4
  ds_read_b128 v[72:75], v7 offset:0
  v_mfma_f32_16x16x32_bf16 a[236:239], v[100:103], v[100:103], a[236:239]
  ds_read_b128 v[76:79], v7 offset:1024
  v_mfma_f32_16x16x32_bf16 v[112:115], v[16:19], v[100:103], v[112:115]
  ds_read_b128 v[80:83], v7 offset:2048
  v_mfma_f32_16x16x32_bf16 v[116:119], v[20:23], v[100:103], v[116:119]
  ds_read_b128 v[84:87], v7 offset:3072
  v_mfma_f32_16x16x32_bf16 v[120:123], v[24:27], v[100:103], v[120:123]
  ds_read_b128 v[88:91], v7 offset:4096
  v_mfma_f32_16x16x32_bf16 v[124:127], v[28:31], v[100:103], v[124:127]
  ds_read_b128 v[92:95], v7 offset:5120
  v_mfma_f32_16x16x32_bf16 v[128:131], v[32:35], v[100:103], v[128:131]
  ds_read_b128 v[96:99], v7 offset:6144
  v_mfma_f32_16x16x32_bf16 v[132:135], v[36:39], v[100:103], v[132:135]
  s_waitcnt vmcnt(4)
  ds_read_b64_tr_b16 v[108:109], v9 offset:2048
  v_mfma_f32_16x16x32_bf16 v[136:139], v[40:43], v[100:103], v[136:139]
  ds_read_b64_tr_b16 v[110:111], v9 offset:2304
  s_waitcnt lgkmcnt(9)
  v_mfma_f32_16x16x32_bf16 a[228:231], a[224:227], v[104:107], a[228:231]
  s_mov_b32 m0, s65
  s_nop 0
  global_load_lds_dwordx4 v4, s[40:41]
  v_add_u32 v4, 2048, v4
  ds_read_b128 v[16:19], v7 offset:7168
  v_mfma_f32_16x16x32_bf16 a[236:239], v[104:107], v[104:107], a[236:239]
  ds_read_b128 v[20:23], v7 offset:8192
  v_mfma_f32_16x16x32_bf16 v[112:115], v[44:47], v[104:107], v[112:115]
  ds_read_b128 v[24:27], v7 offset:9216
  v_mfma_f32_16x16x32_bf16 v[116:119], v[48:51], v[104:107], v[116:119]
  ds_read_b128 v[28:31], v7 offset:10240
  v_mfma_f32_16x16x32_bf16 v[120:123], v[52:55], v[104:107], v[120:123]
  ds_read_b128 v[32:35], v7 offset:11264
  v_mfma_f32_16x16x32_bf16 v[124:127], v[56:59], v[104:107], v[124:127]
  ds_read_b128 v[36:39], v7 offset:12288
  v_mfma_f32_16x16x32_bf16 v[128:131], v[60:63], v[104:107], v[128:131]
  ds_read_b128 v[40:43], v7 offset:13312
  v_mfma_f32_16x16x32_bf16 v[132:135], v[64:67], v[104:107], v[132:135]
  s_waitcnt vmcnt(4)
  ds_read_b64_tr_b16 v[100:101], v9 offset:3072
  v_mfma_f32_16x16x32_bf16 v[136:139], v[68:71], v[104:107], v[136:139]
  ds_read_b64_tr_b16 v[102:103], v9 offset:3328
  s_waitcnt lgkmcnt(9)
  v_mfma_f32_16x16x32_bf16 a[228:231], a[224:227], v[108:111], a[228:231]
  s_mov_b32 m0, s66
  s_nop 0
  global_load_lds_dwordx4 v4, s[40:41]
  v_add_u32 v4, 2048, v4
  ds_read_b128 v[44:47], v7 offset:14336
  v_mfma_f32_16x16x32_bf16 a[236:239], v[108:111], v[108:111], a[236:239]
  ds_read_b128 v[48:51], v7 offset:15360
  v_mfma_f32_16x16x32_bf16 v[112:115], v[72:75], v[108:111], v[112:115]
  ds_read_b128 v[52:55], v7 offset:16384
  v_mfma_f32_16x16x32_bf16 v[116:119], v[76:79], v[108:111], v[116:119]
  ds_read_b128 v[56:59], v7 offset:17408
  v_mfma_f32_16x16x32_bf16 v[120:123], v[80:83], v[108:111], v[120:123]
  ds_read_b128 v[60:63], v7 offset:18432
  v_mfma_f32_16x16x32_bf16 v[124:127], v[84:87], v[108:111], v[124:127]
  ds_read_b128 v[64:67], v7 offset:19456
  v_mfma_f32_16x16x32_bf16 v[128:131], v[88:91], v[108:111], v[128:131]
  ds_read_b128 v[68:71], v7 offset:20480
  v_mfma_f32_16x16x32_bf16 v[132:135], v[92:95], v[108:111], v[132:135]
  s_waitcnt vmcnt(4)
  ds_read_b64_tr_b16 v[104:105], v9 offset:4096
  v_mfma_f32_16x16x32_bf16 v[136:139], v[96:99], v[108:111], v[136:139]
  ds_read_b64_tr_b16 v[106:107], v9 offset:4352
  s_waitcnt lgkmcnt(9)
  v_mfma_f32_16x16x32_bf16 a[228:231], a[224:227], v[100:103], a[228:231]
  s_mov_b32 m0, s67
  s_nop 0
  global_load_lds_dwordx4 v4, s[40:41]
  v_add_u32 v4, 1017856, v4
  ds_read_b128 v[72:75], v7 offset:21504
  v_mfma_f32_16x16x32_bf16 a[236:239], v[100:103], v[100:103], a[236:239]
  ds_read_b128 v[76:79], v7 offset:22528
  v_mfma_f32_16x16x32_bf16 v[112:115], v[16:19], v[100:103], v[112:115]
  ds_read_b128 v[80:83], v7 offset:23552
  v_mfma_f32_16x16x32_bf16 v[116:119], v[20:23], v[100:103], v[116:119]
  ds_read_b128 v[84:87], v7 offset:24576
  v_mfma_f32_16x16x32_bf16 v[120:123], v[24:27], v[100:103], v[120:123]
  ds_read_b128 v[88:91], v7 offset:25600
  v_mfma_f32_16x16x32_bf16 v[124:127], v[28:31], v[100:103], v[124:127]
  ds_read_b128 v[92:95], v7 offset:26624
  v_mfma_f32_16x16x32_bf16 v[128:131], v[32:35], v[100:103], v[128:131]
  ds_read_b128 v[96:99], v7 offset:27648
  v_mfma_f32_16x16x32_bf16 v[132:135], v[36:39], v[100:103], v[132:135]
  s_waitcnt vmcnt(4)
  ds_read_b64_tr_b16 v[108:109], v9 offset:5120
  v_mfma_f32_16x16x32_bf16 v[136:139], v[40:43], v[100:103], v[136:139]
  ds_read_b64_tr_b16 v[110:111], v9 offset:5376
  s_waitcnt lgkmcnt(9)
  v_mfma_f32_16x16x32_bf16 a[228:231], a[224:227], v[104:107], a[228:231]
  ds_read_b128 v[16:19], v7 offset:28672
  ds_read_b128 v[20:23], v7 offset:29696
  v_mfma_f32_16x16x32_bf16 a[236:239], v[104:107], v[104:107], a[236:239]
  ds_read_b128 v[24:27], v7 offset:30720
  v_mfma_f32_16x16x32_bf16 v[112:115], v[44:47], v[104:107], v[112:115]
  ds_read_b128 v[28:31], v7 offset:31744
  v_mfma_f32_16x16x32_bf16 v[116:119], v[48:51], v[104:107], v[116:119]
  ds_read_b128 v[32:35], v7 offset:32768
  v_mfma_f32_16x16x32_bf16 v[120:123], v[52:55], v[104:107], v[120:123]
  ds_read_b128 v[36:39], v7 offset:33792
  v_mfma_f32_16x16x32_bf16 v[124:127], v[56:59], v[104:107], v[124:127]
  ds_read_b128 v[40:43], v7 offset:34816
  v_mfma_f32_16x16x32_bf16 v[128:131], v[60:63], v[104:107], v[128:131]
  s_waitcnt vmcnt(3)
  ds_read_b64_tr_b16 v[100:101], v9 offset:0
  v_mfma_f32_16x16x32_bf16 v[132:135], v[64:67], v[104:107], v[132:135]
  ds_read_b64_tr_b16 v[102:103], v9 offset:256
  v_mfma_f32_16x16x32_bf16 v[136:139], v[68:71], v[104:107], v[136:139]
  s_waitcnt lgkmcnt(9)
  v_mfma_f32_16x16x32_bf16 a[228:231], a[224:227], v[108:111], a[228:231]
  ds_read_b128 v[44:47], v7 offset:35840
  ds_read_b128 v[48:51], v7 offset:36864
  v_mfma_f32_16x16x32_bf16 a[236:239], v[108:111], v[108:111], a[236:239]
  ds_read_b128 v[52:55], v7 offset:37888
  v_mfma_f32_16x16x32_bf16 v[112:115], v[72:75], v[108:111], v[112:115]
  ds_read_b128 v[56:59], v7 offset:38912
  v_mfma_f32_16x16x32_bf16 v[116:119], v[76:79], v[108:111], v[116:119]
  ds_read_b128 v[60:63], v7 offset:39936
  v_mfma_f32_16x16x32_bf16 v[120:123], v[80:83], v[108:111], v[120:123]
  ds_read_b128 v[64:67], v7 offset:40960
  v_mfma_f32_16x16x32_bf16 v[124:127], v[84:87], v[108:111], v[124:127]
  ds_read_b128 v[68:71], v7 offset:41984
  v_mfma_f32_16x16x32_bf16 v[128:131], v[88:91], v[108:111], v[128:131]
  s_waitcnt vmcnt(2)
  ds_read_b64_tr_b16 v[104:105], v9 offset:1024
  v_mfma_f32_16x16x32_bf16 v[132:135], v[92:95], v[108:111], v[132:135]
  ds_read_b64_tr_b16 v[106:107], v9 offset:1280
  v_mfma_f32_16x16x32_bf16 v[136:139], v[96:99], v[108:111], v[136:139]
  s_waitcnt lgkmcnt(9)
  v_mfma_f32_16x16x32_bf16 a[228:231], a[224:227], v[100:103], a[228:231]
  ds_read_b128 v[72:75], v7 offset:43008
  ds_read_b128 v[76:79], v7 offset:44032
  v_mfma_f32_16x16x32_bf16 a[236:239], v[100:103], v[100:103], a[236:239]
  ds_read_b128 v[80:83], v7 offset:45056
  v_mfma_f32_16x16x32_bf16 v[112:115], v[16:19], v[100:103], v[112:115]
  ds_read_b128 v[84:87], v7 offset:46080
  v_mfma_f32_16x16x32_bf16 v[116:119], v[20:23], v[100:103], v[116:119]
  ds_read_b128 v[88:91], v7 offset:47104
  v_mfma_f32_16x16x32_bf16 v[120:123], v[24:27], v[100:103], v[120:123]
  ds_read_b128 v[92:95], v7 offset:48128
  v_mfma_f32_16x16x32_bf16 v[124:127], v[28:31], v[100:103], v[124:127]
  ds_read_b128 v[96:99], v7 offset:49152
  v_mfma_f32_16x16x32_bf16 v[128:131], v[32:35], v[100:103], v[128:131]
  s_waitcnt vmcnt(1)
  ds_read_b64_tr_b16 v[108:109], v9 offset:2048
  v_mfma_f32_16x16x32_bf16 v[132:135], v[36:39], v[100:103], v[132:135]
  ds_read_b64_tr_b16 v[110:111], v9 offset:2304
  v_mfma_f32_16x16x32_bf16 v[136:139], v[40:43], v[100:103], v[136:139]
  s_waitcnt lgkmcnt(9)
  s_cmp_lg_u32 s34, 0
  s_cbranch_scc1 w0_52
  v_lshlrev_b32 v251, 8, v1
  v_add_u32 v251, 31494144, v251
  s_mov_b64 exec, 0xffff
  global_load_dword v11, v251, s[32:33] sc1
  s_mov_b64 exec, -1
  s_nop 3

w0_52:
  v_mfma_f32_16x16x32_bf16 a[228:231], a[224:227], v[104:107], a[228:231]
  ds_read_b128 v[16:19], v7 offset:50176
  ds_read_b128 v[20:23], v7 offset:51200
  v_mfma_f32_16x16x32_bf16 a[236:239], v[104:107], v[104:107], a[236:239]
  ds_read_b128 v[24:27], v7 offset:52224
  v_mfma_f32_16x16x32_bf16 v[112:115], v[44:47], v[104:107], v[112:115]
  ds_read_b128 v[28:31], v7 offset:53248
  v_mfma_f32_16x16x32_bf16 v[116:119], v[48:51], v[104:107], v[116:119]
  ds_read_b128 v[32:35], v7 offset:54272
  v_mfma_f32_16x16x32_bf16 v[120:123], v[52:55], v[104:107], v[120:123]
  ds_read_b128 v[36:39], v7 offset:55296
  v_mfma_f32_16x16x32_bf16 v[124:127], v[56:59], v[104:107], v[124:127]
  ds_read_b128 v[40:43], v7 offset:56320
  v_mfma_f32_16x16x32_bf16 v[128:131], v[60:63], v[104:107], v[128:131]
  s_waitcnt vmcnt(0)
  ds_read_b64_tr_b16 v[100:101], v9 offset:3072
  v_mfma_f32_16x16x32_bf16 v[132:135], v[64:67], v[104:107], v[132:135]
  ds_read_b64_tr_b16 v[102:103], v9 offset:3328
  v_mfma_f32_16x16x32_bf16 v[136:139], v[68:71], v[104:107], v[136:139]
  s_waitcnt lgkmcnt(9)
  v_mfma_f32_16x16x32_bf16 a[228:231], a[224:227], v[108:111], a[228:231]
  ds_read_b128 v[160:163], v13 offset:0
  ds_read_b128 v[164:167], v13 offset:448
  v_mfma_f32_16x16x32_bf16 a[236:239], v[108:111], v[108:111], a[236:239]
  ds_read_b128 v[168:171], v13 offset:64
  v_mfma_f32_16x16x32_bf16 v[112:115], v[72:75], v[108:111], v[112:115]
  ds_read_b128 v[172:175], v13 offset:512
  v_mfma_f32_16x16x32_bf16 v[116:119], v[76:79], v[108:111], v[116:119]
  v_mfma_f32_16x16x32_bf16 v[120:123], v[80:83], v[108:111], v[120:123]
  v_mfma_f32_16x16x32_bf16 v[124:127], v[84:87], v[108:111], v[124:127]
  v_mfma_f32_16x16x32_bf16 v[128:131], v[88:91], v[108:111], v[128:131]
  v_mfma_f32_16x16x32_bf16 v[132:135], v[92:95], v[108:111], v[132:135]
  v_mfma_f32_16x16x32_bf16 v[136:139], v[96:99], v[108:111], v[136:139]
  s_waitcnt lgkmcnt(4)
  v_mfma_f32_16x16x32_bf16 a[228:231], a[224:227], v[100:103], a[228:231]
  v_mfma_f32_16x16x32_bf16 a[236:239], v[100:103], v[100:103], a[236:239]
  v_mfma_f32_16x16x32_bf16 v[112:115], v[16:19], v[100:103], v[112:115]
  v_mfma_f32_16x16x32_bf16 v[116:119], v[20:23], v[100:103], v[116:119]
  v_mfma_f32_16x16x32_bf16 v[120:123], v[24:27], v[100:103], v[120:123]
  v_mfma_f32_16x16x32_bf16 v[124:127], v[28:31], v[100:103], v[124:127]
  v_mfma_f32_16x16x32_bf16 v[128:131], v[32:35], v[100:103], v[128:131]
  v_mfma_f32_16x16x32_bf16 v[132:135], v[36:39], v[100:103], v[132:135]
  v_mfma_f32_16x16x32_bf16 v[136:139], v[40:43], v[100:103], v[136:139]
  s_cmp_lg_u32 s34, 0
  s_cbranch_scc1 w0_55
  s_mov_b64 exec, 0xffff
  s_waitcnt vmcnt(0)
  s_mov_b32 s93, 200000
  v_cmp_ne_u32 vcc, 16, v11
  s_cbranch_vccz gd_54
  gp_53:
  s_sleep 12
  global_load_dword v11, v251, s[32:33] sc1
  s_waitcnt vmcnt(0)
  v_cmp_ne_u32 vcc, 16, v11
  s_cbranch_vccz gd_54
  s_sub_u32 s93, s93, 1
  s_cbranch_scc0 gp_53
  gd_54:
  s_mov_b64 exec, -1

w0_55:
  s_barrier
  v_accvgpr_read_b32 v8, a228
  v_accvgpr_read_b32 v140, a236
  v_accvgpr_read_b32 v141, a237
  v_accvgpr_read_b32 v142, a238
  v_accvgpr_read_b32 v143, a239
  v_and_b32 v144, 3, v2
  v_cmp_eq_u32 vcc, 1, v144
  v_cndmask_b32 v10, v140, v141, vcc
  v_cmp_eq_u32 vcc, 2, v144
  v_cndmask_b32 v10, v10, v142, vcc
  v_cmp_eq_u32 vcc, 3, v144
  v_cndmask_b32 v10, v10, v143, vcc
  v_lshrrev_b32 v144, 2, v2
  v_cmp_eq_u32 vcc, v144, v3
  v_cndmask_b32 v10, 0, v10, vcc

  v_mov_b32 v140, v10
  s_nop 1
  v_permlane16_swap_b32 v10, v140
  s_nop 1
  s_mov_b32 m0, s68
  s_nop 0
  global_load_lds_dwordx4 v4, s[40:41]
  v_add_u32 v4, 2048, v4
  v_add_f32 v10, v10, v140
  v_mov_b32 v140, v10
  s_nop 1
  v_permlane32_swap_b32 v10, v140
  s_nop 1
  v_add_f32 v10, v10, v140
  v_mul_f32 v8, s56, v8
  v_mul_f32 v10, s56, v10
  v_fma_f32 v10, -v8, v8, v10
  v_max_f32 v10, 0, v10
  v_cvt_pk_bf16_f32 v140, v10, v10
  v_and_b32 v140, s58, v140
  v_add_f32 v140, s57, v140
  v_cvt_pk_bf16_f32 v140, v140, v140
  v_and_b32 v140, s58, v140
  v_sqrt_f32 v140, v140
  s_nop 0
  v_cvt_pk_bf16_f32 v140, v140, v140
  v_and_b32 v140, s58, v140
  v_rcp_f32 v140, v140
  s_mov_b32 m0, s69
  s_nop 0
  global_load_lds_dwordx4 v4, s[40:41]
  v_add_u32 v4, 2048, v4
  s_nop 0
  v_mul_f32 v10, v10, v140
  v_mul_f32 v10, v10, v140
  v_cvt_pk_bf16_f32 v10, v10, v10
  v_and_b32 v10, s58, v10
  v_add_f32 v10, s57, v10
  v_cvt_pk_bf16_f32 v10, v10, v10
  v_and_b32 v10, s58, v10
  v_sqrt_f32 v10, v10
  s_nop 0
  v_cvt_pk_bf16_f32 v10, v10, v10
  v_and_b32 v10, s58, v10
  v_rcp_f32 v10, v10
  s_nop 0
  v_mul_f32 v10, v10, v140
  v_mul_f32 v8, v8, v10

  s_waitcnt lgkmcnt(0)
  v_pk_fma_f32 v[140:141], v[8:9], v[164:165], v[160:161] op_sel:[0,0,0] op_sel_hi:[0,1,1] neg_lo:[1,0,0] neg_hi:[1,0,0]
  v_pk_fma_f32 v[142:143], v[8:9], v[166:167], v[162:163] op_sel:[0,0,0] op_sel_hi:[0,1,1] neg_lo:[1,0,0] neg_hi:[1,0,0]
  s_mov_b32 m0, s64
  s_nop 0
  global_load_lds_dwordx4 v4, s[40:41]
  v_add_u32 v4, 2048, v4
  v_pk_fma_f32 v[144:145], v[8:9], v[172:173], v[168:169] op_sel:[0,0,0] op_sel_hi:[0,1,1] neg_lo:[1,0,0] neg_hi:[1,0,0]
  v_pk_fma_f32 v[146:147], v[8:9], v[174:175], v[170:171] op_sel:[0,0,0] op_sel_hi:[0,1,1] neg_lo:[1,0,0] neg_hi:[1,0,0]
  ds_read_b128 v[160:163], v13 offset:128
  ds_read_b128 v[164:167], v13 offset:576
  ds_read_b128 v[168:171], v13 offset:192
  ds_read_b128 v[172:175], v13 offset:640
  v_pk_fma_f32 v[112:113], v[10:11], v[112:113], v[140:141] op_sel:[0,0,0] op_sel_hi:[0,1,1]
  v_pk_fma_f32 v[114:115], v[10:11], v[114:115], v[142:143] op_sel:[0,0,0] op_sel_hi:[0,1,1]
  v_pk_fma_f32 v[116:117], v[10:11], v[116:117], v[144:145] op_sel:[0,0,0] op_sel_hi:[0,1,1]
  v_pk_fma_f32 v[118:119], v[10:11], v[118:119], v[146:147] op_sel:[0,0,0] op_sel_hi:[0,1,1]
  v_pk_mul_f32 v[140:141], v[112:113], v[112:113]
  v_pk_mul_f32 v[142:143], v[114:115], v[114:115]
  v_pk_mul_f32 v[144:145], v[116:117], v[116:117]
  v_pk_mul_f32 v[146:147], v[118:119], v[118:119]
  v_pk_fma_f32 v[140:141], v[140:141], v[14:15], s[70:71]
  v_pk_fma_f32 v[142:143], v[142:143], v[14:15], s[70:71]
  v_pk_fma_f32 v[144:145], v[144:145], v[14:15], s[70:71]
  v_pk_fma_f32 v[146:147], v[146:147], v[14:15], s[70:71]
  v_pk_mul_f32 v[140:141], v[140:141], v[112:113]
  v_pk_mul_f32 v[142:143], v[142:143], v[114:115]
  s_mov_b32 m0, s65
  s_nop 0
  global_load_lds_dwordx4 v4, s[40:41]
  v_add_u32 v4, 2048, v4
  v_pk_mul_f32 v[144:145], v[144:145], v[116:117]
  v_pk_mul_f32 v[146:147], v[146:147], v[118:119]
  v_exp_f32 v140, v140
  v_exp_f32 v141, v141
  v_exp_f32 v142, v142
  v_exp_f32 v143, v143
  v_exp_f32 v144, v144
  v_exp_f32 v145, v145
  v_exp_f32 v146, v146
  v_exp_f32 v147, v147
  s_nop 0
  v_pk_add_f32 v[140:141], v[140:141], 1.0 op_sel_hi:[1,0]
  v_pk_add_f32 v[142:143], v[142:143], 1.0 op_sel_hi:[1,0]
  v_pk_add_f32 v[144:145], v[144:145], 1.0 op_sel_hi:[1,0]
  v_pk_add_f32 v[146:147], v[146:147], 1.0 op_sel_hi:[1,0]
  v_rcp_f32 v140, v140
  v_rcp_f32 v141, v141
  v_rcp_f32 v142, v142
  v_rcp_f32 v143, v143
  v_rcp_f32 v144, v144
  s_mov_b32 m0, s66
  s_nop 0
  global_load_lds_dwordx4 v4, s[40:41]
  v_add_u32 v4, 2048, v4
  v_rcp_f32 v145, v145
  v_rcp_f32 v146, v146
  v_rcp_f32 v147, v147
  s_nop 0
  v_pk_mul_f32 v[112:113], v[112:113], v[140:141]
  v_pk_mul_f32 v[114:115], v[114:115], v[142:143]
  v_pk_mul_f32 v[116:117], v[116:117], v[144:145]
  v_pk_mul_f32 v[118:119], v[118:119], v[146:147]
  v_cvt_pk_bf16_f32 v148, v112, v113
  v_cvt_pk_bf16_f32 v149, v114, v115
  v_cvt_pk_bf16_f32 v150, v116, v117
  v_cvt_pk_bf16_f32 v151, v118, v119
  s_nop 1
  v_permlane16_swap_b32 v148, v150
  v_permlane16_swap_b32 v149, v151
  s_nop 1
  global_store_dwordx4 v5, v[148:151], s[42:43] sc1
  v_add_u32 v5, 0x20000, v5

  s_waitcnt lgkmcnt(0)
  s_mov_b32 m0, s67
  s_nop 0
  global_load_lds_dwordx4 v4, s[40:41]
  v_add_u32 v4, 2048, v4
  v_pk_fma_f32 v[140:141], v[8:9], v[164:165], v[160:161] op_sel:[0,0,0] op_sel_hi:[0,1,1] neg_lo:[1,0,0] neg_hi:[1,0,0]
  v_pk_fma_f32 v[142:143], v[8:9], v[166:167], v[162:163] op_sel:[0,0,0] op_sel_hi:[0,1,1] neg_lo:[1,0,0] neg_hi:[1,0,0]
  v_pk_fma_f32 v[144:145], v[8:9], v[172:173], v[168:169] op_sel:[0,0,0] op_sel_hi:[0,1,1] neg_lo:[1,0,0] neg_hi:[1,0,0]
  v_pk_fma_f32 v[146:147], v[8:9], v[174:175], v[170:171] op_sel:[0,0,0] op_sel_hi:[0,1,1] neg_lo:[1,0,0] neg_hi:[1,0,0]
  ds_read_b128 v[160:163], v13 offset:256
  ds_read_b128 v[164:167], v13 offset:704
  ds_read_b128 v[168:171], v13 offset:320
  ds_read_b128 v[172:175], v13 offset:768
  v_pk_fma_f32 v[120:121], v[10:11], v[120:121], v[140:141] op_sel:[0,0,0] op_sel_hi:[0,1,1]
  v_pk_fma_f32 v[122:123], v[10:11], v[122:123], v[142:143] op_sel:[0,0,0] op_sel_hi:[0,1,1]
  v_pk_fma_f32 v[124:125], v[10:11], v[124:125], v[144:145] op_sel:[0,0,0] op_sel_hi:[0,1,1]
  v_pk_fma_f32 v[126:127], v[10:11], v[126:127], v[146:147] op_sel:[0,0,0] op_sel_hi:[0,1,1]
  v_pk_mul_f32 v[140:141], v[120:121], v[120:121]
  v_pk_mul_f32 v[142:143], v[122:123], v[122:123]
  v_pk_mul_f32 v[144:145], v[124:125], v[124:125]
  v_pk_mul_f32 v[146:147], v[126:127], v[126:127]
  v_pk_fma_f32 v[140:141], v[140:141], v[14:15], s[70:71]
  v_pk_fma_f32 v[142:143], v[142:143], v[14:15], s[70:71]
  v_pk_fma_f32 v[144:145], v[144:145], v[14:15], s[70:71]
  v_pk_fma_f32 v[146:147], v[146:147], v[14:15], s[70:71]
  v_pk_mul_f32 v[140:141], v[140:141], v[120:121]
  v_pk_mul_f32 v[142:143], v[142:143], v[122:123]
  v_pk_mul_f32 v[144:145], v[144:145], v[124:125]
  v_pk_mul_f32 v[146:147], v[146:147], v[126:127]
  v_exp_f32 v140, v140
  v_exp_f32 v141, v141
  v_exp_f32 v142, v142
  v_exp_f32 v143, v143
  v_exp_f32 v144, v144
  v_exp_f32 v145, v145
  v_exp_f32 v146, v146
  v_exp_f32 v147, v147
  s_nop 0
  v_pk_add_f32 v[140:141], v[140:141], 1.0 op_sel_hi:[1,0]
  v_pk_add_f32 v[142:143], v[142:143], 1.0 op_sel_hi:[1,0]
  v_pk_add_f32 v[144:145], v[144:145], 1.0 op_sel_hi:[1,0]
  v_pk_add_f32 v[146:147], v[146:147], 1.0 op_sel_hi:[1,0]
  v_rcp_f32 v140, v140
  v_rcp_f32 v141, v141
  v_rcp_f32 v142, v142
  v_rcp_f32 v143, v143
  v_rcp_f32 v144, v144
  v_rcp_f32 v145, v145
  v_rcp_f32 v146, v146
  v_rcp_f32 v147, v147
  s_nop 0
  v_pk_mul_f32 v[120:121], v[120:121], v[140:141]
  v_pk_mul_f32 v[122:123], v[122:123], v[142:143]
  v_pk_mul_f32 v[124:125], v[124:125], v[144:145]
  v_pk_mul_f32 v[126:127], v[126:127], v[146:147]
  v_cvt_pk_bf16_f32 v152, v120, v121
  v_cvt_pk_bf16_f32 v153, v122, v123
  v_cvt_pk_bf16_f32 v154, v124, v125
  v_cvt_pk_bf16_f32 v155, v126, v127
  s_nop 1
  v_permlane16_swap_b32 v152, v154
  v_permlane16_swap_b32 v153, v155
  s_nop 1
  global_store_dwordx4 v5, v[152:155], s[42:43] sc1
  v_add_u32 v5, 0x20000, v5

  s_waitcnt lgkmcnt(0)
  v_pk_fma_f32 v[140:141], v[8:9], v[164:165], v[160:161] op_sel:[0,0,0] op_sel_hi:[0,1,1] neg_lo:[1,0,0] neg_hi:[1,0,0]
  v_pk_fma_f32 v[142:143], v[8:9], v[166:167], v[162:163] op_sel:[0,0,0] op_sel_hi:[0,1,1] neg_lo:[1,0,0] neg_hi:[1,0,0]
  v_pk_fma_f32 v[144:145], v[8:9], v[172:173], v[168:169] op_sel:[0,0,0] op_sel_hi:[0,1,1] neg_lo:[1,0,0] neg_hi:[1,0,0]
  v_pk_fma_f32 v[146:147], v[8:9], v[174:175], v[170:171] op_sel:[0,0,0] op_sel_hi:[0,1,1] neg_lo:[1,0,0] neg_hi:[1,0,0]
  ds_read_b128 v[160:163], v13 offset:384
  ds_read_b128 v[164:167], v13 offset:832
  v_pk_fma_f32 v[128:129], v[10:11], v[128:129], v[140:141] op_sel:[0,0,0] op_sel_hi:[0,1,1]
  v_pk_fma_f32 v[130:131], v[10:11], v[130:131], v[142:143] op_sel:[0,0,0] op_sel_hi:[0,1,1]
  v_pk_fma_f32 v[132:133], v[10:11], v[132:133], v[144:145] op_sel:[0,0,0] op_sel_hi:[0,1,1]
  v_pk_fma_f32 v[134:135], v[10:11], v[134:135], v[146:147] op_sel:[0,0,0] op_sel_hi:[0,1,1]
  v_pk_mul_f32 v[140:141], v[128:129], v[128:129]
  v_pk_mul_f32 v[142:143], v[130:131], v[130:131]
  v_pk_mul_f32 v[144:145], v[132:133], v[132:133]
  v_pk_mul_f32 v[146:147], v[134:135], v[134:135]
  v_pk_fma_f32 v[140:141], v[140:141], v[14:15], s[70:71]
  v_pk_fma_f32 v[142:143], v[142:143], v[14:15], s[70:71]
  v_pk_fma_f32 v[144:145], v[144:145], v[14:15], s[70:71]
  v_pk_fma_f32 v[146:147], v[146:147], v[14:15], s[70:71]
  v_pk_mul_f32 v[140:141], v[140:141], v[128:129]
  v_pk_mul_f32 v[142:143], v[142:143], v[130:131]
  v_pk_mul_f32 v[144:145], v[144:145], v[132:133]
  v_pk_mul_f32 v[146:147], v[146:147], v[134:135]
  v_exp_f32 v140, v140
  v_exp_f32 v141, v141
  v_exp_f32 v142, v142
  v_exp_f32 v143, v143
  v_exp_f32 v144, v144
  v_exp_f32 v145, v145
  v_exp_f32 v146, v146
  v_exp_f32 v147, v147
  s_nop 0
  v_pk_add_f32 v[140:141], v[140:141], 1.0 op_sel_hi:[1,0]
  v_pk_add_f32 v[142:143], v[142:143], 1.0 op_sel_hi:[1,0]
  v_pk_add_f32 v[144:145], v[144:145], 1.0 op_sel_hi:[1,0]
  v_pk_add_f32 v[146:147], v[146:147], 1.0 op_sel_hi:[1,0]
  v_rcp_f32 v140, v140
  v_rcp_f32 v141, v141
  v_rcp_f32 v142, v142
  v_rcp_f32 v143, v143
  v_rcp_f32 v144, v144
  v_rcp_f32 v145, v145
  v_rcp_f32 v146, v146
  v_rcp_f32 v147, v147
  s_nop 0
  v_pk_mul_f32 v[128:129], v[128:129], v[140:141]
  v_pk_mul_f32 v[130:131], v[130:131], v[142:143]
  v_pk_mul_f32 v[132:133], v[132:133], v[144:145]
  v_pk_mul_f32 v[134:135], v[134:135], v[146:147]
  v_cvt_pk_bf16_f32 v148, v128, v129
  v_cvt_pk_bf16_f32 v149, v130, v131
  v_cvt_pk_bf16_f32 v150, v132, v133
  v_cvt_pk_bf16_f32 v151, v134, v135
  s_nop 1
  v_permlane16_swap_b32 v148, v150
  v_permlane16_swap_b32 v149, v151
  s_nop 1
  global_store_dwordx4 v5, v[148:151], s[42:43] sc1
  v_add_u32 v5, 0xfffc4000, v5

  s_waitcnt lgkmcnt(0)
  v_pk_fma_f32 v[140:141], v[8:9], v[164:165], v[160:161] op_sel:[0,0,0] op_sel_hi:[0,1,1] neg_lo:[1,0,0] neg_hi:[1,0,0]
  v_pk_fma_f32 v[142:143], v[8:9], v[166:167], v[162:163] op_sel:[0,0,0] op_sel_hi:[0,1,1] neg_lo:[1,0,0] neg_hi:[1,0,0]
  v_pk_fma_f32 v[136:137], v[10:11], v[136:137], v[140:141] op_sel:[0,0,0] op_sel_hi:[0,1,1]
  v_pk_fma_f32 v[138:139], v[10:11], v[138:139], v[142:143] op_sel:[0,0,0] op_sel_hi:[0,1,1]
  v_pk_mul_f32 v[140:141], v[136:137], v[136:137]
  v_pk_mul_f32 v[142:143], v[138:139], v[138:139]
  v_pk_fma_f32 v[140:141], v[140:141], v[14:15], s[70:71]
  v_pk_fma_f32 v[142:143], v[142:143], v[14:15], s[70:71]
  v_pk_mul_f32 v[140:141], v[140:141], v[136:137]
  v_pk_mul_f32 v[142:143], v[142:143], v[138:139]
  v_exp_f32 v140, v140
  v_exp_f32 v141, v141
  v_exp_f32 v142, v142
  v_exp_f32 v143, v143
  s_nop 0
  v_pk_add_f32 v[140:141], v[140:141], 1.0 op_sel_hi:[1,0]
  v_pk_add_f32 v[142:143], v[142:143], 1.0 op_sel_hi:[1,0]
  v_rcp_f32 v140, v140
  v_rcp_f32 v141, v141
  v_rcp_f32 v142, v142
  v_rcp_f32 v143, v143
  s_nop 0
  v_pk_mul_f32 v[136:137], v[136:137], v[140:141]
  v_pk_mul_f32 v[138:139], v[138:139], v[142:143]
  v_cvt_pk_bf16_f32 v152, v136, v137
  v_cvt_pk_bf16_f32 v153, v138, v139
  global_store_dwordx2 v12, v[152:153], s[42:43] sc1
  v_add_u32 v12, 16384, v12
  ds_read_b128 v[16:19], v6 offset:0
  ds_read_b128 v[20:23], v6 offset:1024
  ds_read_b128 v[24:27], v6 offset:2048
  ds_read_b128 v[28:31], v6 offset:3072
  ds_read_b128 v[32:35], v6 offset:4096
  ds_read_b128 v[36:39], v6 offset:5120
  ds_read_b128 v[40:43], v6 offset:6144
  s_waitcnt vmcnt(9)
  ds_read_b64_tr_b16 v[100:101], v9 offset:4096
  ds_read_b64_tr_b16 v[102:103], v9 offset:4352
  ds_read_b128 v[44:47], v6 offset:7168
  ds_read_b128 v[48:51], v6 offset:8192
  ds_read_b128 v[52:55], v6 offset:9216
  ds_read_b128 v[56:59], v6 offset:10240
  ds_read_b128 v[60:63], v6 offset:11264
  ds_read_b128 v[64:67], v6 offset:12288
  ds_read_b128 v[68:71], v6 offset:13312
  s_waitcnt vmcnt(8)
  ds_read_b64_tr_b16 v[104:105], v9 offset:5120
  ds_read_b64_tr_b16 v[106:107], v9 offset:5376
  s_waitcnt lgkmcnt(9)
  v_mfma_f32_16x16x32_bf16 a[228:231], a[224:227], v[100:103], 0
  s_mov_b32 m0, s68
  s_nop 0
  global_load_lds_dwordx4 v4, s[40:41]
  v_add_u32 v4, 2048, v4
  ds_read_b128 v[72:75], v6 offset:14336
  v_mfma_f32_16x16x32_bf16 a[236:239], v[100:103], v[100:103], 0
  ds_read_b128 v[76:79], v6 offset:15360
  v_mfma_f32_16x16x32_bf16 v[112:115], v[16:19], v[100:103], 0
  ds_read_b128 v[80:83], v6 offset:16384
  v_mfma_f32_16x16x32_bf16 v[116:119], v[20:23], v[100:103], 0
  ds_read_b128 v[84:87], v6 offset:17408
  v_mfma_f32_16x16x32_bf16 v[120:123], v[24:27], v[100:103], 0
  ds_read_b128 v[88:91], v6 offset:18432
  v_mfma_f32_16x16x32_bf16 v[124:127], v[28:31], v[100:103], 0
  ds_read_b128 v[92:95], v6 offset:19456
  v_mfma_f32_16x16x32_bf16 v[128:131], v[32:35], v[100:103], 0
  ds_read_b128 v[96:99], v6 offset:20480
  v_mfma_f32_16x16x32_bf16 v[132:135], v[36:39], v[100:103], 0
  s_waitcnt vmcnt(8)
  ds_read_b64_tr_b16 v[108:109], v9 offset:0
  v_mfma_f32_16x16x32_bf16 v[136:139], v[40:43], v[100:103], 0
  ds_read_b64_tr_b16 v[110:111], v9 offset:256
  s_waitcnt lgkmcnt(9)
  v_mfma_f32_16x16x32_bf16 a[228:231], a[224:227], v[104:107], a[228:231]
  s_mov_b32 m0, s69
  s_nop 0
  global_load_lds_dwordx4 v4, s[40:41]
  v_add_u32 v4, 2048, v4
  ds_read_b128 v[16:19], v6 offset:21504
  v_mfma_f32_16x16x32_bf16 a[236:239], v[104:107], v[104:107], a[236:239]
  ds_read_b128 v[20:23], v6 offset:22528
  v_mfma_f32_16x16x32_bf16 v[112:115], v[44:47], v[104:107], v[112:115]
  ds_read_b128 v[24:27], v6 offset:23552
  v_mfma_f32_16x16x32_bf16 v[116:119], v[48:51], v[104:107], v[116:119]
  ds_read_b128 v[28:31], v6 offset:24576
  v_mfma_f32_16x16x32_bf16 v[120:123], v[52:55], v[104:107], v[120:123]
  ds_read_b128 v[32:35], v6 offset:25600
  v_mfma_f32_16x16x32_bf16 v[124:127], v[56:59], v[104:107], v[124:127]
  ds_read_b128 v[36:39], v6 offset:26624
  v_mfma_f32_16x16x32_bf16 v[128:131], v[60:63], v[104:107], v[128:131]
  ds_read_b128 v[40:43], v6 offset:27648
  v_mfma_f32_16x16x32_bf16 v[132:135], v[64:67], v[104:107], v[132:135]
  s_waitcnt vmcnt(8)
  ds_read_b64_tr_b16 v[100:101], v9 offset:1024
  v_mfma_f32_16x16x32_bf16 v[136:139], v[68:71], v[104:107], v[136:139]
  ds_read_b64_tr_b16 v[102:103], v9 offset:1280
  s_waitcnt lgkmcnt(9)
  v_mfma_f32_16x16x32_bf16 a[228:231], a[224:227], v[108:111], a[228:231]
  s_mov_b32 m0, s64
  s_nop 0
  global_load_lds_dwordx4 v4, s[40:41]
  v_add_u32 v4, 2048, v4
  ds_read_b128 v[44:47], v6 offset:28672
  v_mfma_f32_16x16x32_bf16 a[236:239], v[108:111], v[108:111], a[236:239]
  ds_read_b128 v[48:51], v6 offset:29696
  v_mfma_f32_16x16x32_bf16 v[112:115], v[72:75], v[108:111], v[112:115]
  ds_read_b128 v[52:55], v6 offset:30720
  v_mfma_f32_16x16x32_bf16 v[116:119], v[76:79], v[108:111], v[116:119]
  ds_read_b128 v[56:59], v6 offset:31744
  v_mfma_f32_16x16x32_bf16 v[120:123], v[80:83], v[108:111], v[120:123]
  ds_read_b128 v[60:63], v6 offset:32768
  v_mfma_f32_16x16x32_bf16 v[124:127], v[84:87], v[108:111], v[124:127]
  ds_read_b128 v[64:67], v6 offset:33792
  v_mfma_f32_16x16x32_bf16 v[128:131], v[88:91], v[108:111], v[128:131]
  ds_read_b128 v[68:71], v6 offset:34816
  v_mfma_f32_16x16x32_bf16 v[132:135], v[92:95], v[108:111], v[132:135]
  s_waitcnt vmcnt(8)
  ds_read_b64_tr_b16 v[104:105], v9 offset:2048
  v_mfma_f32_16x16x32_bf16 v[136:139], v[96:99], v[108:111], v[136:139]
  ds_read_b64_tr_b16 v[106:107], v9 offset:2304
  s_waitcnt lgkmcnt(9)
  s_waitcnt vmcnt(3)
  s_barrier
  s_cmp_lg_u32 s34, 0
  s_cbranch_scc1 w0_56
  s_add_u32 s93, s92, 0
  v_mov_b32 v251, s93
  v_mov_b32 v11, 1
  s_mov_b64 exec, 1
  global_atomic_add v251, v11, s[90:91] sc1
  s_mov_b64 exec, -1
  s_nop 3

w0_56:
  v_mfma_f32_16x16x32_bf16 a[228:231], a[224:227], v[100:103], a[228:231]
  s_mov_b32 m0, s65
  s_nop 0
  global_load_lds_dwordx4 v4, s[40:41]
  v_add_u32 v4, 2048, v4
  ds_read_b128 v[72:75], v6 offset:35840
  v_mfma_f32_16x16x32_bf16 a[236:239], v[100:103], v[100:103], a[236:239]
  ds_read_b128 v[76:79], v6 offset:36864
  v_mfma_f32_16x16x32_bf16 v[112:115], v[16:19], v[100:103], v[112:115]
  ds_read_b128 v[80:83], v6 offset:37888
  v_mfma_f32_16x16x32_bf16 v[116:119], v[20:23], v[100:103], v[116:119]
  ds_read_b128 v[84:87], v6 offset:38912
  v_mfma_f32_16x16x32_bf16 v[120:123], v[24:27], v[100:103], v[120:123]
  ds_read_b128 v[88:91], v6 offset:39936
  v_mfma_f32_16x16x32_bf16 v[124:127], v[28:31], v[100:103], v[124:127]
  ds_read_b128 v[92:95], v6 offset:40960
  v_mfma_f32_16x16x32_bf16 v[128:131], v[32:35], v[100:103], v[128:131]
  ds_read_b128 v[96:99], v6 offset:41984
  v_mfma_f32_16x16x32_bf16 v[132:135], v[36:39], v[100:103], v[132:135]
  s_waitcnt vmcnt(7)
  ds_read_b64_tr_b16 v[108:109], v9 offset:3072
  v_mfma_f32_16x16x32_bf16 v[136:139], v[40:43], v[100:103], v[136:139]
  ds_read_b64_tr_b16 v[110:111], v9 offset:3328
  s_waitcnt lgkmcnt(9)
  v_mfma_f32_16x16x32_bf16 a[228:231], a[224:227], v[104:107], a[228:231]
  s_mov_b32 m0, s66
  s_nop 0
  global_load_lds_dwordx4 v4, s[40:41]
  v_add_u32 v4, 2048, v4
  ds_read_b128 v[16:19], v6 offset:43008
  v_mfma_f32_16x16x32_bf16 a[236:239], v[104:107], v[104:107], a[236:239]
  ds_read_b128 v[20:23], v6 offset:44032
  v_mfma_f32_16x16x32_bf16 v[112:115], v[44:47], v[104:107], v[112:115]
  ds_read_b128 v[24:27], v6 offset:45056
  v_mfma_f32_16x16x32_bf16 v[116:119], v[48:51], v[104:107], v[116:119]
  ds_read_b128 v[28:31], v6 offset:46080
  v_mfma_f32_16x16x32_bf16 v[120:123], v[52:55], v[104:107], v[120:123]
  ds_read_b128 v[32:35], v6 offset:47104
  v_mfma_f32_16x16x32_bf16 v[124:127], v[56:59], v[104:107], v[124:127]
  ds_read_b128 v[36:39], v6 offset:48128
  v_mfma_f32_16x16x32_bf16 v[128:131], v[60:63], v[104:107], v[128:131]
  ds_read_b128 v[40:43], v6 offset:49152
  v_mfma_f32_16x16x32_bf16 v[132:135], v[64:67], v[104:107], v[132:135]
  s_waitcnt vmcnt(4)
  ds_read_b64_tr_b16 v[100:101], v9 offset:4096
  v_mfma_f32_16x16x32_bf16 v[136:139], v[68:71], v[104:107], v[136:139]
  ds_read_b64_tr_b16 v[102:103], v9 offset:4352
  s_waitcnt lgkmcnt(9)
  v_mfma_f32_16x16x32_bf16 a[228:231], a[224:227], v[108:111], a[228:231]
  s_mov_b32 m0, s67
  s_nop 0
  global_load_lds_dwordx4 v4, s[40:41]
  v_add_u32 v4, 2048, v4
  ds_read_b128 v[44:47], v6 offset:50176
  v_mfma_f32_16x16x32_bf16 a[236:239], v[108:111], v[108:111], a[236:239]
  ds_read_b128 v[48:51], v6 offset:51200
  v_mfma_f32_16x16x32_bf16 v[112:115], v[72:75], v[108:111], v[112:115]
  ds_read_b128 v[52:55], v6 offset:52224
  v_mfma_f32_16x16x32_bf16 v[116:119], v[76:79], v[108:111], v[116:119]
  ds_read_b128 v[56:59], v6 offset:53248
  v_mfma_f32_16x16x32_bf16 v[120:123], v[80:83], v[108:111], v[120:123]
  ds_read_b128 v[60:63], v6 offset:54272
  v_mfma_f32_16x16x32_bf16 v[124:127], v[84:87], v[108:111], v[124:127]
  ds_read_b128 v[64:67], v6 offset:55296
  v_mfma_f32_16x16x32_bf16 v[128:131], v[88:91], v[108:111], v[128:131]
  ds_read_b128 v[68:71], v6 offset:56320
  v_mfma_f32_16x16x32_bf16 v[132:135], v[92:95], v[108:111], v[132:135]
  s_waitcnt vmcnt(4)
  ds_read_b64_tr_b16 v[104:105], v9 offset:5120
  v_mfma_f32_16x16x32_bf16 v[136:139], v[96:99], v[108:111], v[136:139]
  ds_read_b64_tr_b16 v[106:107], v9 offset:5376
  s_waitcnt lgkmcnt(9)
  v_mfma_f32_16x16x32_bf16 a[228:231], a[224:227], v[100:103], a[228:231]
  s_mov_b32 m0, s68
  s_nop 0
  global_load_lds_dwordx4 v4, s[40:41]
  v_add_u32 v4, 2048, v4
  ds_read_b128 v[72:75], v7 offset:0
  v_mfma_f32_16x16x32_bf16 a[236:239], v[100:103], v[100:103], a[236:239]
  ds_read_b128 v[76:79], v7 offset:1024
  v_mfma_f32_16x16x32_bf16 v[112:115], v[16:19], v[100:103], v[112:115]
  ds_read_b128 v[80:83], v7 offset:2048
  v_mfma_f32_16x16x32_bf16 v[116:119], v[20:23], v[100:103], v[116:119]
  ds_read_b128 v[84:87], v7 offset:3072
  v_mfma_f32_16x16x32_bf16 v[120:123], v[24:27], v[100:103], v[120:123]
  ds_read_b128 v[88:91], v7 offset:4096
  v_mfma_f32_16x16x32_bf16 v[124:127], v[28:31], v[100:103], v[124:127]
  ds_read_b128 v[92:95], v7 offset:5120
  v_mfma_f32_16x16x32_bf16 v[128:131], v[32:35], v[100:103], v[128:131]
  ds_read_b128 v[96:99], v7 offset:6144
  v_mfma_f32_16x16x32_bf16 v[132:135], v[36:39], v[100:103], v[132:135]
  s_waitcnt vmcnt(4)
  ds_read_b64_tr_b16 v[108:109], v9 offset:0
  v_mfma_f32_16x16x32_bf16 v[136:139], v[40:43], v[100:103], v[136:139]
  ds_read_b64_tr_b16 v[110:111], v9 offset:256
  s_waitcnt lgkmcnt(9)
  v_mfma_f32_16x16x32_bf16 a[228:231], a[224:227], v[104:107], a[228:231]
  s_mov_b32 m0, s69
  s_nop 0
  global_load_lds_dwordx4 v4, s[40:41]
  v_add_u32 v4, 2048, v4
  ds_read_b128 v[16:19], v7 offset:7168
  v_mfma_f32_16x16x32_bf16 a[236:239], v[104:107], v[104:107], a[236:239]
  ds_read_b128 v[20:23], v7 offset:8192
  v_mfma_f32_16x16x32_bf16 v[112:115], v[44:47], v[104:107], v[112:115]
  ds_read_b128 v[24:27], v7 offset:9216
  v_mfma_f32_16x16x32_bf16 v[116:119], v[48:51], v[104:107], v[116:119]
  ds_read_b128 v[28:31], v7 offset:10240
  v_mfma_f32_16x16x32_bf16 v[120:123], v[52:55], v[104:107], v[120:123]
  ds_read_b128 v[32:35], v7 offset:11264
  v_mfma_f32_16x16x32_bf16 v[124:127], v[56:59], v[104:107], v[124:127]
  ds_read_b128 v[36:39], v7 offset:12288
  v_mfma_f32_16x16x32_bf16 v[128:131], v[60:63], v[104:107], v[128:131]
  ds_read_b128 v[40:43], v7 offset:13312
  v_mfma_f32_16x16x32_bf16 v[132:135], v[64:67], v[104:107], v[132:135]
  s_waitcnt vmcnt(4)
  ds_read_b64_tr_b16 v[100:101], v9 offset:1024
  v_mfma_f32_16x16x32_bf16 v[136:139], v[68:71], v[104:107], v[136:139]
  ds_read_b64_tr_b16 v[102:103], v9 offset:1280
  s_waitcnt lgkmcnt(9)
  v_mfma_f32_16x16x32_bf16 a[228:231], a[224:227], v[108:111], a[228:231]
  s_mov_b32 m0, s64
  s_nop 0
  global_load_lds_dwordx4 v4, s[40:41]
  v_add_u32 v4, 2048, v4
  ds_read_b128 v[44:47], v7 offset:14336
  v_mfma_f32_16x16x32_bf16 a[236:239], v[108:111], v[108:111], a[236:239]
  ds_read_b128 v[48:51], v7 offset:15360
  v_mfma_f32_16x16x32_bf16 v[112:115], v[72:75], v[108:111], v[112:115]
  ds_read_b128 v[52:55], v7 offset:16384
  v_mfma_f32_16x16x32_bf16 v[116:119], v[76:79], v[108:111], v[116:119]
  ds_read_b128 v[56:59], v7 offset:17408
  v_mfma_f32_16x16x32_bf16 v[120:123], v[80:83], v[108:111], v[120:123]
  ds_read_b128 v[60:63], v7 offset:18432
  v_mfma_f32_16x16x32_bf16 v[124:127], v[84:87], v[108:111], v[124:127]
  ds_read_b128 v[64:67], v7 offset:19456
  v_mfma_f32_16x16x32_bf16 v[128:131], v[88:91], v[108:111], v[128:131]
  ds_read_b128 v[68:71], v7 offset:20480
  v_mfma_f32_16x16x32_bf16 v[132:135], v[92:95], v[108:111], v[132:135]
  s_waitcnt vmcnt(4)
  ds_read_b64_tr_b16 v[104:105], v9 offset:2048
  v_mfma_f32_16x16x32_bf16 v[136:139], v[96:99], v[108:111], v[136:139]
  ds_read_b64_tr_b16 v[106:107], v9 offset:2304
  s_waitcnt lgkmcnt(9)
  v_mfma_f32_16x16x32_bf16 a[228:231], a[224:227], v[100:103], a[228:231]
  s_mov_b32 m0, s65
  s_nop 0
  global_load_lds_dwordx4 v4, s[40:41]
  v_add_u32 v4, 1017856, v4
  ds_read_b128 v[72:75], v7 offset:21504
  v_mfma_f32_16x16x32_bf16 a[236:239], v[100:103], v[100:103], a[236:239]
  ds_read_b128 v[76:79], v7 offset:22528
  v_mfma_f32_16x16x32_bf16 v[112:115], v[16:19], v[100:103], v[112:115]
  ds_read_b128 v[80:83], v7 offset:23552
  v_mfma_f32_16x16x32_bf16 v[116:119], v[20:23], v[100:103], v[116:119]
  ds_read_b128 v[84:87], v7 offset:24576
  v_mfma_f32_16x16x32_bf16 v[120:123], v[24:27], v[100:103], v[120:123]
  ds_read_b128 v[88:91], v7 offset:25600
  v_mfma_f32_16x16x32_bf16 v[124:127], v[28:31], v[100:103], v[124:127]
  ds_read_b128 v[92:95], v7 offset:26624
  v_mfma_f32_16x16x32_bf16 v[128:131], v[32:35], v[100:103], v[128:131]
  ds_read_b128 v[96:99], v7 offset:27648
  v_mfma_f32_16x16x32_bf16 v[132:135], v[36:39], v[100:103], v[132:135]
  s_waitcnt vmcnt(4)
  ds_read_b64_tr_b16 v[108:109], v9 offset:3072
  v_mfma_f32_16x16x32_bf16 v[136:139], v[40:43], v[100:103], v[136:139]
  ds_read_b64_tr_b16 v[110:111], v9 offset:3328
  s_waitcnt lgkmcnt(9)
  v_mfma_f32_16x16x32_bf16 a[228:231], a[224:227], v[104:107], a[228:231]
  ds_read_b128 v[16:19], v7 offset:28672
  ds_read_b128 v[20:23], v7 offset:29696
  v_mfma_f32_16x16x32_bf16 a[236:239], v[104:107], v[104:107], a[236:239]
  ds_read_b128 v[24:27], v7 offset:30720
  v_mfma_f32_16x16x32_bf16 v[112:115], v[44:47], v[104:107], v[112:115]
  ds_read_b128 v[28:31], v7 offset:31744
  v_mfma_f32_16x16x32_bf16 v[116:119], v[48:51], v[104:107], v[116:119]
  ds_read_b128 v[32:35], v7 offset:32768
  v_mfma_f32_16x16x32_bf16 v[120:123], v[52:55], v[104:107], v[120:123]
  ds_read_b128 v[36:39], v7 offset:33792
  v_mfma_f32_16x16x32_bf16 v[124:127], v[56:59], v[104:107], v[124:127]
  ds_read_b128 v[40:43], v7 offset:34816
  v_mfma_f32_16x16x32_bf16 v[128:131], v[60:63], v[104:107], v[128:131]
  s_waitcnt vmcnt(3)
  ds_read_b64_tr_b16 v[100:101], v9 offset:4096
  v_mfma_f32_16x16x32_bf16 v[132:135], v[64:67], v[104:107], v[132:135]
  ds_read_b64_tr_b16 v[102:103], v9 offset:4352
  v_mfma_f32_16x16x32_bf16 v[136:139], v[68:71], v[104:107], v[136:139]
  s_waitcnt lgkmcnt(9)
  v_mfma_f32_16x16x32_bf16 a[228:231], a[224:227], v[108:111], a[228:231]
  ds_read_b128 v[44:47], v7 offset:35840
  ds_read_b128 v[48:51], v7 offset:36864
  v_mfma_f32_16x16x32_bf16 a[236:239], v[108:111], v[108:111], a[236:239]
  ds_read_b128 v[52:55], v7 offset:37888
  v_mfma_f32_16x16x32_bf16 v[112:115], v[72:75], v[108:111], v[112:115]
  ds_read_b128 v[56:59], v7 offset:38912
  v_mfma_f32_16x16x32_bf16 v[116:119], v[76:79], v[108:111], v[116:119]
  ds_read_b128 v[60:63], v7 offset:39936
  v_mfma_f32_16x16x32_bf16 v[120:123], v[80:83], v[108:111], v[120:123]
  ds_read_b128 v[64:67], v7 offset:40960
  v_mfma_f32_16x16x32_bf16 v[124:127], v[84:87], v[108:111], v[124:127]
  ds_read_b128 v[68:71], v7 offset:41984
  v_mfma_f32_16x16x32_bf16 v[128:131], v[88:91], v[108:111], v[128:131]
  s_waitcnt vmcnt(2)
  ds_read_b64_tr_b16 v[104:105], v9 offset:5120
  v_mfma_f32_16x16x32_bf16 v[132:135], v[92:95], v[108:111], v[132:135]
  ds_read_b64_tr_b16 v[106:107], v9 offset:5376
  v_mfma_f32_16x16x32_bf16 v[136:139], v[96:99], v[108:111], v[136:139]
  s_waitcnt lgkmcnt(9)
  s_cmp_lg_u32 s34, 0
  s_cbranch_scc1 w0_57
  s_add_u32 s93, s92, 0
  v_mov_b32 v251, s93
  global_load_dword v11, v251, s[90:91] sc1

w0_57:
  v_mfma_f32_16x16x32_bf16 a[228:231], a[224:227], v[100:103], a[228:231]
  ds_read_b128 v[72:75], v7 offset:43008
  ds_read_b128 v[76:79], v7 offset:44032
  v_mfma_f32_16x16x32_bf16 a[236:239], v[100:103], v[100:103], a[236:239]
  ds_read_b128 v[80:83], v7 offset:45056
  v_mfma_f32_16x16x32_bf16 v[112:115], v[16:19], v[100:103], v[112:115]
  ds_read_b128 v[84:87], v7 offset:46080
  v_mfma_f32_16x16x32_bf16 v[116:119], v[20:23], v[100:103], v[116:119]
  ds_read_b128 v[88:91], v7 offset:47104
  v_mfma_f32_16x16x32_bf16 v[120:123], v[24:27], v[100:103], v[120:123]
  ds_read_b128 v[92:95], v7 offset:48128
  v_mfma_f32_16x16x32_bf16 v[124:127], v[28:31], v[100:103], v[124:127]
  ds_read_b128 v[96:99], v7 offset:49152
  v_mfma_f32_16x16x32_bf16 v[128:131], v[32:35], v[100:103], v[128:131]
  s_waitcnt vmcnt(1)
  ds_read_b64_tr_b16 v[108:109], v9 offset:0
  v_mfma_f32_16x16x32_bf16 v[132:135], v[36:39], v[100:103], v[132:135]
  ds_read_b64_tr_b16 v[110:111], v9 offset:256
  v_mfma_f32_16x16x32_bf16 v[136:139], v[40:43], v[100:103], v[136:139]
  s_waitcnt lgkmcnt(9)
  v_mfma_f32_16x16x32_bf16 a[228:231], a[224:227], v[104:107], a[228:231]
  ds_read_b128 v[16:19], v7 offset:50176
  ds_read_b128 v[20:23], v7 offset:51200
  v_mfma_f32_16x16x32_bf16 a[236:239], v[104:107], v[104:107], a[236:239]
  ds_read_b128 v[24:27], v7 offset:52224
  v_mfma_f32_16x16x32_bf16 v[112:115], v[44:47], v[104:107], v[112:115]
  ds_read_b128 v[28:31], v7 offset:53248
  v_mfma_f32_16x16x32_bf16 v[116:119], v[48:51], v[104:107], v[116:119]
  ds_read_b128 v[32:35], v7 offset:54272
  v_mfma_f32_16x16x32_bf16 v[120:123], v[52:55], v[104:107], v[120:123]
  ds_read_b128 v[36:39], v7 offset:55296
  v_mfma_f32_16x16x32_bf16 v[124:127], v[56:59], v[104:107], v[124:127]
  ds_read_b128 v[40:43], v7 offset:56320
  v_mfma_f32_16x16x32_bf16 v[128:131], v[60:63], v[104:107], v[128:131]
  s_waitcnt vmcnt(0)
  ds_read_b64_tr_b16 v[100:101], v9 offset:1024
  v_mfma_f32_16x16x32_bf16 v[132:135], v[64:67], v[104:107], v[132:135]
  ds_read_b64_tr_b16 v[102:103], v9 offset:1280
  v_mfma_f32_16x16x32_bf16 v[136:139], v[68:71], v[104:107], v[136:139]
  s_waitcnt lgkmcnt(9)
  v_mfma_f32_16x16x32_bf16 a[228:231], a[224:227], v[108:111], a[228:231]
  ds_read_b128 v[160:163], v13 offset:0
  ds_read_b128 v[164:167], v13 offset:448
  v_mfma_f32_16x16x32_bf16 a[236:239], v[108:111], v[108:111], a[236:239]
  ds_read_b128 v[168:171], v13 offset:64
  v_mfma_f32_16x16x32_bf16 v[112:115], v[72:75], v[108:111], v[112:115]
  ds_read_b128 v[172:175], v13 offset:512
  v_mfma_f32_16x16x32_bf16 v[116:119], v[76:79], v[108:111], v[116:119]
  v_mfma_f32_16x16x32_bf16 v[120:123], v[80:83], v[108:111], v[120:123]
  v_mfma_f32_16x16x32_bf16 v[124:127], v[84:87], v[108:111], v[124:127]
  v_mfma_f32_16x16x32_bf16 v[128:131], v[88:91], v[108:111], v[128:131]
  v_mfma_f32_16x16x32_bf16 v[132:135], v[92:95], v[108:111], v[132:135]
  v_mfma_f32_16x16x32_bf16 v[136:139], v[96:99], v[108:111], v[136:139]
  s_waitcnt lgkmcnt(4)
  v_mfma_f32_16x16x32_bf16 a[228:231], a[224:227], v[100:103], a[228:231]
  v_mfma_f32_16x16x32_bf16 a[236:239], v[100:103], v[100:103], a[236:239]
  v_mfma_f32_16x16x32_bf16 v[112:115], v[16:19], v[100:103], v[112:115]
  v_mfma_f32_16x16x32_bf16 v[116:119], v[20:23], v[100:103], v[116:119]
  v_mfma_f32_16x16x32_bf16 v[120:123], v[24:27], v[100:103], v[120:123]
  v_mfma_f32_16x16x32_bf16 v[124:127], v[28:31], v[100:103], v[124:127]
  v_mfma_f32_16x16x32_bf16 v[128:131], v[32:35], v[100:103], v[128:131]
  v_mfma_f32_16x16x32_bf16 v[132:135], v[36:39], v[100:103], v[132:135]
  v_mfma_f32_16x16x32_bf16 v[136:139], v[40:43], v[100:103], v[136:139]
  s_cmp_lg_u32 s34, 0
  s_cbranch_scc1 w0_60
  s_waitcnt vmcnt(0)
  s_mov_b32 s93, 200000
  v_cmp_ne_u32 vcc, 16, v11
  s_cbranch_vccz pd_59
  pl_58:
  s_sleep 4
  global_load_dword v11, v251, s[90:91] sc1
  s_waitcnt vmcnt(0)
  v_cmp_ne_u32 vcc, 16, v11
  s_cbranch_vccz pd_59
  s_sub_u32 s93, s93, 1
  s_cbranch_scc0 pl_58
  pd_59:

w0_60:
  s_barrier
  v_accvgpr_read_b32 v8, a228
  v_accvgpr_read_b32 v140, a236
  v_accvgpr_read_b32 v141, a237
  v_accvgpr_read_b32 v142, a238
  v_accvgpr_read_b32 v143, a239
  v_and_b32 v144, 3, v2
  v_cmp_eq_u32 vcc, 1, v144
  v_cndmask_b32 v10, v140, v141, vcc
  v_cmp_eq_u32 vcc, 2, v144
  global_load_dwordx4 v[240:243], v249, s[40:41]
  v_add_u32 v249, 0x100000, v249
  v_cndmask_b32 v10, v10, v142, vcc
  v_cmp_eq_u32 vcc, 3, v144
  v_cndmask_b32 v10, v10, v143, vcc
  v_lshrrev_b32 v144, 2, v2
  v_cmp_eq_u32 vcc, v144, v3
  v_cndmask_b32 v10, 0, v10, vcc

  v_mov_b32 v140, v10
  s_nop 1
  global_load_dwordx4 v[16:19], v248, s[42:43] offset:0
  v_permlane16_swap_b32 v10, v140
  s_nop 1
  v_add_f32 v10, v10, v140
  v_mov_b32 v140, v10
  s_nop 1
  v_permlane32_swap_b32 v10, v140
  s_nop 1
  v_add_f32 v10, v10, v140
  v_mul_f32 v8, s56, v8
  global_load_dwordx4 v[20:23], v248, s[42:43] offset:256
  v_add_u32 v248, 0x20000, v248
  v_mul_f32 v10, s56, v10
  v_fma_f32 v10, -v8, v8, v10
  v_max_f32 v10, 0, v10
  v_cvt_pk_bf16_f32 v140, v10, v10
  v_and_b32 v140, s58, v140
  v_add_f32 v140, s57, v140
  v_cvt_pk_bf16_f32 v140, v140, v140
  v_and_b32 v140, s58, v140
  v_sqrt_f32 v140, v140
  global_load_dwordx4 v[24:27], v248, s[42:43] offset:0
  s_nop 0
  v_cvt_pk_bf16_f32 v140, v140, v140
  v_and_b32 v140, s58, v140
  v_rcp_f32 v140, v140
  s_nop 0
  v_mul_f32 v10, v10, v140
  v_mul_f32 v10, v10, v140
  v_cvt_pk_bf16_f32 v10, v10, v10
  v_and_b32 v10, s58, v10
  global_load_dwordx4 v[28:31], v248, s[42:43] offset:256
  v_add_u32 v248, 0x20000, v248
  v_add_f32 v10, s57, v10
  v_cvt_pk_bf16_f32 v10, v10, v10
  v_and_b32 v10, s58, v10
  v_sqrt_f32 v10, v10
  s_nop 0
  v_cvt_pk_bf16_f32 v10, v10, v10
  v_and_b32 v10, s58, v10
  v_rcp_f32 v10, v10
  s_nop 0
  global_load_dwordx4 v[32:35], v248, s[42:43] offset:0
  v_mul_f32 v10, v10, v140
  v_mul_f32 v8, v8, v10

  s_waitcnt lgkmcnt(0)
  v_pk_fma_f32 v[140:141], v[8:9], v[164:165], v[160:161] op_sel:[0,0,0] op_sel_hi:[0,1,1] neg_lo:[1,0,0] neg_hi:[1,0,0]
  v_pk_fma_f32 v[142:143], v[8:9], v[166:167], v[162:163] op_sel:[0,0,0] op_sel_hi:[0,1,1] neg_lo:[1,0,0] neg_hi:[1,0,0]
  v_pk_fma_f32 v[144:145], v[8:9], v[172:173], v[168:169] op_sel:[0,0,0] op_sel_hi:[0,1,1] neg_lo:[1,0,0] neg_hi:[1,0,0]
  v_pk_fma_f32 v[146:147], v[8:9], v[174:175], v[170:171] op_sel:[0,0,0] op_sel_hi:[0,1,1] neg_lo:[1,0,0] neg_hi:[1,0,0]
  ds_read_b128 v[160:163], v13 offset:128
  global_load_dwordx4 v[36:39], v248, s[42:43] offset:256
  v_add_u32 v248, 0x20000, v248
  ds_read_b128 v[164:167], v13 offset:576
  ds_read_b128 v[168:171], v13 offset:192
  ds_read_b128 v[172:175], v13 offset:640
  v_pk_fma_f32 v[112:113], v[10:11], v[112:113], v[140:141] op_sel:[0,0,0] op_sel_hi:[0,1,1]
  v_pk_fma_f32 v[114:115], v[10:11], v[114:115], v[142:143] op_sel:[0,0,0] op_sel_hi:[0,1,1]
  v_pk_fma_f32 v[116:117], v[10:11], v[116:117], v[144:145] op_sel:[0,0,0] op_sel_hi:[0,1,1]
  v_pk_fma_f32 v[118:119], v[10:11], v[118:119], v[146:147] op_sel:[0,0,0] op_sel_hi:[0,1,1]
  v_pk_mul_f32 v[140:141], v[112:113], v[112:113]
  v_pk_mul_f32 v[142:143], v[114:115], v[114:115]
  global_load_dwordx4 v[40:43], v248, s[42:43] offset:0
  v_pk_mul_f32 v[144:145], v[116:117], v[116:117]
  v_pk_mul_f32 v[146:147], v[118:119], v[118:119]
  v_pk_fma_f32 v[140:141], v[140:141], v[14:15], s[70:71]
  v_pk_fma_f32 v[142:143], v[142:143], v[14:15], s[70:71]
  v_pk_fma_f32 v[144:145], v[144:145], v[14:15], s[70:71]
  v_pk_fma_f32 v[146:147], v[146:147], v[14:15], s[70:71]
  v_pk_mul_f32 v[140:141], v[140:141], v[112:113]
  v_pk_mul_f32 v[142:143], v[142:143], v[114:115]
  v_pk_mul_f32 v[144:145], v[144:145], v[116:117]
  global_load_dwordx4 v[44:47], v248, s[42:43] offset:256
  v_add_u32 v248, 0x20000, v248
  v_pk_mul_f32 v[146:147], v[146:147], v[118:119]
  v_exp_f32 v140, v140
  v_exp_f32 v141, v141
  v_exp_f32 v142, v142
  v_exp_f32 v143, v143
  v_exp_f32 v144, v144
  v_exp_f32 v145, v145
  v_exp_f32 v146, v146
  v_exp_f32 v147, v147
  global_load_dwordx4 v[48:51], v248, s[42:43] offset:0
  s_nop 0
  v_pk_add_f32 v[140:141], v[140:141], 1.0 op_sel_hi:[1,0]
  v_pk_add_f32 v[142:143], v[142:143], 1.0 op_sel_hi:[1,0]
  v_pk_add_f32 v[144:145], v[144:145], 1.0 op_sel_hi:[1,0]
  v_pk_add_f32 v[146:147], v[146:147], 1.0 op_sel_hi:[1,0]
  v_rcp_f32 v140, v140
  v_rcp_f32 v141, v141
  v_rcp_f32 v142, v142
  v_rcp_f32 v143, v143
  global_load_dwordx4 v[52:55], v248, s[42:43] offset:256
  v_add_u32 v248, 0x20000, v248
  v_rcp_f32 v144, v144
  v_rcp_f32 v145, v145
  v_rcp_f32 v146, v146
  v_rcp_f32 v147, v147
  s_nop 0
  v_pk_mul_f32 v[112:113], v[112:113], v[140:141]
  v_pk_mul_f32 v[114:115], v[114:115], v[142:143]
  v_pk_mul_f32 v[116:117], v[116:117], v[144:145]
  v_pk_mul_f32 v[118:119], v[118:119], v[146:147]
  global_load_dwordx4 v[56:59], v248, s[42:43] offset:0
  v_cvt_pk_bf16_f32 v148, v112, v113
  v_cvt_pk_bf16_f32 v149, v114, v115
  v_cvt_pk_bf16_f32 v150, v116, v117
  v_cvt_pk_bf16_f32 v151, v118, v119
  s_nop 1
  v_permlane16_swap_b32 v148, v150
  v_permlane16_swap_b32 v149, v151
  s_nop 1
  global_store_dwordx4 v5, v[148:151], s[42:43] sc1
  global_load_dwordx4 v[60:63], v248, s[42:43] offset:256
  v_add_u32 v248, 0x20000, v248
  v_add_u32 v5, 0x20000, v5

  s_waitcnt lgkmcnt(0)
  v_pk_fma_f32 v[140:141], v[8:9], v[164:165], v[160:161] op_sel:[0,0,0] op_sel_hi:[0,1,1] neg_lo:[1,0,0] neg_hi:[1,0,0]
  v_pk_fma_f32 v[142:143], v[8:9], v[166:167], v[162:163] op_sel:[0,0,0] op_sel_hi:[0,1,1] neg_lo:[1,0,0] neg_hi:[1,0,0]
  v_pk_fma_f32 v[144:145], v[8:9], v[172:173], v[168:169] op_sel:[0,0,0] op_sel_hi:[0,1,1] neg_lo:[1,0,0] neg_hi:[1,0,0]
  v_pk_fma_f32 v[146:147], v[8:9], v[174:175], v[170:171] op_sel:[0,0,0] op_sel_hi:[0,1,1] neg_lo:[1,0,0] neg_hi:[1,0,0]
  ds_read_b128 v[160:163], v13 offset:256
  ds_read_b128 v[164:167], v13 offset:704
  global_load_dwordx4 v[64:67], v248, s[42:43] offset:0
  ds_read_b128 v[168:171], v13 offset:320
  ds_read_b128 v[172:175], v13 offset:768
  v_pk_fma_f32 v[120:121], v[10:11], v[120:121], v[140:141] op_sel:[0,0,0] op_sel_hi:[0,1,1]
  v_pk_fma_f32 v[122:123], v[10:11], v[122:123], v[142:143] op_sel:[0,0,0] op_sel_hi:[0,1,1]
  v_pk_fma_f32 v[124:125], v[10:11], v[124:125], v[144:145] op_sel:[0,0,0] op_sel_hi:[0,1,1]
  v_pk_fma_f32 v[126:127], v[10:11], v[126:127], v[146:147] op_sel:[0,0,0] op_sel_hi:[0,1,1]
  v_pk_mul_f32 v[140:141], v[120:121], v[120:121]
  v_pk_mul_f32 v[142:143], v[122:123], v[122:123]
  v_pk_mul_f32 v[144:145], v[124:125], v[124:125]
  global_load_dwordx4 v[68:71], v248, s[42:43] offset:256
  v_add_u32 v248, 0x20000, v248
  v_pk_mul_f32 v[146:147], v[126:127], v[126:127]
  v_pk_fma_f32 v[140:141], v[140:141], v[14:15], s[70:71]
  v_pk_fma_f32 v[142:143], v[142:143], v[14:15], s[70:71]
  v_pk_fma_f32 v[144:145], v[144:145], v[14:15], s[70:71]
  v_pk_fma_f32 v[146:147], v[146:147], v[14:15], s[70:71]
  v_pk_mul_f32 v[140:141], v[140:141], v[120:121]
  v_pk_mul_f32 v[142:143], v[142:143], v[122:123]
  v_pk_mul_f32 v[144:145], v[144:145], v[124:125]
  v_pk_mul_f32 v[146:147], v[146:147], v[126:127]
  v_exp_f32 v140, v140
  v_exp_f32 v141, v141
  v_exp_f32 v142, v142
  v_exp_f32 v143, v143
  v_exp_f32 v144, v144
  v_exp_f32 v145, v145
  v_exp_f32 v146, v146
  v_exp_f32 v147, v147
  s_nop 0
  v_pk_add_f32 v[140:141], v[140:141], 1.0 op_sel_hi:[1,0]
  v_pk_add_f32 v[142:143], v[142:143], 1.0 op_sel_hi:[1,0]
  v_pk_add_f32 v[144:145], v[144:145], 1.0 op_sel_hi:[1,0]
  v_pk_add_f32 v[146:147], v[146:147], 1.0 op_sel_hi:[1,0]
  v_rcp_f32 v140, v140
  v_rcp_f32 v141, v141
  v_rcp_f32 v142, v142
  v_rcp_f32 v143, v143
  v_rcp_f32 v144, v144
  v_rcp_f32 v145, v145
  v_rcp_f32 v146, v146
  v_rcp_f32 v147, v147
  s_nop 0
  v_pk_mul_f32 v[120:121], v[120:121], v[140:141]
  v_pk_mul_f32 v[122:123], v[122:123], v[142:143]
  v_pk_mul_f32 v[124:125], v[124:125], v[144:145]
  v_pk_mul_f32 v[126:127], v[126:127], v[146:147]
  v_cvt_pk_bf16_f32 v152, v120, v121
  v_cvt_pk_bf16_f32 v153, v122, v123
  v_cvt_pk_bf16_f32 v154, v124, v125
  v_cvt_pk_bf16_f32 v155, v126, v127
  s_nop 1
  v_permlane16_swap_b32 v152, v154
  v_permlane16_swap_b32 v153, v155
  s_nop 1
  global_store_dwordx4 v5, v[152:155], s[42:43] sc1
  v_add_u32 v5, 0x20000, v5

  s_waitcnt lgkmcnt(0)
  v_pk_fma_f32 v[140:141], v[8:9], v[164:165], v[160:161] op_sel:[0,0,0] op_sel_hi:[0,1,1] neg_lo:[1,0,0] neg_hi:[1,0,0]
  v_pk_fma_f32 v[142:143], v[8:9], v[166:167], v[162:163] op_sel:[0,0,0] op_sel_hi:[0,1,1] neg_lo:[1,0,0] neg_hi:[1,0,0]
  v_pk_fma_f32 v[144:145], v[8:9], v[172:173], v[168:169] op_sel:[0,0,0] op_sel_hi:[0,1,1] neg_lo:[1,0,0] neg_hi:[1,0,0]
  v_pk_fma_f32 v[146:147], v[8:9], v[174:175], v[170:171] op_sel:[0,0,0] op_sel_hi:[0,1,1] neg_lo:[1,0,0] neg_hi:[1,0,0]
  ds_read_b128 v[160:163], v13 offset:384
  ds_read_b128 v[164:167], v13 offset:832
  v_pk_fma_f32 v[128:129], v[10:11], v[128:129], v[140:141] op_sel:[0,0,0] op_sel_hi:[0,1,1]
  v_pk_fma_f32 v[130:131], v[10:11], v[130:131], v[142:143] op_sel:[0,0,0] op_sel_hi:[0,1,1]
  v_pk_fma_f32 v[132:133], v[10:11], v[132:133], v[144:145] op_sel:[0,0,0] op_sel_hi:[0,1,1]
  v_pk_fma_f32 v[134:135], v[10:11], v[134:135], v[146:147] op_sel:[0,0,0] op_sel_hi:[0,1,1]
  v_pk_mul_f32 v[140:141], v[128:129], v[128:129]
  v_pk_mul_f32 v[142:143], v[130:131], v[130:131]
  v_pk_mul_f32 v[144:145], v[132:133], v[132:133]
  v_pk_mul_f32 v[146:147], v[134:135], v[134:135]
  v_pk_fma_f32 v[140:141], v[140:141], v[14:15], s[70:71]
  v_pk_fma_f32 v[142:143], v[142:143], v[14:15], s[70:71]
  v_pk_fma_f32 v[144:145], v[144:145], v[14:15], s[70:71]
  v_pk_fma_f32 v[146:147], v[146:147], v[14:15], s[70:71]
  v_pk_mul_f32 v[140:141], v[140:141], v[128:129]
  v_pk_mul_f32 v[142:143], v[142:143], v[130:131]
  v_pk_mul_f32 v[144:145], v[144:145], v[132:133]
  v_pk_mul_f32 v[146:147], v[146:147], v[134:135]
  v_exp_f32 v140, v140
  v_exp_f32 v141, v141
  v_exp_f32 v142, v142
  v_exp_f32 v143, v143
  v_exp_f32 v144, v144
  v_exp_f32 v145, v145
  v_exp_f32 v146, v146
  v_exp_f32 v147, v147
  s_nop 0
  v_pk_add_f32 v[140:141], v[140:141], 1.0 op_sel_hi:[1,0]
  v_pk_add_f32 v[142:143], v[142:143], 1.0 op_sel_hi:[1,0]
  v_pk_add_f32 v[144:145], v[144:145], 1.0 op_sel_hi:[1,0]
  v_pk_add_f32 v[146:147], v[146:147], 1.0 op_sel_hi:[1,0]
  v_rcp_f32 v140, v140
  v_rcp_f32 v141, v141
  v_rcp_f32 v142, v142
  v_rcp_f32 v143, v143
  v_rcp_f32 v144, v144
  v_rcp_f32 v145, v145
  v_rcp_f32 v146, v146
  v_rcp_f32 v147, v147
  s_nop 0
  v_pk_mul_f32 v[128:129], v[128:129], v[140:141]
  v_pk_mul_f32 v[130:131], v[130:131], v[142:143]
  v_pk_mul_f32 v[132:133], v[132:133], v[144:145]
  v_pk_mul_f32 v[134:135], v[134:135], v[146:147]
  v_cvt_pk_bf16_f32 v148, v128, v129
  v_cvt_pk_bf16_f32 v149, v130, v131
  v_cvt_pk_bf16_f32 v150, v132, v133
  v_cvt_pk_bf16_f32 v151, v134, v135
  s_nop 1
  v_permlane16_swap_b32 v148, v150
  v_permlane16_swap_b32 v149, v151
  s_nop 1
  global_store_dwordx4 v5, v[148:151], s[42:43] sc1
  v_add_u32 v5, 0xfffc4000, v5

  s_waitcnt lgkmcnt(0)
  v_pk_fma_f32 v[140:141], v[8:9], v[164:165], v[160:161] op_sel:[0,0,0] op_sel_hi:[0,1,1] neg_lo:[1,0,0] neg_hi:[1,0,0]
  v_pk_fma_f32 v[142:143], v[8:9], v[166:167], v[162:163] op_sel:[0,0,0] op_sel_hi:[0,1,1] neg_lo:[1,0,0] neg_hi:[1,0,0]
  v_pk_fma_f32 v[136:137], v[10:11], v[136:137], v[140:141] op_sel:[0,0,0] op_sel_hi:[0,1,1]
  v_pk_fma_f32 v[138:139], v[10:11], v[138:139], v[142:143] op_sel:[0,0,0] op_sel_hi:[0,1,1]
  v_pk_mul_f32 v[140:141], v[136:137], v[136:137]
  v_pk_mul_f32 v[142:143], v[138:139], v[138:139]
  v_pk_fma_f32 v[140:141], v[140:141], v[14:15], s[70:71]
  v_pk_fma_f32 v[142:143], v[142:143], v[14:15], s[70:71]
  v_pk_mul_f32 v[140:141], v[140:141], v[136:137]
  v_pk_mul_f32 v[142:143], v[142:143], v[138:139]
  v_exp_f32 v140, v140
  v_exp_f32 v141, v141
  v_exp_f32 v142, v142
  v_exp_f32 v143, v143
  s_nop 0
  v_pk_add_f32 v[140:141], v[140:141], 1.0 op_sel_hi:[1,0]
  v_pk_add_f32 v[142:143], v[142:143], 1.0 op_sel_hi:[1,0]
  v_rcp_f32 v140, v140
  v_rcp_f32 v141, v141
  v_rcp_f32 v142, v142
  v_rcp_f32 v143, v143
  s_nop 0
  v_pk_mul_f32 v[136:137], v[136:137], v[140:141]
  v_pk_mul_f32 v[138:139], v[138:139], v[142:143]
  v_cvt_pk_bf16_f32 v152, v136, v137
  v_cvt_pk_bf16_f32 v153, v138, v139
  global_store_dwordx2 v12, v[152:153], s[42:43] sc1
  v_add_u32 v12, 16384, v12
  v_lshlrev_b32 v112, 4, v0
  v_add_u32 v112, 151552, v112
  s_waitcnt vmcnt(18)
  ds_write_b128 v112, v[240:243]

  s_waitcnt vmcnt(16)
  v_mfma_f32_16x16x32_bf16 v[208:211], a[0:3], v[16:19], 0
  v_mfma_f32_16x16x32_bf16 v[212:215], a[0:3], v[20:23], 0
  global_load_dwordx4 v[72:75], v248, s[42:43] offset:0
  v_mfma_f32_16x16x32_bf16 v[216:219], a[4:7], v[16:19], 0
  global_load_dwordx4 v[76:79], v248, s[42:43] offset:256
  v_add_u32 v248, 0x20000, v248
  v_mfma_f32_16x16x32_bf16 v[220:223], a[4:7], v[20:23], 0
  v_mfma_f32_16x16x32_bf16 v[224:227], a[8:11], v[16:19], 0
  v_mfma_f32_16x16x32_bf16 v[228:231], a[8:11], v[20:23], 0
  v_mfma_f32_16x16x32_bf16 v[232:235], a[12:15], v[16:19], 0
  v_mfma_f32_16x16x32_bf16 v[236:239], a[12:15], v[20:23], 0
  s_waitcnt vmcnt(16)
  v_mfma_f32_16x16x32_bf16 v[208:211], a[16:19], v[24:27], v[208:211]
  v_mfma_f32_16x16x32_bf16 v[212:215], a[16:19], v[28:31], v[212:215]
  global_load_dwordx4 v[80:83], v248, s[42:43] offset:0
  v_mfma_f32_16x16x32_bf16 v[216:219], a[20:23], v[24:27], v[216:219]
  global_load_dwordx4 v[84:87], v248, s[42:43] offset:256
  v_add_u32 v248, 0x20000, v248
  v_mfma_f32_16x16x32_bf16 v[220:223], a[20:23], v[28:31], v[220:223]
  v_mfma_f32_16x16x32_bf16 v[224:227], a[24:27], v[24:27], v[224:227]
  v_mfma_f32_16x16x32_bf16 v[228:231], a[24:27], v[28:31], v[228:231]
  v_mfma_f32_16x16x32_bf16 v[232:235], a[28:31], v[24:27], v[232:235]
  v_mfma_f32_16x16x32_bf16 v[236:239], a[28:31], v[28:31], v[236:239]
  s_waitcnt vmcnt(16)
  v_mfma_f32_16x16x32_bf16 v[208:211], a[32:35], v[32:35], v[208:211]
  v_mfma_f32_16x16x32_bf16 v[212:215], a[32:35], v[36:39], v[212:215]
  global_load_dwordx4 v[88:91], v248, s[42:43] offset:0
  v_mfma_f32_16x16x32_bf16 v[216:219], a[36:39], v[32:35], v[216:219]
  global_load_dwordx4 v[92:95], v248, s[42:43] offset:256
  v_add_u32 v248, 0x20000, v248
  v_mfma_f32_16x16x32_bf16 v[220:223], a[36:39], v[36:39], v[220:223]
  v_mfma_f32_16x16x32_bf16 v[224:227], a[40:43], v[32:35], v[224:227]
  v_mfma_f32_16x16x32_bf16 v[228:231], a[40:43], v[36:39], v[228:231]
  v_mfma_f32_16x16x32_bf16 v[232:235], a[44:47], v[32:35], v[232:235]
  v_mfma_f32_16x16x32_bf16 v[236:239], a[44:47], v[36:39], v[236:239]
  s_waitcnt vmcnt(16)
  s_waitcnt vmcnt(6)
  s_barrier
  s_cmp_lg_u32 s34, 0
  s_cbranch_scc1 w0_61
  s_add_u32 s93, s92, 8192
  v_mov_b32 v251, s93
  v_mov_b32 v11, 1
  s_mov_b64 exec, 1
  global_atomic_add v251, v11, s[90:91] sc1
  s_mov_b64 exec, -1
  s_nop 3

w0_61:
  v_mfma_f32_16x16x32_bf16 v[208:211], a[48:51], v[40:43], v[208:211]
  v_mfma_f32_16x16x32_bf16 v[212:215], a[48:51], v[44:47], v[212:215]
  global_load_dwordx4 v[96:99], v248, s[42:43] offset:0
  v_mfma_f32_16x16x32_bf16 v[216:219], a[52:55], v[40:43], v[216:219]
  global_load_dwordx4 v[100:103], v248, s[42:43] offset:256
  v_add_u32 v248, 0x20000, v248
  v_mfma_f32_16x16x32_bf16 v[220:223], a[52:55], v[44:47], v[220:223]
  v_mfma_f32_16x16x32_bf16 v[224:227], a[56:59], v[40:43], v[224:227]
  v_mfma_f32_16x16x32_bf16 v[228:231], a[56:59], v[44:47], v[228:231]
  v_mfma_f32_16x16x32_bf16 v[232:235], a[60:63], v[40:43], v[232:235]
  v_mfma_f32_16x16x32_bf16 v[236:239], a[60:63], v[44:47], v[236:239]
  s_waitcnt vmcnt(16)
  v_mfma_f32_16x16x32_bf16 v[208:211], a[64:67], v[48:51], v[208:211]
  v_mfma_f32_16x16x32_bf16 v[212:215], a[64:67], v[52:55], v[212:215]
  global_load_dwordx4 v[104:107], v248, s[42:43] offset:0
  v_mfma_f32_16x16x32_bf16 v[216:219], a[68:71], v[48:51], v[216:219]
  global_load_dwordx4 v[108:111], v248, s[42:43] offset:256
  v_add_u32 v248, 0x20000, v248
  v_mfma_f32_16x16x32_bf16 v[220:223], a[68:71], v[52:55], v[220:223]
  v_mfma_f32_16x16x32_bf16 v[224:227], a[72:75], v[48:51], v[224:227]
  v_mfma_f32_16x16x32_bf16 v[228:231], a[72:75], v[52:55], v[228:231]
  v_mfma_f32_16x16x32_bf16 v[232:235], a[76:79], v[48:51], v[232:235]
  v_mfma_f32_16x16x32_bf16 v[236:239], a[76:79], v[52:55], v[236:239]
  s_waitcnt vmcnt(15)
  v_mfma_f32_16x16x32_bf16 v[208:211], a[80:83], v[56:59], v[208:211]
  v_mfma_f32_16x16x32_bf16 v[212:215], a[80:83], v[60:63], v[212:215]
  global_load_dwordx4 v[16:19], v248, s[42:43] offset:0
  v_mfma_f32_16x16x32_bf16 v[216:219], a[84:87], v[56:59], v[216:219]
  global_load_dwordx4 v[20:23], v248, s[42:43] offset:256
  v_add_u32 v248, 0x20000, v248
  v_mfma_f32_16x16x32_bf16 v[220:223], a[84:87], v[60:63], v[220:223]
  v_mfma_f32_16x16x32_bf16 v[224:227], a[88:91], v[56:59], v[224:227]
  v_mfma_f32_16x16x32_bf16 v[228:231], a[88:91], v[60:63], v[228:231]
  v_mfma_f32_16x16x32_bf16 v[232:235], a[92:95], v[56:59], v[232:235]
  v_mfma_f32_16x16x32_bf16 v[236:239], a[92:95], v[60:63], v[236:239]
  s_waitcnt vmcnt(15)
  v_mfma_f32_16x16x32_bf16 v[208:211], a[96:99], v[64:67], v[208:211]
  v_mfma_f32_16x16x32_bf16 v[212:215], a[96:99], v[68:71], v[212:215]
  global_load_dwordx4 v[24:27], v248, s[42:43] offset:0
  v_mfma_f32_16x16x32_bf16 v[216:219], a[100:103], v[64:67], v[216:219]
  global_load_dwordx4 v[28:31], v248, s[42:43] offset:256
  v_add_u32 v248, 0xffe64000, v248
  v_mfma_f32_16x16x32_bf16 v[220:223], a[100:103], v[68:71], v[220:223]
  v_mfma_f32_16x16x32_bf16 v[224:227], a[104:107], v[64:67], v[224:227]
  v_mfma_f32_16x16x32_bf16 v[228:231], a[104:107], v[68:71], v[228:231]
  v_mfma_f32_16x16x32_bf16 v[232:235], a[108:111], v[64:67], v[232:235]
  v_mfma_f32_16x16x32_bf16 v[236:239], a[108:111], v[68:71], v[236:239]
  s_waitcnt vmcnt(12)
  v_mfma_f32_16x16x32_bf16 v[208:211], a[112:115], v[72:75], v[208:211]
  v_mfma_f32_16x16x32_bf16 v[212:215], a[112:115], v[76:79], v[212:215]
  v_mfma_f32_16x16x32_bf16 v[216:219], a[116:119], v[72:75], v[216:219]
  v_mfma_f32_16x16x32_bf16 v[220:223], a[116:119], v[76:79], v[220:223]
  v_mfma_f32_16x16x32_bf16 v[224:227], a[120:123], v[72:75], v[224:227]
  v_mfma_f32_16x16x32_bf16 v[228:231], a[120:123], v[76:79], v[228:231]
  v_mfma_f32_16x16x32_bf16 v[232:235], a[124:127], v[72:75], v[232:235]
  v_mfma_f32_16x16x32_bf16 v[236:239], a[124:127], v[76:79], v[236:239]
  s_waitcnt vmcnt(10)
  v_mfma_f32_16x16x32_bf16 v[208:211], a[128:131], v[80:83], v[208:211]
  v_mfma_f32_16x16x32_bf16 v[212:215], a[128:131], v[84:87], v[212:215]
  v_mfma_f32_16x16x32_bf16 v[216:219], a[132:135], v[80:83], v[216:219]
  v_mfma_f32_16x16x32_bf16 v[220:223], a[132:135], v[84:87], v[220:223]
  v_mfma_f32_16x16x32_bf16 v[224:227], a[136:139], v[80:83], v[224:227]
  v_mfma_f32_16x16x32_bf16 v[228:231], a[136:139], v[84:87], v[228:231]
  v_mfma_f32_16x16x32_bf16 v[232:235], a[140:143], v[80:83], v[232:235]
  v_mfma_f32_16x16x32_bf16 v[236:239], a[140:143], v[84:87], v[236:239]
  s_waitcnt vmcnt(8)
  v_mfma_f32_16x16x32_bf16 v[208:211], a[144:147], v[88:91], v[208:211]
  v_mfma_f32_16x16x32_bf16 v[212:215], a[144:147], v[92:95], v[212:215]
  v_mfma_f32_16x16x32_bf16 v[216:219], a[148:151], v[88:91], v[216:219]
  v_mfma_f32_16x16x32_bf16 v[220:223], a[148:151], v[92:95], v[220:223]
  v_mfma_f32_16x16x32_bf16 v[224:227], a[152:155], v[88:91], v[224:227]
  v_mfma_f32_16x16x32_bf16 v[228:231], a[152:155], v[92:95], v[228:231]
  v_mfma_f32_16x16x32_bf16 v[232:235], a[156:159], v[88:91], v[232:235]
  v_mfma_f32_16x16x32_bf16 v[236:239], a[156:159], v[92:95], v[236:239]
  s_waitcnt vmcnt(6)
  s_cmp_lg_u32 s34, 0
  s_cbranch_scc1 w0_62
  s_add_u32 s93, s92, 8192
  v_mov_b32 v251, s93
  global_load_dword v11, v251, s[90:91] sc1

w0_62:
  v_mfma_f32_16x16x32_bf16 v[208:211], a[160:163], v[96:99], v[208:211]
  v_mfma_f32_16x16x32_bf16 v[212:215], a[160:163], v[100:103], v[212:215]
  v_mfma_f32_16x16x32_bf16 v[216:219], a[164:167], v[96:99], v[216:219]
  v_mfma_f32_16x16x32_bf16 v[220:223], a[164:167], v[100:103], v[220:223]
  v_mfma_f32_16x16x32_bf16 v[224:227], a[168:171], v[96:99], v[224:227]
  v_mfma_f32_16x16x32_bf16 v[228:231], a[168:171], v[100:103], v[228:231]
  v_mfma_f32_16x16x32_bf16 v[232:235], a[172:175], v[96:99], v[232:235]
  v_mfma_f32_16x16x32_bf16 v[236:239], a[172:175], v[100:103], v[236:239]
  s_waitcnt vmcnt(4)
  v_mfma_f32_16x16x32_bf16 v[208:211], a[176:179], v[104:107], v[208:211]
  v_mfma_f32_16x16x32_bf16 v[212:215], a[176:179], v[108:111], v[212:215]
  v_mfma_f32_16x16x32_bf16 v[216:219], a[180:183], v[104:107], v[216:219]
  v_mfma_f32_16x16x32_bf16 v[220:223], a[180:183], v[108:111], v[220:223]
  v_mfma_f32_16x16x32_bf16 v[224:227], a[184:187], v[104:107], v[224:227]
  v_mfma_f32_16x16x32_bf16 v[228:231], a[184:187], v[108:111], v[228:231]
  v_mfma_f32_16x16x32_bf16 v[232:235], a[188:191], v[104:107], v[232:235]
  v_mfma_f32_16x16x32_bf16 v[236:239], a[188:191], v[108:111], v[236:239]
  s_waitcnt vmcnt(2)
  v_mfma_f32_16x16x32_bf16 v[208:211], a[192:195], v[16:19], v[208:211]
  v_mfma_f32_16x16x32_bf16 v[212:215], a[192:195], v[20:23], v[212:215]
  v_mfma_f32_16x16x32_bf16 v[216:219], a[196:199], v[16:19], v[216:219]
  v_mfma_f32_16x16x32_bf16 v[220:223], a[196:199], v[20:23], v[220:223]
  v_mfma_f32_16x16x32_bf16 v[224:227], a[200:203], v[16:19], v[224:227]
  v_mfma_f32_16x16x32_bf16 v[228:231], a[200:203], v[20:23], v[228:231]
  v_mfma_f32_16x16x32_bf16 v[232:235], a[204:207], v[16:19], v[232:235]
  v_mfma_f32_16x16x32_bf16 v[236:239], a[204:207], v[20:23], v[236:239]
  s_waitcnt vmcnt(0)
  v_mfma_f32_16x16x32_bf16 v[208:211], a[208:211], v[24:27], v[208:211]
  v_mfma_f32_16x16x32_bf16 v[212:215], a[208:211], v[28:31], v[212:215]
  v_mfma_f32_16x16x32_bf16 v[216:219], a[212:215], v[24:27], v[216:219]
  v_mfma_f32_16x16x32_bf16 v[220:223], a[212:215], v[28:31], v[220:223]
  v_mfma_f32_16x16x32_bf16 v[224:227], a[216:219], v[24:27], v[224:227]
  v_mfma_f32_16x16x32_bf16 v[228:231], a[216:219], v[28:31], v[228:231]
  v_mfma_f32_16x16x32_bf16 v[232:235], a[220:223], v[24:27], v[232:235]
  v_mfma_f32_16x16x32_bf16 v[236:239], a[220:223], v[28:31], v[236:239]
  v_mul_u32_u24 v113, 272, v2
  v_lshl_add_u32 v113, v3, 4, v113
  s_mul_i32 s50, s34, 8704
  s_add_u32 s50, s50, 114688
  v_add_u32 v113, s50, v113
  v_and_b32 v114, 31, v1
  v_mul_u32_u24 v115, 272, v114
  v_lshrrev_b32 v116, 5, v1
  v_lshl_add_u32 v115, v116, 5, v115
  s_lshl_b32 s50, s34, 6
  s_add_u32 s50, s50, 114688
  v_add_u32 v115, s50, v115

  ds_write_b128 v113, v[208:211] offset:0
  ds_write_b128 v113, v[212:215] offset:4352
  ds_write_b128 v113, v[216:219] offset:64
  ds_write_b128 v113, v[220:223] offset:4416
  ds_write_b128 v113, v[224:227] offset:128
  ds_write_b128 v113, v[228:231] offset:4480
  ds_write_b128 v113, v[232:235] offset:192
  ds_write_b128 v113, v[236:239] offset:4544
  v_lshrrev_b32 v117, 2, v2
  v_lshl_add_u32 v117, v116, 3, v117
  v_lshlrev_b32 v117, 6, v117
  v_and_b32 v118, 1, v3
  v_lshl_add_u32 v117, v118, 5, v117
  v_and_b32 v118, 3, v2
  v_lshl_add_u32 v117, v118, 3, v117
  s_lshl_b32 s50, s34, 10
  s_add_u32 s50, s50, 151552
  v_add_u32 v117, s50, v117

  v_lshlrev_b32 v120, 16, v244
  v_and_b32 v121, s58, v244
  v_lshlrev_b32 v122, 16, v245
  v_and_b32 v123, s58, v245
  v_lshlrev_b32 v124, 16, v246
  v_and_b32 v125, s58, v246
  v_lshlrev_b32 v126, 16, v247
  v_and_b32 v127, s58, v247
  s_cmp_lg_u32 s34, 0
  s_cbranch_scc1 w0_65
  s_waitcnt vmcnt(0)
  s_mov_b32 s93, 200000
  v_cmp_ne_u32 vcc, 16, v11
  s_cbranch_vccz pd_64
  pl_63:
  s_sleep 4
  global_load_dword v11, v251, s[90:91] sc1
  s_waitcnt vmcnt(0)
  v_cmp_ne_u32 vcc, 16, v11
  s_cbranch_vccz pd_64
  s_sub_u32 s93, s93, 1
  s_cbranch_scc0 pl_63
  pd_64:

w0_65:
  s_waitcnt lgkmcnt(0)
  s_barrier
  ds_read_b128 v[128:131], v115 offset:0
  ds_read_b128 v[132:135], v115 offset:16
  ds_read_b128 v[136:139], v115 offset:8704
  ds_read_b128 v[140:143], v115 offset:8720
  ds_read_b128 v[144:147], v115 offset:17408
  ds_read_b128 v[148:151], v115 offset:17424
  ds_read_b128 v[152:155], v115 offset:26112
  ds_read_b128 v[156:159], v115 offset:26128
  ds_read_b64_tr_b16 v[160:161], v117
  ds_read_b64_tr_b16 v[162:163], v117 offset:256
  global_load_dwordx4 v[240:243], v249, s[40:41]
  v_add_u32 v249, 0x100000, v249
  global_load_dwordx4 v[16:19], v248, s[42:43] offset:0
  global_load_dwordx4 v[20:23], v248, s[42:43] offset:256
  v_add_u32 v248, 0x20000, v248
  global_load_dwordx4 v[24:27], v248, s[42:43] offset:0
  s_waitcnt lgkmcnt(0)
  s_barrier
  v_pk_add_f32 v[128:129], v[128:129], v[136:137]
  global_load_dwordx4 v[28:31], v248, s[42:43] offset:256
  v_add_u32 v248, 0x20000, v248
  v_pk_add_f32 v[144:145], v[144:145], v[152:153]
  v_pk_add_f32 v[130:131], v[130:131], v[138:139]
  v_pk_add_f32 v[146:147], v[146:147], v[154:155]
  global_load_dwordx4 v[32:35], v248, s[42:43] offset:0
  v_pk_add_f32 v[132:133], v[132:133], v[140:141]
  v_pk_add_f32 v[148:149], v[148:149], v[156:157]
  v_pk_add_f32 v[134:135], v[134:135], v[142:143]
  global_load_dwordx4 v[36:39], v248, s[42:43] offset:256
  v_add_u32 v248, 0x20000, v248
  v_pk_add_f32 v[150:151], v[150:151], v[158:159]
  v_pk_add_f32 v[128:129], v[128:129], v[144:145]
  v_pk_add_f32 v[130:131], v[130:131], v[146:147]
  global_load_dwordx4 v[40:43], v248, s[42:43] offset:0
  v_pk_add_f32 v[132:133], v[132:133], v[148:149]
  v_pk_add_f32 v[134:135], v[134:135], v[150:151]
  v_cvt_pk_bf16_f32 v164, v128, v129
  global_load_dwordx4 v[44:47], v248, s[42:43] offset:256
  v_add_u32 v248, 0x20000, v248
  v_lshlrev_b32 v128, 16, v164
  v_and_b32 v129, s58, v164
  v_pk_add_f32 v[128:129], v[128:129], v[120:121]
  global_load_dwordx4 v[48:51], v248, s[42:43] offset:0
  v_cvt_pk_bf16_f32 v164, v128, v129
  v_lshlrev_b32 v128, 16, v164
  v_and_b32 v129, s58, v164
  global_load_dwordx4 v[52:55], v248, s[42:43] offset:256
  v_add_u32 v248, 0x20000, v248
  v_lshlrev_b32 v164, 16, v160
  v_and_b32 v165, s58, v160
  v_pk_add_f32 v[128:129], v[128:129], v[164:165]
  global_load_dwordx4 v[56:59], v248, s[42:43] offset:0
  v_cvt_pk_bf16_f32 v172, v128, v129

  v_cvt_pk_bf16_f32 v166, v130, v131
  global_load_dwordx4 v[60:63], v248, s[42:43] offset:256
  v_add_u32 v248, 0x20000, v248
  v_lshlrev_b32 v130, 16, v166
  v_and_b32 v131, s58, v166
  v_pk_add_f32 v[130:131], v[130:131], v[122:123]
  global_load_dwordx4 v[64:67], v248, s[42:43] offset:0
  v_cvt_pk_bf16_f32 v166, v130, v131
  v_lshlrev_b32 v130, 16, v166
  v_and_b32 v131, s58, v166
  global_load_dwordx4 v[68:71], v248, s[42:43] offset:256
  v_add_u32 v248, 0x20000, v248
  v_lshlrev_b32 v166, 16, v161
  v_and_b32 v167, s58, v161
  v_pk_add_f32 v[130:131], v[130:131], v[166:167]
  v_cvt_pk_bf16_f32 v173, v130, v131

  v_cvt_pk_bf16_f32 v168, v132, v133
  v_lshlrev_b32 v132, 16, v168
  v_and_b32 v133, s58, v168
  v_pk_add_f32 v[132:133], v[132:133], v[124:125]
  v_cvt_pk_bf16_f32 v168, v132, v133
  v_lshlrev_b32 v132, 16, v168
  v_and_b32 v133, s58, v168
  v_lshlrev_b32 v168, 16, v162
  v_and_b32 v169, s58, v162
  v_pk_add_f32 v[132:133], v[132:133], v[168:169]
  v_cvt_pk_bf16_f32 v174, v132, v133

  v_cvt_pk_bf16_f32 v170, v134, v135
  v_lshlrev_b32 v134, 16, v170
  v_and_b32 v135, s58, v170
  v_pk_add_f32 v[134:135], v[134:135], v[126:127]
  v_cvt_pk_bf16_f32 v170, v134, v135
  v_lshlrev_b32 v134, 16, v170
  v_and_b32 v135, s58, v170
  v_lshlrev_b32 v170, 16, v163
  v_and_b32 v171, s58, v163
  v_pk_add_f32 v[134:135], v[134:135], v[170:171]
  v_cvt_pk_bf16_f32 v175, v134, v135

  s_add_u32 s50, s48, 0
  v_add_u32 v118, s50, v114
  v_lshlrev_b32 v118, 10, v118
  v_lshl_add_u32 v118, v250, 4, v118
  global_store_dwordx4 v118, v[172:175], s[28:29]

  v_lshlrev_b32 v112, 4, v0
  v_add_u32 v112, 155648, v112
  s_waitcnt vmcnt(15)
  ds_write_b128 v112, v[240:243]

  s_waitcnt vmcnt(13)
  v_mfma_f32_16x16x32_bf16 v[208:211], a[0:3], v[16:19], 0
  v_mfma_f32_16x16x32_bf16 v[212:215], a[0:3], v[20:23], 0
  global_load_dwordx4 v[72:75], v248, s[42:43] offset:0
  v_mfma_f32_16x16x32_bf16 v[216:219], a[4:7], v[16:19], 0
  global_load_dwordx4 v[76:79], v248, s[42:43] offset:256
  v_add_u32 v248, 0x20000, v248
  v_mfma_f32_16x16x32_bf16 v[220:223], a[4:7], v[20:23], 0
  v_mfma_f32_16x16x32_bf16 v[224:227], a[8:11], v[16:19], 0
  v_mfma_f32_16x16x32_bf16 v[228:231], a[8:11], v[20:23], 0
  v_mfma_f32_16x16x32_bf16 v[232:235], a[12:15], v[16:19], 0
  v_mfma_f32_16x16x32_bf16 v[236:239], a[12:15], v[20:23], 0
  s_waitcnt vmcnt(13)
  v_mfma_f32_16x16x32_bf16 v[208:211], a[16:19], v[24:27], v[208:211]
  v_mfma_f32_16x16x32_bf16 v[212:215], a[16:19], v[28:31], v[212:215]
  global_load_dwordx4 v[80:83], v248, s[42:43] offset:0
  v_mfma_f32_16x16x32_bf16 v[216:219], a[20:23], v[24:27], v[216:219]
  global_load_dwordx4 v[84:87], v248, s[42:43] offset:256
  v_add_u32 v248, 0x20000, v248
  v_mfma_f32_16x16x32_bf16 v[220:223], a[20:23], v[28:31], v[220:223]
  v_mfma_f32_16x16x32_bf16 v[224:227], a[24:27], v[24:27], v[224:227]
  v_mfma_f32_16x16x32_bf16 v[228:231], a[24:27], v[28:31], v[228:231]
  v_mfma_f32_16x16x32_bf16 v[232:235], a[28:31], v[24:27], v[232:235]
  v_mfma_f32_16x16x32_bf16 v[236:239], a[28:31], v[28:31], v[236:239]
  s_waitcnt vmcnt(13)
  v_mfma_f32_16x16x32_bf16 v[208:211], a[32:35], v[32:35], v[208:211]
  v_mfma_f32_16x16x32_bf16 v[212:215], a[32:35], v[36:39], v[212:215]
  global_load_dwordx4 v[88:91], v248, s[42:43] offset:0
  v_mfma_f32_16x16x32_bf16 v[216:219], a[36:39], v[32:35], v[216:219]
  global_load_dwordx4 v[92:95], v248, s[42:43] offset:256
  v_add_u32 v248, 0x20000, v248
  v_mfma_f32_16x16x32_bf16 v[220:223], a[36:39], v[36:39], v[220:223]
  v_mfma_f32_16x16x32_bf16 v[224:227], a[40:43], v[32:35], v[224:227]
  v_mfma_f32_16x16x32_bf16 v[228:231], a[40:43], v[36:39], v[228:231]
  v_mfma_f32_16x16x32_bf16 v[232:235], a[44:47], v[32:35], v[232:235]
  v_mfma_f32_16x16x32_bf16 v[236:239], a[44:47], v[36:39], v[236:239]
  s_waitcnt vmcnt(13)
  v_mfma_f32_16x16x32_bf16 v[208:211], a[48:51], v[40:43], v[208:211]
  v_mfma_f32_16x16x32_bf16 v[212:215], a[48:51], v[44:47], v[212:215]
  global_load_dwordx4 v[96:99], v248, s[42:43] offset:0
  v_mfma_f32_16x16x32_bf16 v[216:219], a[52:55], v[40:43], v[216:219]
  global_load_dwordx4 v[100:103], v248, s[42:43] offset:256
  v_add_u32 v248, 0x20000, v248
  v_mfma_f32_16x16x32_bf16 v[220:223], a[52:55], v[44:47], v[220:223]
  v_mfma_f32_16x16x32_bf16 v[224:227], a[56:59], v[40:43], v[224:227]
  v_mfma_f32_16x16x32_bf16 v[228:231], a[56:59], v[44:47], v[228:231]
  v_mfma_f32_16x16x32_bf16 v[232:235], a[60:63], v[40:43], v[232:235]
  v_mfma_f32_16x16x32_bf16 v[236:239], a[60:63], v[44:47], v[236:239]
  s_waitcnt vmcnt(13)
  v_mfma_f32_16x16x32_bf16 v[208:211], a[64:67], v[48:51], v[208:211]
  v_mfma_f32_16x16x32_bf16 v[212:215], a[64:67], v[52:55], v[212:215]
  global_load_dwordx4 v[104:107], v248, s[42:43] offset:0
  v_mfma_f32_16x16x32_bf16 v[216:219], a[68:71], v[48:51], v[216:219]
  global_load_dwordx4 v[108:111], v248, s[42:43] offset:256
  v_add_u32 v248, 0x20000, v248
  v_mfma_f32_16x16x32_bf16 v[220:223], a[68:71], v[52:55], v[220:223]
  v_mfma_f32_16x16x32_bf16 v[224:227], a[72:75], v[48:51], v[224:227]
  v_mfma_f32_16x16x32_bf16 v[228:231], a[72:75], v[52:55], v[228:231]
  v_mfma_f32_16x16x32_bf16 v[232:235], a[76:79], v[48:51], v[232:235]
  v_mfma_f32_16x16x32_bf16 v[236:239], a[76:79], v[52:55], v[236:239]
  s_waitcnt vmcnt(13)
  v_mfma_f32_16x16x32_bf16 v[208:211], a[80:83], v[56:59], v[208:211]
  v_mfma_f32_16x16x32_bf16 v[212:215], a[80:83], v[60:63], v[212:215]
  global_load_dwordx4 v[16:19], v248, s[42:43] offset:0
  v_mfma_f32_16x16x32_bf16 v[216:219], a[84:87], v[56:59], v[216:219]
  global_load_dwordx4 v[20:23], v248, s[42:43] offset:256
  v_add_u32 v248, 0x20000, v248
  v_mfma_f32_16x16x32_bf16 v[220:223], a[84:87], v[60:63], v[220:223]
  v_mfma_f32_16x16x32_bf16 v[224:227], a[88:91], v[56:59], v[224:227]
  v_mfma_f32_16x16x32_bf16 v[228:231], a[88:91], v[60:63], v[228:231]
  v_mfma_f32_16x16x32_bf16 v[232:235], a[92:95], v[56:59], v[232:235]
  v_mfma_f32_16x16x32_bf16 v[236:239], a[92:95], v[60:63], v[236:239]
  s_waitcnt vmcnt(13)
  v_mfma_f32_16x16x32_bf16 v[208:211], a[96:99], v[64:67], v[208:211]
  v_mfma_f32_16x16x32_bf16 v[212:215], a[96:99], v[68:71], v[212:215]
  global_load_dwordx4 v[24:27], v248, s[42:43] offset:0
  v_mfma_f32_16x16x32_bf16 v[216:219], a[100:103], v[64:67], v[216:219]
  global_load_dwordx4 v[28:31], v248, s[42:43] offset:256
  v_add_u32 v248, 0xffe64000, v248
  v_mfma_f32_16x16x32_bf16 v[220:223], a[100:103], v[68:71], v[220:223]
  v_mfma_f32_16x16x32_bf16 v[224:227], a[104:107], v[64:67], v[224:227]
  v_mfma_f32_16x16x32_bf16 v[228:231], a[104:107], v[68:71], v[228:231]
  v_mfma_f32_16x16x32_bf16 v[232:235], a[108:111], v[64:67], v[232:235]
  v_mfma_f32_16x16x32_bf16 v[236:239], a[108:111], v[68:71], v[236:239]
  s_waitcnt vmcnt(12)
  v_mfma_f32_16x16x32_bf16 v[208:211], a[112:115], v[72:75], v[208:211]
  v_mfma_f32_16x16x32_bf16 v[212:215], a[112:115], v[76:79], v[212:215]
  v_mfma_f32_16x16x32_bf16 v[216:219], a[116:119], v[72:75], v[216:219]
  v_mfma_f32_16x16x32_bf16 v[220:223], a[116:119], v[76:79], v[220:223]
  v_mfma_f32_16x16x32_bf16 v[224:227], a[120:123], v[72:75], v[224:227]
  v_mfma_f32_16x16x32_bf16 v[228:231], a[120:123], v[76:79], v[228:231]
  v_mfma_f32_16x16x32_bf16 v[232:235], a[124:127], v[72:75], v[232:235]
  v_mfma_f32_16x16x32_bf16 v[236:239], a[124:127], v[76:79], v[236:239]
  s_waitcnt vmcnt(10)
  v_mfma_f32_16x16x32_bf16 v[208:211], a[128:131], v[80:83], v[208:211]
  v_mfma_f32_16x16x32_bf16 v[212:215], a[128:131], v[84:87], v[212:215]
  v_mfma_f32_16x16x32_bf16 v[216:219], a[132:135], v[80:83], v[216:219]
  v_mfma_f32_16x16x32_bf16 v[220:223], a[132:135], v[84:87], v[220:223]
  v_mfma_f32_16x16x32_bf16 v[224:227], a[136:139], v[80:83], v[224:227]
  v_mfma_f32_16x16x32_bf16 v[228:231], a[136:139], v[84:87], v[228:231]
  v_mfma_f32_16x16x32_bf16 v[232:235], a[140:143], v[80:83], v[232:235]
  v_mfma_f32_16x16x32_bf16 v[236:239], a[140:143], v[84:87], v[236:239]
  s_waitcnt vmcnt(8)
  v_mfma_f32_16x16x32_bf16 v[208:211], a[144:147], v[88:91], v[208:211]
  v_mfma_f32_16x16x32_bf16 v[212:215], a[144:147], v[92:95], v[212:215]
  v_mfma_f32_16x16x32_bf16 v[216:219], a[148:151], v[88:91], v[216:219]
  v_mfma_f32_16x16x32_bf16 v[220:223], a[148:151], v[92:95], v[220:223]
  v_mfma_f32_16x16x32_bf16 v[224:227], a[152:155], v[88:91], v[224:227]
  v_mfma_f32_16x16x32_bf16 v[228:231], a[152:155], v[92:95], v[228:231]
  v_mfma_f32_16x16x32_bf16 v[232:235], a[156:159], v[88:91], v[232:235]
  v_mfma_f32_16x16x32_bf16 v[236:239], a[156:159], v[92:95], v[236:239]
  s_waitcnt vmcnt(6)
  v_mfma_f32_16x16x32_bf16 v[208:211], a[160:163], v[96:99], v[208:211]
  v_mfma_f32_16x16x32_bf16 v[212:215], a[160:163], v[100:103], v[212:215]
  v_mfma_f32_16x16x32_bf16 v[216:219], a[164:167], v[96:99], v[216:219]
  v_mfma_f32_16x16x32_bf16 v[220:223], a[164:167], v[100:103], v[220:223]
  v_mfma_f32_16x16x32_bf16 v[224:227], a[168:171], v[96:99], v[224:227]
  v_mfma_f32_16x16x32_bf16 v[228:231], a[168:171], v[100:103], v[228:231]
  v_mfma_f32_16x16x32_bf16 v[232:235], a[172:175], v[96:99], v[232:235]
  v_mfma_f32_16x16x32_bf16 v[236:239], a[172:175], v[100:103], v[236:239]
  s_waitcnt vmcnt(4)
  v_mfma_f32_16x16x32_bf16 v[208:211], a[176:179], v[104:107], v[208:211]
  v_mfma_f32_16x16x32_bf16 v[212:215], a[176:179], v[108:111], v[212:215]
  v_mfma_f32_16x16x32_bf16 v[216:219], a[180:183], v[104:107], v[216:219]
  v_mfma_f32_16x16x32_bf16 v[220:223], a[180:183], v[108:111], v[220:223]
  v_mfma_f32_16x16x32_bf16 v[224:227], a[184:187], v[104:107], v[224:227]
  v_mfma_f32_16x16x32_bf16 v[228:231], a[184:187], v[108:111], v[228:231]
  v_mfma_f32_16x16x32_bf16 v[232:235], a[188:191], v[104:107], v[232:235]
  v_mfma_f32_16x16x32_bf16 v[236:239], a[188:191], v[108:111], v[236:239]
  s_waitcnt vmcnt(2)
  v_mfma_f32_16x16x32_bf16 v[208:211], a[192:195], v[16:19], v[208:211]
  v_mfma_f32_16x16x32_bf16 v[212:215], a[192:195], v[20:23], v[212:215]
  v_mfma_f32_16x16x32_bf16 v[216:219], a[196:199], v[16:19], v[216:219]
  v_mfma_f32_16x16x32_bf16 v[220:223], a[196:199], v[20:23], v[220:223]
  v_mfma_f32_16x16x32_bf16 v[224:227], a[200:203], v[16:19], v[224:227]
  v_mfma_f32_16x16x32_bf16 v[228:231], a[200:203], v[20:23], v[228:231]
  v_mfma_f32_16x16x32_bf16 v[232:235], a[204:207], v[16:19], v[232:235]
  v_mfma_f32_16x16x32_bf16 v[236:239], a[204:207], v[20:23], v[236:239]
  s_waitcnt vmcnt(0)
  v_mfma_f32_16x16x32_bf16 v[208:211], a[208:211], v[24:27], v[208:211]
  v_mfma_f32_16x16x32_bf16 v[212:215], a[208:211], v[28:31], v[212:215]
  v_mfma_f32_16x16x32_bf16 v[216:219], a[212:215], v[24:27], v[216:219]
  v_mfma_f32_16x16x32_bf16 v[220:223], a[212:215], v[28:31], v[220:223]
  v_mfma_f32_16x16x32_bf16 v[224:227], a[216:219], v[24:27], v[224:227]
  v_mfma_f32_16x16x32_bf16 v[228:231], a[216:219], v[28:31], v[228:231]
  v_mfma_f32_16x16x32_bf16 v[232:235], a[220:223], v[24:27], v[232:235]
  v_mfma_f32_16x16x32_bf16 v[236:239], a[220:223], v[28:31], v[236:239]
  v_mul_u32_u24 v113, 272, v2
  v_lshl_add_u32 v113, v3, 4, v113
  s_mul_i32 s50, s34, 8704
  s_add_u32 s50, s50, 114688
  v_add_u32 v113, s50, v113
  v_and_b32 v114, 31, v1
  v_mul_u32_u24 v115, 272, v114
  v_lshrrev_b32 v116, 5, v1
  v_lshl_add_u32 v115, v116, 5, v115
  s_lshl_b32 s50, s34, 6
  s_add_u32 s50, s50, 114688
  v_add_u32 v115, s50, v115

  ds_write_b128 v113, v[208:211] offset:0
  ds_write_b128 v113, v[212:215] offset:4352
  ds_write_b128 v113, v[216:219] offset:64
  ds_write_b128 v113, v[220:223] offset:4416
  ds_write_b128 v113, v[224:227] offset:128
  ds_write_b128 v113, v[228:231] offset:4480
  ds_write_b128 v113, v[232:235] offset:192
  ds_write_b128 v113, v[236:239] offset:4544
  v_lshrrev_b32 v117, 2, v2
  v_lshl_add_u32 v117, v116, 3, v117
  v_lshlrev_b32 v117, 6, v117
  v_and_b32 v118, 1, v3
  v_lshl_add_u32 v117, v118, 5, v117
  v_and_b32 v118, 3, v2
  v_lshl_add_u32 v117, v118, 3, v117
  s_lshl_b32 s50, s34, 10
  s_add_u32 s50, s50, 155648
  v_add_u32 v117, s50, v117

  v_lshlrev_b32 v120, 16, v244
  v_and_b32 v121, s58, v244
  v_lshlrev_b32 v122, 16, v245
  v_and_b32 v123, s58, v245
  v_lshlrev_b32 v124, 16, v246
  v_and_b32 v125, s58, v246
  v_lshlrev_b32 v126, 16, v247
  v_and_b32 v127, s58, v247
  s_waitcnt lgkmcnt(0)
  s_barrier
  ds_read_b128 v[128:131], v115 offset:0
  ds_read_b128 v[132:135], v115 offset:16
  ds_read_b128 v[136:139], v115 offset:8704
  ds_read_b128 v[140:143], v115 offset:8720
  ds_read_b128 v[144:147], v115 offset:17408
  ds_read_b128 v[148:151], v115 offset:17424
  ds_read_b128 v[152:155], v115 offset:26112
  ds_read_b128 v[156:159], v115 offset:26128
  ds_read_b64_tr_b16 v[160:161], v117
  ds_read_b64_tr_b16 v[162:163], v117 offset:256
  s_waitcnt lgkmcnt(0)
  v_pk_add_f32 v[128:129], v[128:129], v[136:137]
  v_pk_add_f32 v[144:145], v[144:145], v[152:153]
  v_pk_add_f32 v[130:131], v[130:131], v[138:139]
  v_pk_add_f32 v[146:147], v[146:147], v[154:155]
  v_pk_add_f32 v[132:133], v[132:133], v[140:141]
  v_pk_add_f32 v[148:149], v[148:149], v[156:157]
  v_pk_add_f32 v[134:135], v[134:135], v[142:143]
  v_pk_add_f32 v[150:151], v[150:151], v[158:159]
  v_pk_add_f32 v[128:129], v[128:129], v[144:145]
  v_pk_add_f32 v[130:131], v[130:131], v[146:147]
  v_pk_add_f32 v[132:133], v[132:133], v[148:149]
  v_pk_add_f32 v[134:135], v[134:135], v[150:151]
  v_cvt_pk_bf16_f32 v164, v128, v129
  v_lshlrev_b32 v128, 16, v164
  v_and_b32 v129, s58, v164
  v_pk_add_f32 v[128:129], v[128:129], v[120:121]
  v_cvt_pk_bf16_f32 v164, v128, v129
  v_lshlrev_b32 v128, 16, v164
  v_and_b32 v129, s58, v164
  v_lshlrev_b32 v164, 16, v160
  v_and_b32 v165, s58, v160
  v_pk_add_f32 v[128:129], v[128:129], v[164:165]
  v_cvt_pk_bf16_f32 v172, v128, v129

  v_cvt_pk_bf16_f32 v166, v130, v131
  v_lshlrev_b32 v130, 16, v166
  v_and_b32 v131, s58, v166
  v_pk_add_f32 v[130:131], v[130:131], v[122:123]
  v_cvt_pk_bf16_f32 v166, v130, v131
  v_lshlrev_b32 v130, 16, v166
  v_and_b32 v131, s58, v166
  v_lshlrev_b32 v166, 16, v161
  v_and_b32 v167, s58, v161
  v_pk_add_f32 v[130:131], v[130:131], v[166:167]
  v_cvt_pk_bf16_f32 v173, v130, v131

  v_cvt_pk_bf16_f32 v168, v132, v133
  v_lshlrev_b32 v132, 16, v168
  v_and_b32 v133, s58, v168
  v_pk_add_f32 v[132:133], v[132:133], v[124:125]
  v_cvt_pk_bf16_f32 v168, v132, v133
  v_lshlrev_b32 v132, 16, v168
  v_and_b32 v133, s58, v168
  v_lshlrev_b32 v168, 16, v162
  v_and_b32 v169, s58, v162
  v_pk_add_f32 v[132:133], v[132:133], v[168:169]
  v_cvt_pk_bf16_f32 v174, v132, v133

  v_cvt_pk_bf16_f32 v170, v134, v135
  v_lshlrev_b32 v134, 16, v170
  v_and_b32 v135, s58, v170
  v_pk_add_f32 v[134:135], v[134:135], v[126:127]
  v_cvt_pk_bf16_f32 v170, v134, v135
  v_lshlrev_b32 v134, 16, v170
  v_and_b32 v135, s58, v170
  v_lshlrev_b32 v170, 16, v163
  v_and_b32 v171, s58, v163
  v_pk_add_f32 v[134:135], v[134:135], v[170:171]
  v_cvt_pk_bf16_f32 v175, v134, v135

  s_add_u32 s50, s48, 1024
  v_add_u32 v118, s50, v114
  v_lshlrev_b32 v118, 10, v118
  v_lshl_add_u32 v118, v250, 4, v118
  global_store_dwordx4 v118, v[172:175], s[28:29]

mega_kernel_end:
  s_endpgm
.section .rodata,"a"
.p2align 6
.amdhsa_kernel mega_kernel
  .amdhsa_next_free_vgpr 512
  .amdhsa_next_free_sgpr 102
  .amdhsa_accum_offset 256
  .amdhsa_group_segment_fixed_size 0
  .amdhsa_kernarg_size 120
  .amdhsa_user_sgpr_count 2
  .amdhsa_user_sgpr_kernarg_segment_ptr 1
  .amdhsa_system_sgpr_workgroup_id_x 1
.end_amdhsa_kernel
```
